```python
import torch

def _softmax(x, axis=-1):
    return torch.softmax(x, dim=axis)
def _gelu(x):
    return torch.nn.functional.gelu(x, approximate="tanh")
def _silu(x):
    return torch.nn.functional.silu(x)
def _sigmoid(x):
    return torch.sigmoid(x)
def _layernorm(x, axis=-1, eps=1e-5):
    m = x.mean(dim=axis, keepdim=True)
    v = x.var(dim=axis, keepdim=True, unbiased=False)
    return (x - m) / torch.sqrt(v + eps)
def _scatter_add(tgt, idx, src, axis=0):
    return tgt.clone().index_add_(axis, idx, src)
def _segment_sum(src, seg, n):
    out = torch.zeros((n,) + src.shape[1:], dtype=src.dtype)
    return out.index_add_(0, seg, src)
def _pad(x, pw):
    flat = tuple(v for pair in reversed(pw) for v in pair)
    return torch.nn.functional.pad(x, flat)

kernel_name = 'sequential_preLN__ssm_conv_s4__geglu_ffn__prompt'

def setup_inputs():

    _w = (lambda a: (lambda t: t.to(torch.bfloat16) if t.is_floating_point() else t)(torch.as_tensor(a)))
    def _A_setup():
        B, L, D, N = 1, 2048, 640, 128
        A_re = -(lambda _x: torch.exp(torch.as_tensor(_x)))((lambda *s: torch.randn(*s, dtype=torch.bfloat16) * 6.4)(D, N))
        A_im = torch.pi * (lambda *s: torch.randn(*s, dtype=torch.bfloat16) * 0.05)(D, N)
        B_re = (lambda *s: torch.randn(*s, dtype=torch.bfloat16) * 0.05)(D, N)
        B_im = (lambda *s: torch.randn(*s, dtype=torch.bfloat16) * 0.05)(D, N)
        C_re = (lambda *s: torch.randn(*s, dtype=torch.bfloat16) * 0.05)(D, N)
        C_im = (lambda *s: torch.randn(*s, dtype=torch.bfloat16) * 0.05)(D, N)
        log_dt = (lambda *s: torch.randn(*s, dtype=torch.bfloat16) * 0.05)(D) * 0.5 - 4.0
        Dskip = (lambda *s: torch.randn(*s, dtype=torch.bfloat16) * 0.05)(D)
        return {
            "u": _w((lambda *s: torch.randn(*s, dtype=torch.bfloat16) * 0.05)(B, L, D)),
            "A_re": _w(A_re),
            "A_im": _w(A_im),
            "B_re": _w(B_re),
            "B_im": _w(B_im),
            "C_re": _w(C_re),
            "C_im": _w(C_im),
            "log_dt": _w(log_dt),
            "Dskip": _w(Dskip),
        }
    _A_in = _A_setup()

    def _B_setup():
        B, S, D, F = 1, 2048, 640, 1728
        return {
            "x": _w((lambda *s: torch.randn(*s, dtype=torch.bfloat16) * 0.05)(B, S, D)),
            "w_gate": _w((lambda *s: torch.randn(*s, dtype=torch.bfloat16) * 0.05)(D, F)),
            "w_up": _w((lambda *s: torch.randn(*s, dtype=torch.bfloat16) * 0.05)(D, F)),
            "w_down": _w((lambda *s: torch.randn(*s, dtype=torch.bfloat16) * 0.05)(F, D)),
        }
    _B_in = _B_setup()

    return {
        "A_u": _A_in["u"],
        "A_A_re": _A_in["A_re"],
        "A_A_im": _A_in["A_im"],
        "A_B_re": _A_in["B_re"],
        "A_B_im": _A_in["B_im"],
        "A_C_re": _A_in["C_re"],
        "A_C_im": _A_in["C_im"],
        "A_log_dt": _A_in["log_dt"],
        "A_Dskip": _A_in["Dskip"],
        "B_x": _B_in["x"],
        "B_w_gate": _B_in["w_gate"],
        "B_w_up": _B_in["w_up"],
        "B_w_down": _B_in["w_down"],
    }

def reference(A_u, A_A_re, A_A_im, A_B_re, A_B_im, A_C_re, A_C_im, A_log_dt, A_Dskip, B_x, B_w_gate, B_w_up, B_w_down):
    def _A_ref(u, A_re, A_im, B_re, B_im, C_re, C_im, log_dt, Dskip):
        Bsz, L, D = u.shape
        dt = torch.exp(log_dt)[:, None]
        A = A_re + 1j * A_im
        Bc = B_re + 1j * B_im
        Cc = C_re + 1j * C_im
        logdA = dt * A
        dB = dt * Bc
        l = (lambda x, dt: x.to(dt))(torch.arange(L), A_re.dtype)
        P = torch.exp(logdA[:, :, None] * l[None, None, :])
        K = torch.einsum("dn,dnl,dn->dl", Cc, P, dB).real
        L2 = 2 * L
        Kp = _pad(K, ((0, 0), (0, L)))
        up = (lambda x, *d: x.permute(*d))(u, 0, 2, 1)
        up = _pad(up, ((0, 0), (0, 0), (0, L)))
        Kf = (lambda x, axes=(-2,-1): torch.fft.rfft2(x.float(), dim=axes))(Kp[:, None, :], axes=(-2, -1))
        Uf = (lambda x, axes=(-2,-1): torch.fft.rfft2(x.float(), dim=axes))(up[:, :, None, :], axes=(-2, -1))
        Yf = Uf * Kf[None, :, :, :]
        y = (lambda x, s, axes=(-2,-1): torch.fft.irfft2(x, s=s, dim=axes).to(torch.bfloat16))(Yf, (1, L2), axes=(-2, -1))[:, :, 0, :L]
        y = (lambda x, *d: x.permute(*d))(y, 0, 2, 1) + u * Dskip[None, None, :]
        return y

    def _B_ref(x, w_gate, w_up, w_down):
        return (_gelu(x @ w_gate) * (x @ w_up)) @ w_down

    x = A_u
    h = x + _A_ref(_layernorm(x, axis=-1), A_A_re, A_A_im, A_B_re, A_B_im, A_C_re, A_C_im, A_log_dt, A_Dskip)
    h2 = h + _B_ref(_layernorm(h, axis=-1), B_w_gate, B_w_up, B_w_down)
    return h2
```

```asm
; @launch grid=(256,1,1) block=(256,1,1) lds=163840
.amdgcn_target "amdgcn-amd-amdhsa--gfx950"
.text
.globl sequential_preLN__ssm_conv_s4__geglu_ffn__prompt_kernel
.p2align 8
.type sequential_preLN__ssm_conv_s4__geglu_ffn__prompt_kernel,@function
sequential_preLN__ssm_conv_s4__geglu_ffn__prompt_kernel:
  s_cmp_ge_u32 s2, 256
  s_cbranch_scc1 sequential_preLN__ssm_conv_s4__geglu_ffn__prompt_kernel_end
  s_load_dwordx16 s[4:19], s[0:1], 0
  s_load_dwordx16 s[20:35], s[0:1], 64
  s_getpc_b64 s[62:63]
sequential_preLN__ssm_conv_s4__geglu_ffn__prompt_kernel_pc0:
  s_lshr_b32 s59, s2, 3
  s_add_u32 s58, s2, 0
  s_and_b32 s58, s58, 7
  v_lshrrev_b32 v2, 6, v0
  v_and_b32 v1, 63, v0
  s_lshl_b32 s64, s59, 14
  v_lshl_add_u32 v4, v0, 6, s64
  v_readfirstlane_b32 s57, v2
  v_min_u32 v4, sequential_preLN__ssm_conv_s4__geglu_ffn__prompt_kernel_last-sequential_preLN__ssm_conv_s4__geglu_ffn__prompt_kernel_pc0-16, v4
  v_mov_b32 v5, s63
  v_add_co_u32 v250, vcc, s62, v4
  s_nop 1
  v_addc_co_u32 v251, vcc, 0, v5, vcc
  global_load_dwordx4 v[252:255], v[250:251], off
  s_lshr_b32 s64, s59, 2
  s_and_b32 s65, s59, 3
  s_and_b32 s66, s64, 1
  s_lshr_b32 s64, s64, 1
  s_add_u32 s67, s65, s66
  v_mov_b32 v9, 0
  v_lshlrev_b32 v3, 4, v1
  v_mov_b32 v4, 0x40000000
  v_cmp_ne_u32 vcc, 0, v1
  s_nop 1
  v_cndmask_b32 v15, 0, v4, vcc
  s_mov_b32 s42, 0x280000
  s_mov_b32 s43, 0x00020000
  s_mov_b32 s38, 0x10000000
  s_mov_b32 s39, 0x00020000
  s_mov_b32 s54, 0x280000
  s_mov_b32 s55, 0x00020000
  s_cmp_ge_u32 s67, 3
  s_cbranch_scc1 sequential_preLN__ssm_conv_s4__geglu_ffn__prompt_kernel_rep
  s_and_b32 s60, s58, 1
  s_xor_b32 s60, s60, 1
  s_lshr_b32 s67, s58, 1
  s_lshl2_add_u32 s60, s60, s67
  s_mul_i32 s60, s60, 20
  s_mul_i32 s64, s64, 5
  s_mul_i32 s66, s66, 3
  s_add_u32 s60, s60, s65
  s_add_u32 s64, s64, s66
  s_add_u32 s60, s60, s64
  s_lshl_b32 s64, s60, 2
  s_add_u32 s64, s64, s57
  s_lshl_b32 s64, s64, 1
  s_lshl_b32 s65, s60, 10
  v_lshl_add_u32 v20, v0, 2, s65
  v_mov_b32 v21, s64
  v_mul_u32_u24 v198, 5120, v0
  s_lshl_b32 s75, s60, 3
  s_add_u32 s76, s75, 1310720
  v_and_b32 v16, 15, v1
  v_lshrrev_b32 v17, 4, v1
  v_mul_u32_u24 v195, 40960, v17
  v_lshl_add_u32 v195, v16, 4, v195
  s_mul_i32 s70, s57, 163840
  s_lshl_b32 s64, s60, 8
  s_add_u32 s70, s70, s64
  s_add_u32 s70, s70, 0x100000
  s_add_u32 s71, s70, 655360
  s_add_u32 s72, s71, 655360
  s_add_u32 s73, s72, 655360
  s_waitcnt lgkmcnt(0)
  global_load_ushort v202, v21, s[18:19]
  global_load_dword v24, v20, s[6:7]
  global_load_dword v25, v20, s[8:9]
  global_load_dword v26, v20, s[10:11]
  global_load_dword v27, v20, s[12:13]
  global_load_dword v28, v20, s[14:15]
  global_load_dword v29, v20, s[16:17]
  global_load_ushort v203, v21, s[20:21]
  s_mov_b32 s36, s34
  s_mov_b32 s37, s35
  s_mov_b32 s40, s4
  s_mov_b32 s41, s5
  buffer_load_dword v9, v9, s[36:39], 0 offen sc1
  s_mov_b32 s52, s30
  s_mov_b32 s53, s31
  buffer_load_dwordx2 v[208:209], v198, s[40:43], s75 offen offset:0
  buffer_load_dwordx2 v[210:211], v198, s[40:43], s75 offen offset:1280
  buffer_load_dwordx2 v[212:213], v198, s[40:43], s75 offen offset:2560
  v_lshlrev_b32 v199, 5, v0
  v_lshlrev_b32 v201, 3, v0
  s_mov_b32 s77, 0x10000
  s_mov_b32 s69, 0x12000
  v_add_u32 v200, 98880, v201
  v_add_u32 v201, 81920, v201
  s_mov_b32 s20, 0x05040100
  s_mov_b32 s21, 0x07060302
  s_mul_i32 s74, s57, 8336
  s_add_u32 s74, s74, 116800
  s_mul_i32 s67, s57, 4608
  s_add_u32 s67, s67, 98368
  v_lshlrev_b32 v20, 5, v16
  v_lshl_add_u32 v192, v17, 3, v20
  v_lshl_add_u32 v196, v17, 4, v20
  v_add_u32 v196, s67, v196
  v_lshlrev_b32 v197, 3, v17
  v_sub_u32 v197, v197, v16
  v_add_u32 v197, 2031, v197
  v_and_b32 v20, 1, v197
  v_mul_u32_u24 v20, 4162, v20
  v_lshl_add_u32 v197, v197, 1, v20
  v_add_u32 v197, s74, v197
  v_lshlrev_b32 v194, 6, v17
  v_and_b32 v20, 3, v1
  v_lshl_add_u32 v194, v20, 3, v194
  v_bfe_u32 v20, v1, 2, 1
  v_mul_u32_u24 v20, 1056, v20
  v_bfe_u32 v21, v1, 3, 1
  v_mul_u32_u24 v21, 2176, v21
  v_add3_u32 v194, v194, v20, v21
  s_lshl_b32 s64, s57, 8
  s_add_u32 s64, s64, 150144
  v_add_u32 v194, s64, v194
  s_and_b32 s64, s57, 1
  s_mul_i32 s64, s64, 1056
  s_lshr_b32 s65, s57, 1
  s_mul_i32 s65, s65, 2176
  s_add_u32 s64, s64, s65
  s_add_u32 s64, s64, 150144
  v_add_u32 v193, s64, v192
  s_mul_i32 s64, s57, 4112
  s_add_u32 s64, s64, 81920
  v_add_u32 v192, s64, v192
  v_add_u32 v188, -960, v197
  v_add_u32 v189, -1984, v197
  v_add_u32 v190, -3008, v197
  v_add_u32 v191, -4032, v197
  s_lshr_b32 s64, s58, 1
  s_and_b32 s65, s59, 3
  s_sub_u32 s65, 3, s65
  s_lshl_b32 s65, s65, 2
  s_add_u32 s61, s64, s65
  s_add_u32 s64, s64, 1
  s_and_b32 s64, s64, 3
  s_add_u32 s4, s64, s65
  s_and_b32 s64, s58, 1
  s_lshl1_add_u32 s4, s4, s64
  s_lshl_b32 s64, s64, 3
  s_lshr_b32 s5, s59, 2
  s_add_u32 s62, s64, s5
  s_mul_i32 s64, s62, 7
  s_lshr_b32 s65, s62, 2
  s_sub_u32 s7, s64, s65
  s_mul_i32 s63, s7, 41984
  s_lshl_b32 s6, s57, 12
  s_add_u32 s63, s63, s6
  s_add_u32 s63, s63, 0xe00000
  s_mul_i32 s65, s57, 14
  s_mul_i32 s64, s65, 40960
  s_mul_i32 s25, s5, 5120
  s_add_u32 s79, s64, s25
  v_add_u32 v0, s79, v3
  s_movk_i32 s100, 4096
  s_lshl_b32 s65, s65, 2
  v_min_u32 v13, 55, v1
  v_add_u32 v13, s65, v13
  v_lshlrev_b32 v13, 5, v13
  s_lshr_b32 s64, s7, 2
  s_mul_i32 s64, s64, 14
  s_add_u32 s25, s7, 6
  s_lshr_b32 s25, s25, 2
  s_min_u32 s25, s25, 26
  s_mul_i32 s25, s25, 14
  s_add_u32 s25, s25, 13
  v_add_u32 v12, s64, v1
  v_min_u32 v12, s25, v12
  v_lshlrev_b32 v12, 5, v12
  s_mov_b32 s18, 0x40000
  s_mov_b32 s19, 0x4c000
  v_bfe_u32 v4, v1, 4, 1
  v_mul_u32_u24 v8, 55296, v4
  v_and_b32 v4, 15, v1
  v_lshl_add_u32 v8, v4, 5, v8
  buffer_load_dwordx2 v[214:215], v198, s[40:43], s75 offen offset:3840
  buffer_load_dwordx2 v[216:217], v198, s[40:43], s76 offen offset:0
  s_mov_b32 s23, 1664525
  s_waitcnt vmcnt(5)
  v_mul_lo_u32 v9, v9, s23
  v_add_u32 v2, 1013904223, v9
  s_nop 0
  v_readfirstlane_b32 s56, v2
  v_lshlrev_b32 v30, 16, v202
  v_mul_f32 v30, 0x3fb8aa3b, v30
  v_exp_f32 v30, v30
  s_mul_i32 s99, s57, 33792
  v_lshl_add_u32 v22, v1, 3, s99
  v_cvt_pk_bf16_f32 v30, v30, v30
  v_and_b32 v30, 0xffff0000, v30
  v_lshlrev_b32 v32, 16, v24
  v_and_b32 v33, 0xffff0000, v24
  v_lshlrev_b32 v34, 16, v25
  v_and_b32 v35, 0xffff0000, v25
  v_lshlrev_b32 v36, 16, v26
  v_and_b32 v37, 0xffff0000, v26
  v_lshlrev_b32 v38, 16, v27
  v_and_b32 v39, 0xffff0000, v27
  v_lshlrev_b32 v40, 16, v28
  v_and_b32 v41, 0xffff0000, v28
  v_lshlrev_b32 v42, 16, v29
  v_and_b32 v43, 0xffff0000, v29
  v_mov_b32 v31, v30
  v_pk_mul_f32 v[32:33], v[32:33], v[30:31]
  v_pk_mul_f32 v[34:35], v[34:35], v[30:31]
  v_pk_mul_f32 v[36:37], v[36:37], v[30:31]
  v_pk_mul_f32 v[38:39], v[38:39], v[30:31]
  v_mul_f32 v32, 0x3fb8aa3b, v32
  v_mul_f32 v33, 0x3fb8aa3b, v33
  v_mul_f32 v34, 0x3e22f983, v34
  v_mul_f32 v35, 0x3e22f983, v35
  v_pk_mul_f32 v[68:69], v[42:43], v[38:39]
  v_pk_mul_f32 v[70:71], v[40:41], v[38:39]
  v_pk_fma_f32 v[64:65], v[40:41], v[36:37], v[68:69] neg_lo:[0,0,1] neg_hi:[0,0,1]
  v_pk_fma_f32 v[66:67], v[42:43], v[36:37], v[70:71]
  v_mul_f32 v72, 0x41000000, v32
  v_mul_f32 v76, 0x41000000, v33
  v_mul_f32 v73, 0x41000000, v34
  v_mul_f32 v77, 0x41000000, v35
  v_exp_f32 v72, v72
  v_exp_f32 v76, v76
  v_fract_f32 v73, v73
  v_fract_f32 v77, v77
  v_cos_f32 v74, v73
  v_cos_f32 v78, v77
  v_sin_f32 v75, v73
  v_sin_f32 v79, v77
  v_mul_f32 v48, v72, v74
  v_mul_f32 v49, v76, v78
  v_mul_f32 v50, v72, v75
  v_mul_f32 v51, v76, v79
  v_exp_f32 v72, v32
  v_exp_f32 v76, v33
  v_fract_f32 v73, v34
  v_fract_f32 v77, v35
  v_cos_f32 v74, v73
  v_cos_f32 v78, v77
  v_sin_f32 v75, v73
  v_sin_f32 v79, v77
  v_mul_f32 v44, v72, v74
  v_mul_f32 v45, v76, v78
  v_mul_f32 v46, v72, v75
  v_mul_f32 v47, v76, v79
  v_mul_f32 v72, 0x43800000, v32
  v_mul_f32 v76, 0x43800000, v33
  v_mul_f32 v73, 0x43800000, v34
  v_mul_f32 v77, 0x43800000, v35
  v_exp_f32 v72, v72
  v_exp_f32 v76, v76
  v_fract_f32 v73, v73
  v_fract_f32 v77, v77
  v_cos_f32 v74, v73
  v_cos_f32 v78, v77
  v_sin_f32 v75, v73
  v_sin_f32 v79, v77
  v_mul_f32 v52, v72, v74
  v_mul_f32 v53, v76, v78
  v_mul_f32 v54, v72, v75
  v_mul_f32 v55, v76, v79
  v_mov_b32 v112, 0x3f803f80
  v_mov_b32 v113, 0
  v_cvt_pk_bf16_f32 v104, v64, v65
  ds_write_b64 v22, v[112:113] offset:16896
  v_cvt_pk_bf16_f32 v105, v66, v67
  v_mov_b32 v80, v48
  ds_write_b64 v22, v[104:105] offset:0
  v_mov_b32 v81, v49
  v_pk_mul_f32 v[68:69], v[66:67], v[46:47]
  v_sub_f32 v82, 0, v50
  v_pk_mul_f32 v[70:71], v[64:65], v[46:47]
  v_sub_f32 v83, 0, v51
  v_pk_fma_f32 v[88:89], v[64:65], v[44:45], v[68:69] neg_lo:[0,0,1] neg_hi:[0,0,1]
  v_cvt_pk_bf16_f32 v98, v80, v81
  v_pk_fma_f32 v[90:91], v[66:67], v[44:45], v[70:71]
  v_cvt_pk_bf16_f32 v99, v82, v83
  v_cvt_pk_bf16_f32 v106, v88, v89
  ds_write_b64 v22, v[98:99] offset:17424
  v_cvt_pk_bf16_f32 v107, v90, v91
  v_pk_mul_f32 v[84:85], v[82:83], v[50:51]
  ds_write_b64 v22, v[106:107] offset:528
  v_pk_mul_f32 v[86:87], v[80:81], v[50:51]
  v_pk_mul_f32 v[68:69], v[90:91], v[46:47]
  v_pk_fma_f32 v[80:81], v[80:81], v[48:49], v[84:85]
  v_pk_mul_f32 v[70:71], v[88:89], v[46:47]
  v_pk_fma_f32 v[82:83], v[82:83], v[48:49], v[86:87] neg_lo:[0,0,1] neg_hi:[0,0,1]
  v_cvt_pk_bf16_f32 v100, v80, v81
  v_pk_fma_f32 v[88:89], v[88:89], v[44:45], v[68:69] neg_lo:[0,0,1] neg_hi:[0,0,1]
  v_cvt_pk_bf16_f32 v101, v82, v83
  v_pk_fma_f32 v[90:91], v[90:91], v[44:45], v[70:71]
  ds_write_b64 v22, v[100:101] offset:17952
  v_cvt_pk_bf16_f32 v108, v88, v89
  v_pk_mul_f32 v[84:85], v[82:83], v[50:51]
  v_cvt_pk_bf16_f32 v109, v90, v91
  v_pk_mul_f32 v[86:87], v[80:81], v[50:51]
  ds_write_b64 v22, v[108:109] offset:1056
  v_pk_fma_f32 v[80:81], v[80:81], v[48:49], v[84:85]
  v_pk_mul_f32 v[68:69], v[90:91], v[46:47]
  v_pk_fma_f32 v[82:83], v[82:83], v[48:49], v[86:87] neg_lo:[0,0,1] neg_hi:[0,0,1]
  v_pk_mul_f32 v[70:71], v[88:89], v[46:47]
  v_cvt_pk_bf16_f32 v102, v80, v81
  v_pk_fma_f32 v[88:89], v[88:89], v[44:45], v[68:69] neg_lo:[0,0,1] neg_hi:[0,0,1]
  buffer_load_dwordx2 v[218:219], v198, s[40:43], s76 offen offset:1280
  v_cvt_pk_bf16_f32 v103, v82, v83
  v_pk_fma_f32 v[90:91], v[90:91], v[44:45], v[70:71]
  ds_write_b64 v22, v[102:103] offset:18480
  v_cvt_pk_bf16_f32 v110, v88, v89
  v_pk_mul_f32 v[84:85], v[82:83], v[50:51]
  v_cvt_pk_bf16_f32 v111, v90, v91
  v_pk_mul_f32 v[86:87], v[80:81], v[50:51]
  ds_write_b64 v22, v[110:111] offset:1584
  v_pk_fma_f32 v[80:81], v[80:81], v[48:49], v[84:85]
  v_pk_mul_f32 v[68:69], v[90:91], v[46:47]
  v_pk_fma_f32 v[82:83], v[82:83], v[48:49], v[86:87] neg_lo:[0,0,1] neg_hi:[0,0,1]
  v_cvt_pk_bf16_f32 v96, v80, v81
  v_pk_mul_f32 v[70:71], v[88:89], v[46:47]
  v_cvt_pk_bf16_f32 v97, v82, v83
  v_pk_fma_f32 v[88:89], v[88:89], v[44:45], v[68:69] neg_lo:[0,0,1] neg_hi:[0,0,1]
  ds_write_b64 v22, v[96:97] offset:19008
  v_pk_fma_f32 v[90:91], v[90:91], v[44:45], v[70:71]
  v_pk_mul_f32 v[84:85], v[82:83], v[50:51]
  v_cvt_pk_bf16_f32 v104, v88, v89
  v_pk_mul_f32 v[86:87], v[80:81], v[50:51]
  v_cvt_pk_bf16_f32 v105, v90, v91
  v_pk_fma_f32 v[80:81], v[80:81], v[48:49], v[84:85]
  ds_write_b64 v22, v[104:105] offset:4224
  v_pk_fma_f32 v[82:83], v[82:83], v[48:49], v[86:87] neg_lo:[0,0,1] neg_hi:[0,0,1]
  v_pk_mul_f32 v[68:69], v[90:91], v[46:47]
  v_cvt_pk_bf16_f32 v98, v80, v81
  v_pk_mul_f32 v[70:71], v[88:89], v[46:47]
  v_cvt_pk_bf16_f32 v99, v82, v83
  v_pk_fma_f32 v[88:89], v[88:89], v[44:45], v[68:69] neg_lo:[0,0,1] neg_hi:[0,0,1]
  ds_write_b64 v22, v[98:99] offset:19536
  v_pk_fma_f32 v[90:91], v[90:91], v[44:45], v[70:71]
  v_pk_mul_f32 v[84:85], v[82:83], v[50:51]
  v_cvt_pk_bf16_f32 v106, v88, v89
  v_pk_mul_f32 v[86:87], v[80:81], v[50:51]
  v_cvt_pk_bf16_f32 v107, v90, v91
  v_pk_fma_f32 v[80:81], v[80:81], v[48:49], v[84:85]
  ds_write_b64 v22, v[106:107] offset:4752
  v_pk_fma_f32 v[82:83], v[82:83], v[48:49], v[86:87] neg_lo:[0,0,1] neg_hi:[0,0,1]
  v_cvt_pk_bf16_f32 v100, v80, v81
  v_pk_mul_f32 v[68:69], v[90:91], v[46:47]
  v_cvt_pk_bf16_f32 v101, v82, v83
  v_pk_mul_f32 v[70:71], v[88:89], v[46:47]
  ds_write_b64 v22, v[100:101] offset:20064
  v_pk_fma_f32 v[88:89], v[88:89], v[44:45], v[68:69] neg_lo:[0,0,1] neg_hi:[0,0,1]
  v_pk_mul_f32 v[84:85], v[82:83], v[50:51]
  v_pk_fma_f32 v[90:91], v[90:91], v[44:45], v[70:71]
  v_pk_mul_f32 v[86:87], v[80:81], v[50:51]
  v_cvt_pk_bf16_f32 v108, v88, v89
  v_pk_fma_f32 v[80:81], v[80:81], v[48:49], v[84:85]
  v_cvt_pk_bf16_f32 v109, v90, v91
  v_pk_fma_f32 v[82:83], v[82:83], v[48:49], v[86:87] neg_lo:[0,0,1] neg_hi:[0,0,1]
  ds_write_b64 v22, v[108:109] offset:5280
  v_cvt_pk_bf16_f32 v102, v80, v81
  v_pk_mul_f32 v[68:69], v[90:91], v[46:47]
  v_cvt_pk_bf16_f32 v103, v82, v83
  v_pk_mul_f32 v[70:71], v[88:89], v[46:47]
  ds_write_b64 v22, v[102:103] offset:20592
  v_pk_fma_f32 v[88:89], v[88:89], v[44:45], v[68:69] neg_lo:[0,0,1] neg_hi:[0,0,1]
  v_pk_mul_f32 v[84:85], v[82:83], v[50:51]
  v_pk_fma_f32 v[90:91], v[90:91], v[44:45], v[70:71]
  v_pk_mul_f32 v[86:87], v[80:81], v[50:51]
  v_cvt_pk_bf16_f32 v110, v88, v89
  v_pk_fma_f32 v[80:81], v[80:81], v[48:49], v[84:85]
  v_cvt_pk_bf16_f32 v111, v90, v91
  v_pk_fma_f32 v[82:83], v[82:83], v[48:49], v[86:87] neg_lo:[0,0,1] neg_hi:[0,0,1]
  v_cvt_pk_bf16_f32 v96, v80, v81
  ds_write_b64 v22, v[110:111] offset:5808
  v_cvt_pk_bf16_f32 v97, v82, v83
  v_pk_mul_f32 v[68:69], v[90:91], v[46:47]
  ds_write_b64 v22, v[96:97] offset:21120
  v_pk_mul_f32 v[70:71], v[88:89], v[46:47]
  v_pk_mul_f32 v[84:85], v[82:83], v[50:51]
  v_pk_fma_f32 v[88:89], v[88:89], v[44:45], v[68:69] neg_lo:[0,0,1] neg_hi:[0,0,1]
  v_pk_mul_f32 v[86:87], v[80:81], v[50:51]
  v_pk_fma_f32 v[90:91], v[90:91], v[44:45], v[70:71]
  v_pk_fma_f32 v[80:81], v[80:81], v[48:49], v[84:85]
  v_cvt_pk_bf16_f32 v104, v88, v89
  v_pk_fma_f32 v[82:83], v[82:83], v[48:49], v[86:87] neg_lo:[0,0,1] neg_hi:[0,0,1]
  v_cvt_pk_bf16_f32 v105, v90, v91
  v_cvt_pk_bf16_f32 v98, v80, v81
  ds_write_b64 v22, v[104:105] offset:14256
  v_cvt_pk_bf16_f32 v99, v82, v83
  v_pk_mul_f32 v[68:69], v[46:47], v[46:47]
  ds_write_b64 v22, v[98:99] offset:21648
  v_pk_mul_f32 v[70:71], v[44:45], v[46:47]
  buffer_load_dwordx2 v[220:221], v198, s[40:43], s76 offen offset:2560
  v_pk_mul_f32 v[84:85], v[82:83], v[50:51]
  v_pk_fma_f32 v[56:57], v[44:45], v[44:45], v[68:69] neg_lo:[0,0,1] neg_hi:[0,0,1]
  v_pk_mul_f32 v[86:87], v[80:81], v[50:51]
  v_pk_fma_f32 v[58:59], v[46:47], v[44:45], v[70:71]
  v_pk_fma_f32 v[80:81], v[80:81], v[48:49], v[84:85]
  v_pk_fma_f32 v[82:83], v[82:83], v[48:49], v[86:87] neg_lo:[0,0,1] neg_hi:[0,0,1]
  v_pk_mul_f32 v[68:69], v[58:59], v[58:59]
  v_cvt_pk_bf16_f32 v100, v80, v81
  v_pk_mul_f32 v[70:71], v[56:57], v[58:59]
  v_cvt_pk_bf16_f32 v101, v82, v83
  v_pk_fma_f32 v[60:61], v[56:57], v[56:57], v[68:69] neg_lo:[0,0,1] neg_hi:[0,0,1]
  ds_write_b64 v22, v[100:101] offset:22176
  v_pk_fma_f32 v[62:63], v[58:59], v[56:57], v[70:71]
  v_pk_mul_f32 v[84:85], v[82:83], v[50:51]
  v_pk_mul_f32 v[68:69], v[66:67], v[54:55]
  v_pk_mul_f32 v[86:87], v[80:81], v[50:51]
  v_pk_mul_f32 v[70:71], v[64:65], v[54:55]
  v_pk_fma_f32 v[80:81], v[80:81], v[48:49], v[84:85]
  v_pk_fma_f32 v[92:93], v[64:65], v[52:53], v[68:69] neg_lo:[0,0,1] neg_hi:[0,0,1]
  v_pk_fma_f32 v[82:83], v[82:83], v[48:49], v[86:87] neg_lo:[0,0,1] neg_hi:[0,0,1]
  v_pk_fma_f32 v[94:95], v[66:67], v[52:53], v[70:71]
  v_cvt_pk_bf16_f32 v102, v80, v81
  v_cvt_pk_bf16_f32 v106, v92, v93
  v_cvt_pk_bf16_f32 v103, v82, v83
  v_cvt_pk_bf16_f32 v107, v94, v95
  ds_write_b64 v22, v[102:103] offset:22704
  ds_write_b64 v22, v[106:107] offset:2112
  v_pk_mul_f32 v[84:85], v[82:83], v[50:51]
  ds_write_b64 v22, v[106:107] offset:2640
  v_pk_mul_f32 v[86:87], v[80:81], v[50:51]
  v_pk_mul_f32 v[68:69], v[94:95], v[58:59]
  v_pk_fma_f32 v[80:81], v[80:81], v[48:49], v[84:85]
  v_pk_fma_f32 v[82:83], v[82:83], v[48:49], v[86:87] neg_lo:[0,0,1] neg_hi:[0,0,1]
  v_pk_mul_f32 v[70:71], v[92:93], v[58:59]
  v_cvt_pk_bf16_f32 v96, v80, v81
  v_pk_fma_f32 v[88:89], v[92:93], v[56:57], v[68:69] neg_lo:[0,0,1] neg_hi:[0,0,1]
  v_cvt_pk_bf16_f32 v97, v82, v83
  v_pk_fma_f32 v[90:91], v[94:95], v[56:57], v[70:71]
  ds_write_b64 v22, v[96:97] offset:23232
  v_cvt_pk_bf16_f32 v108, v88, v89
  v_pk_mul_f32 v[84:85], v[82:83], v[50:51]
  v_cvt_pk_bf16_f32 v109, v90, v91
  v_pk_mul_f32 v[86:87], v[80:81], v[50:51]
  ds_write_b64 v22, v[108:109] offset:3168
  v_pk_fma_f32 v[80:81], v[80:81], v[48:49], v[84:85]
  v_pk_mul_f32 v[68:69], v[90:91], v[58:59]
  v_pk_fma_f32 v[82:83], v[82:83], v[48:49], v[86:87] neg_lo:[0,0,1] neg_hi:[0,0,1]
  v_pk_mul_f32 v[70:71], v[88:89], v[58:59]
  v_cvt_pk_bf16_f32 v98, v80, v81
  v_pk_fma_f32 v[88:89], v[88:89], v[56:57], v[68:69] neg_lo:[0,0,1] neg_hi:[0,0,1]
  v_cvt_pk_bf16_f32 v99, v82, v83
  v_pk_fma_f32 v[90:91], v[90:91], v[56:57], v[70:71]
  ds_write_b64 v22, v[98:99] offset:23760
  v_cvt_pk_bf16_f32 v110, v88, v89
  v_pk_mul_f32 v[84:85], v[82:83], v[50:51]
  v_cvt_pk_bf16_f32 v111, v90, v91
  v_pk_mul_f32 v[86:87], v[80:81], v[50:51]
  ds_write_b64 v22, v[110:111] offset:3696
  v_pk_fma_f32 v[80:81], v[80:81], v[48:49], v[84:85]
  v_pk_fma_f32 v[82:83], v[82:83], v[48:49], v[86:87] neg_lo:[0,0,1] neg_hi:[0,0,1]
  ds_write_b64 v22, v[110:111] offset:6336
  v_cvt_pk_bf16_f32 v100, v80, v81
  ds_write_b64 v22, v[110:111] offset:6864
  v_cvt_pk_bf16_f32 v101, v82, v83
  v_pk_mul_f32 v[68:69], v[90:91], v[58:59]
  ds_write_b64 v22, v[100:101] offset:24288
  v_pk_mul_f32 v[70:71], v[88:89], v[58:59]
  v_pk_mul_f32 v[84:85], v[82:83], v[50:51]
  v_pk_fma_f32 v[88:89], v[88:89], v[56:57], v[68:69] neg_lo:[0,0,1] neg_hi:[0,0,1]
  v_pk_mul_f32 v[86:87], v[80:81], v[50:51]
  v_pk_fma_f32 v[90:91], v[90:91], v[56:57], v[70:71]
  v_pk_fma_f32 v[80:81], v[80:81], v[48:49], v[84:85]
  v_cvt_pk_bf16_f32 v104, v88, v89
  v_pk_fma_f32 v[82:83], v[82:83], v[48:49], v[86:87] neg_lo:[0,0,1] neg_hi:[0,0,1]
  v_cvt_pk_bf16_f32 v105, v90, v91
  v_cvt_pk_bf16_f32 v102, v80, v81
  ds_write_b64 v22, v[104:105] offset:7392
  v_cvt_pk_bf16_f32 v103, v82, v83
  v_pk_mul_f32 v[68:69], v[90:91], v[58:59]
  ds_write_b64 v22, v[102:103] offset:24816
  v_pk_mul_f32 v[70:71], v[88:89], v[58:59]
  v_pk_mul_f32 v[84:85], v[82:83], v[50:51]
  v_pk_fma_f32 v[88:89], v[88:89], v[56:57], v[68:69] neg_lo:[0,0,1] neg_hi:[0,0,1]
  v_pk_mul_f32 v[86:87], v[80:81], v[50:51]
  v_pk_fma_f32 v[90:91], v[90:91], v[56:57], v[70:71]
  buffer_load_dwordx2 v[222:223], v198, s[40:43], s76 offen offset:3840
  v_pk_fma_f32 v[80:81], v[80:81], v[48:49], v[84:85]
  v_pk_fma_f32 v[82:83], v[82:83], v[48:49], v[86:87] neg_lo:[0,0,1] neg_hi:[0,0,1]
  v_cvt_pk_bf16_f32 v106, v88, v89
  v_cvt_pk_bf16_f32 v96, v80, v81
  v_cvt_pk_bf16_f32 v107, v90, v91
  v_cvt_pk_bf16_f32 v97, v82, v83
  ds_write_b64 v22, v[106:107] offset:7920
  ds_write_b64 v22, v[96:97] offset:25344
  ds_write_b64 v22, v[106:107] offset:16368
  v_pk_mul_f32 v[84:85], v[82:83], v[50:51]
  v_pk_mul_f32 v[68:69], v[94:95], v[54:55]
  v_pk_mul_f32 v[86:87], v[80:81], v[50:51]
  v_pk_mul_f32 v[70:71], v[92:93], v[54:55]
  v_pk_fma_f32 v[80:81], v[80:81], v[48:49], v[84:85]
  v_pk_fma_f32 v[92:93], v[92:93], v[52:53], v[68:69] neg_lo:[0,0,1] neg_hi:[0,0,1]
  v_pk_fma_f32 v[82:83], v[82:83], v[48:49], v[86:87] neg_lo:[0,0,1] neg_hi:[0,0,1]
  v_pk_fma_f32 v[94:95], v[94:95], v[52:53], v[70:71]
  v_cvt_pk_bf16_f32 v98, v80, v81
  v_cvt_pk_bf16_f32 v108, v92, v93
  v_cvt_pk_bf16_f32 v99, v82, v83
  v_cvt_pk_bf16_f32 v109, v94, v95
  ds_write_b64 v22, v[98:99] offset:25872
  ds_write_b64 v22, v[108:109] offset:8448
  v_pk_mul_f32 v[84:85], v[82:83], v[50:51]
  v_pk_mul_f32 v[68:69], v[94:95], v[62:63]
  v_pk_mul_f32 v[86:87], v[80:81], v[50:51]
  v_pk_fma_f32 v[80:81], v[80:81], v[48:49], v[84:85]
  v_pk_mul_f32 v[70:71], v[92:93], v[62:63]
  v_pk_fma_f32 v[82:83], v[82:83], v[48:49], v[86:87] neg_lo:[0,0,1] neg_hi:[0,0,1]
  v_pk_fma_f32 v[88:89], v[92:93], v[60:61], v[68:69] neg_lo:[0,0,1] neg_hi:[0,0,1]
  v_cvt_pk_bf16_f32 v100, v80, v81
  v_pk_fma_f32 v[90:91], v[94:95], v[60:61], v[70:71]
  v_cvt_pk_bf16_f32 v101, v82, v83
  v_cvt_pk_bf16_f32 v110, v88, v89
  ds_write_b64 v22, v[100:101] offset:26400
  v_cvt_pk_bf16_f32 v111, v90, v91
  v_pk_mul_f32 v[84:85], v[82:83], v[50:51]
  ds_write_b64 v22, v[110:111] offset:8976
  v_pk_mul_f32 v[86:87], v[80:81], v[50:51]
  v_pk_mul_f32 v[68:69], v[94:95], v[50:51]
  v_pk_fma_f32 v[80:81], v[80:81], v[48:49], v[84:85]
  v_pk_mul_f32 v[70:71], v[92:93], v[50:51]
  v_pk_fma_f32 v[82:83], v[82:83], v[48:49], v[86:87] neg_lo:[0,0,1] neg_hi:[0,0,1]
  v_pk_fma_f32 v[88:89], v[92:93], v[48:49], v[68:69] neg_lo:[0,0,1] neg_hi:[0,0,1]
  v_cvt_pk_bf16_f32 v102, v80, v81
  v_pk_fma_f32 v[90:91], v[94:95], v[48:49], v[70:71]
  v_cvt_pk_bf16_f32 v103, v82, v83
  v_cvt_pk_bf16_f32 v104, v88, v89
  ds_write_b64 v22, v[102:103] offset:26928
  v_cvt_pk_bf16_f32 v105, v90, v91
  v_pk_mul_f32 v[84:85], v[82:83], v[50:51]
  ds_write_b64 v22, v[104:105] offset:9504
  v_pk_mul_f32 v[86:87], v[80:81], v[50:51]
  v_pk_fma_f32 v[80:81], v[80:81], v[48:49], v[84:85]
  v_pk_mul_f32 v[68:69], v[94:95], v[54:55]
  v_pk_fma_f32 v[82:83], v[82:83], v[48:49], v[86:87] neg_lo:[0,0,1] neg_hi:[0,0,1]
  v_pk_mul_f32 v[70:71], v[92:93], v[54:55]
  v_cvt_pk_bf16_f32 v96, v80, v81
  v_pk_fma_f32 v[92:93], v[92:93], v[52:53], v[68:69] neg_lo:[0,0,1] neg_hi:[0,0,1]
  v_cvt_pk_bf16_f32 v97, v82, v83
  v_pk_fma_f32 v[94:95], v[94:95], v[52:53], v[70:71]
  ds_write_b64 v22, v[96:97] offset:27456
  v_cvt_pk_bf16_f32 v106, v92, v93
  v_pk_mul_f32 v[84:85], v[82:83], v[50:51]
  v_cvt_pk_bf16_f32 v107, v94, v95
  v_pk_mul_f32 v[86:87], v[80:81], v[50:51]
  ds_write_b64 v22, v[106:107] offset:10560
  v_pk_fma_f32 v[80:81], v[80:81], v[48:49], v[84:85]
  v_pk_mul_f32 v[68:69], v[94:95], v[62:63]
  v_pk_fma_f32 v[82:83], v[82:83], v[48:49], v[86:87] neg_lo:[0,0,1] neg_hi:[0,0,1]
  v_pk_mul_f32 v[70:71], v[92:93], v[62:63]
  v_cvt_pk_bf16_f32 v98, v80, v81
  v_pk_fma_f32 v[88:89], v[92:93], v[60:61], v[68:69] neg_lo:[0,0,1] neg_hi:[0,0,1]
  v_cvt_pk_bf16_f32 v99, v82, v83
  v_pk_fma_f32 v[90:91], v[94:95], v[60:61], v[70:71]
  ds_write_b64 v22, v[98:99] offset:27984
  v_cvt_pk_bf16_f32 v108, v88, v89
  v_pk_mul_f32 v[84:85], v[82:83], v[50:51]
  v_cvt_pk_bf16_f32 v109, v90, v91
  v_pk_mul_f32 v[86:87], v[80:81], v[50:51]
  v_pk_fma_f32 v[80:81], v[80:81], v[48:49], v[84:85]
  ds_write_b64 v22, v[108:109] offset:11088
  v_pk_fma_f32 v[82:83], v[82:83], v[48:49], v[86:87] neg_lo:[0,0,1] neg_hi:[0,0,1]
  v_pk_mul_f32 v[68:69], v[94:95], v[50:51]
  v_cvt_pk_bf16_f32 v100, v80, v81
  v_pk_mul_f32 v[70:71], v[92:93], v[50:51]
  v_cvt_pk_bf16_f32 v101, v82, v83
  v_pk_fma_f32 v[88:89], v[92:93], v[48:49], v[68:69] neg_lo:[0,0,1] neg_hi:[0,0,1]
  ds_write_b64 v22, v[100:101] offset:28512
  v_pk_fma_f32 v[90:91], v[94:95], v[48:49], v[70:71]
  v_pk_mul_f32 v[84:85], v[82:83], v[50:51]
  v_cvt_pk_bf16_f32 v110, v88, v89
  v_pk_mul_f32 v[86:87], v[80:81], v[50:51]
  v_cvt_pk_bf16_f32 v111, v90, v91
  v_pk_fma_f32 v[80:81], v[80:81], v[48:49], v[84:85]
  ds_write_b64 v22, v[110:111] offset:11616
  v_pk_fma_f32 v[82:83], v[82:83], v[48:49], v[86:87] neg_lo:[0,0,1] neg_hi:[0,0,1]
  v_pk_mul_f32 v[68:69], v[94:95], v[54:55]
  v_cvt_pk_bf16_f32 v102, v80, v81
  v_pk_mul_f32 v[70:71], v[92:93], v[54:55]
  v_cvt_pk_bf16_f32 v103, v82, v83
  v_pk_fma_f32 v[92:93], v[92:93], v[52:53], v[68:69] neg_lo:[0,0,1] neg_hi:[0,0,1]
  ds_write_b64 v22, v[102:103] offset:29040
  v_pk_fma_f32 v[94:95], v[94:95], v[52:53], v[70:71]
  v_pk_mul_f32 v[84:85], v[82:83], v[50:51]
  v_cvt_pk_bf16_f32 v104, v92, v93
  v_pk_mul_f32 v[86:87], v[80:81], v[50:51]
  v_pk_fma_f32 v[80:81], v[80:81], v[48:49], v[84:85]
  v_cvt_pk_bf16_f32 v105, v94, v95
  v_pk_fma_f32 v[82:83], v[82:83], v[48:49], v[86:87] neg_lo:[0,0,1] neg_hi:[0,0,1]
  ds_write_b64 v22, v[104:105] offset:10032
  v_cvt_pk_bf16_f32 v96, v80, v81
  v_pk_mul_f32 v[68:69], v[94:95], v[50:51]
  v_cvt_pk_bf16_f32 v97, v82, v83
  v_pk_mul_f32 v[70:71], v[92:93], v[50:51]
  ds_write_b64 v22, v[96:97] offset:29568
  v_pk_fma_f32 v[88:89], v[92:93], v[48:49], v[68:69] neg_lo:[0,0,1] neg_hi:[0,0,1]
  v_pk_mul_f32 v[84:85], v[82:83], v[50:51]
  v_pk_fma_f32 v[90:91], v[94:95], v[48:49], v[70:71]
  v_pk_mul_f32 v[86:87], v[80:81], v[50:51]
  v_cvt_pk_bf16_f32 v106, v88, v89
  v_pk_fma_f32 v[80:81], v[80:81], v[48:49], v[84:85]
  v_cvt_pk_bf16_f32 v107, v90, v91
  v_pk_fma_f32 v[82:83], v[82:83], v[48:49], v[86:87] neg_lo:[0,0,1] neg_hi:[0,0,1]
  ds_write_b64 v22, v[106:107] offset:12672
  v_cvt_pk_bf16_f32 v98, v80, v81
  v_pk_mul_f32 v[68:69], v[94:95], v[54:55]
  v_cvt_pk_bf16_f32 v99, v82, v83
  v_pk_mul_f32 v[70:71], v[92:93], v[54:55]
  ds_write_b64 v22, v[98:99] offset:30096
  v_pk_fma_f32 v[92:93], v[92:93], v[52:53], v[68:69] neg_lo:[0,0,1] neg_hi:[0,0,1]
  v_pk_mul_f32 v[84:85], v[82:83], v[50:51]
  v_pk_mul_f32 v[86:87], v[80:81], v[50:51]
  v_pk_fma_f32 v[94:95], v[94:95], v[52:53], v[70:71]
  v_pk_fma_f32 v[80:81], v[80:81], v[48:49], v[84:85]
  v_cvt_pk_bf16_f32 v108, v92, v93
  v_pk_fma_f32 v[82:83], v[82:83], v[48:49], v[86:87] neg_lo:[0,0,1] neg_hi:[0,0,1]
  v_cvt_pk_bf16_f32 v109, v94, v95
  v_cvt_pk_bf16_f32 v100, v80, v81
  ds_write_b64 v22, v[108:109] offset:13200
  v_cvt_pk_bf16_f32 v101, v82, v83
  v_pk_mul_f32 v[68:69], v[94:95], v[50:51]
  ds_write_b64 v22, v[100:101] offset:30624
  v_pk_mul_f32 v[70:71], v[92:93], v[50:51]
  v_pk_mul_f32 v[84:85], v[82:83], v[50:51]
  v_pk_fma_f32 v[88:89], v[92:93], v[48:49], v[68:69] neg_lo:[0,0,1] neg_hi:[0,0,1]
  v_pk_mul_f32 v[86:87], v[80:81], v[50:51]
  v_pk_fma_f32 v[90:91], v[94:95], v[48:49], v[70:71]
  v_pk_fma_f32 v[80:81], v[80:81], v[48:49], v[84:85]
  v_cvt_pk_bf16_f32 v110, v88, v89
  v_pk_fma_f32 v[82:83], v[82:83], v[48:49], v[86:87] neg_lo:[0,0,1] neg_hi:[0,0,1]
  v_cvt_pk_bf16_f32 v111, v90, v91
  v_cvt_pk_bf16_f32 v102, v80, v81
  ds_write_b64 v22, v[110:111] offset:13728
  v_cvt_pk_bf16_f32 v103, v82, v83
  v_pk_mul_f32 v[68:69], v[94:95], v[54:55]
  ds_write_b64 v22, v[102:103] offset:31152
  v_pk_mul_f32 v[70:71], v[92:93], v[54:55]
  v_pk_mul_f32 v[84:85], v[82:83], v[50:51]
  v_pk_mul_f32 v[86:87], v[80:81], v[50:51]
  v_pk_fma_f32 v[92:93], v[92:93], v[52:53], v[68:69] neg_lo:[0,0,1] neg_hi:[0,0,1]
  v_pk_fma_f32 v[80:81], v[80:81], v[48:49], v[84:85]
  v_pk_fma_f32 v[94:95], v[94:95], v[52:53], v[70:71]
  v_pk_fma_f32 v[82:83], v[82:83], v[48:49], v[86:87] neg_lo:[0,0,1] neg_hi:[0,0,1]
  v_cvt_pk_bf16_f32 v104, v92, v93
  v_cvt_pk_bf16_f32 v96, v80, v81
  v_cvt_pk_bf16_f32 v105, v94, v95
  v_cvt_pk_bf16_f32 v97, v82, v83
  ds_write_b64 v22, v[104:105] offset:12144
  ds_write_b64 v22, v[96:97] offset:31680
  v_pk_mul_f32 v[68:69], v[94:95], v[50:51]
  v_pk_mul_f32 v[84:85], v[82:83], v[50:51]
  v_pk_mul_f32 v[70:71], v[92:93], v[50:51]
  v_pk_mul_f32 v[86:87], v[80:81], v[50:51]
  v_pk_fma_f32 v[88:89], v[92:93], v[48:49], v[68:69] neg_lo:[0,0,1] neg_hi:[0,0,1]
  v_pk_fma_f32 v[80:81], v[80:81], v[48:49], v[84:85]
  v_pk_fma_f32 v[90:91], v[94:95], v[48:49], v[70:71]
  v_pk_fma_f32 v[82:83], v[82:83], v[48:49], v[86:87] neg_lo:[0,0,1] neg_hi:[0,0,1]
  v_cvt_pk_bf16_f32 v106, v88, v89
  v_cvt_pk_bf16_f32 v98, v80, v81
  v_cvt_pk_bf16_f32 v107, v90, v91
  v_cvt_pk_bf16_f32 v99, v82, v83
  ds_write_b64 v22, v[106:107] offset:14784
  ds_write_b64 v22, v[98:99] offset:32208
  v_pk_mul_f32 v[68:69], v[94:95], v[54:55]
  v_pk_mul_f32 v[84:85], v[82:83], v[50:51]
  v_pk_mul_f32 v[86:87], v[80:81], v[50:51]
  v_pk_mul_f32 v[70:71], v[92:93], v[54:55]
  v_pk_fma_f32 v[80:81], v[80:81], v[48:49], v[84:85]
  v_pk_fma_f32 v[92:93], v[92:93], v[52:53], v[68:69] neg_lo:[0,0,1] neg_hi:[0,0,1]
  v_pk_fma_f32 v[82:83], v[82:83], v[48:49], v[86:87] neg_lo:[0,0,1] neg_hi:[0,0,1]
  v_pk_fma_f32 v[94:95], v[94:95], v[52:53], v[70:71]
  v_cvt_pk_bf16_f32 v100, v80, v81
  v_cvt_pk_bf16_f32 v108, v92, v93
  v_cvt_pk_bf16_f32 v101, v82, v83
  v_cvt_pk_bf16_f32 v109, v94, v95
  ds_write_b64 v22, v[100:101] offset:32736
  ds_write_b64 v22, v[108:109] offset:15312
  v_pk_mul_f32 v[84:85], v[82:83], v[50:51]
  v_pk_mul_f32 v[68:69], v[94:95], v[50:51]
  v_pk_mul_f32 v[86:87], v[80:81], v[50:51]
  v_pk_mul_f32 v[70:71], v[92:93], v[50:51]
  v_pk_fma_f32 v[80:81], v[80:81], v[48:49], v[84:85]
  v_pk_fma_f32 v[88:89], v[92:93], v[48:49], v[68:69] neg_lo:[0,0,1] neg_hi:[0,0,1]
  v_pk_fma_f32 v[82:83], v[82:83], v[48:49], v[86:87] neg_lo:[0,0,1] neg_hi:[0,0,1]
  v_pk_fma_f32 v[90:91], v[94:95], v[48:49], v[70:71]
  v_cvt_pk_bf16_f32 v102, v80, v81
  v_cvt_pk_bf16_f32 v110, v88, v89
  v_cvt_pk_bf16_f32 v103, v82, v83
  v_cvt_pk_bf16_f32 v111, v90, v91
  ds_write_b64 v22, v[102:103] offset:33264
  ds_write_b64 v22, v[110:111] offset:15840
  v_and_b32 v23, 31, v1
  v_mul_u32_u24 v23, 528, v23
  v_lshrrev_b32 v24, 5, v1
  v_lshl_add_u32 v23, v24, 4, v23
  v_add_u32 v23, s99, v23
  ds_read_b128 v[32:35], v23 offset:0
  ds_read_b128 v[36:39], v23 offset:16896
  ds_read_b128 v[40:43], v23 offset:32
  ds_read_b128 v[44:47], v23 offset:16928
  ds_read_b128 v[48:51], v23 offset:64
  ds_read_b128 v[52:55], v23 offset:16960
  ds_read_b128 v[56:59], v23 offset:96
  ds_read_b128 v[60:63], v23 offset:16992
  ds_read_b128 v[64:67], v23 offset:128
  ds_read_b128 v[68:71], v23 offset:17024
  ds_read_b128 v[72:75], v23 offset:160
  ds_read_b128 v[76:79], v23 offset:17056
  s_waitcnt lgkmcnt(10)
  v_mfma_f32_32x32x16_bf16 v[144:159], v[32:35], v[36:39], 0
  buffer_load_dwordx4 v[224:227], v199, s[36:39], s77 offen offset:0 sc1
  ds_read_b128 v[80:83], v23 offset:192
  ds_read_b128 v[84:87], v23 offset:17088
  v_lshrrev_b32 v4, 5, v1
  s_waitcnt lgkmcnt(10)
  v_mfma_f32_32x32x16_bf16 v[144:159], v[40:43], v[44:47], v[144:159]
  ds_read_b128 v[88:91], v23 offset:224
  ds_read_b128 v[92:95], v23 offset:17120
  v_lshl_add_u32 v8, v4, 4, v8
  s_waitcnt lgkmcnt(10)
  v_mfma_f32_32x32x16_bf16 v[144:159], v[48:51], v[52:55], v[144:159]
  ds_read_b128 v[96:99], v23 offset:256
  ds_read_b128 v[100:103], v23 offset:17152
  s_lshl_b32 s64, s61, 3
  s_waitcnt lgkmcnt(10)
  v_mfma_f32_32x32x16_bf16 v[144:159], v[56:59], v[60:63], v[144:159]
  ds_read_b128 v[104:107], v23 offset:288
  ds_read_b128 v[108:111], v23 offset:17184
  s_lshl_b32 s65, s57, 1
  s_waitcnt lgkmcnt(10)
  v_mfma_f32_32x32x16_bf16 v[144:159], v[64:67], v[68:71], v[144:159]
  ds_read_b128 v[112:115], v23 offset:320
  ds_read_b128 v[116:119], v23 offset:17216
  s_add_u32 s64, s64, s65
  s_waitcnt lgkmcnt(10)
  v_mfma_f32_32x32x16_bf16 v[144:159], v[72:75], v[76:79], v[144:159]
  ds_read_b128 v[120:123], v23 offset:352
  ds_read_b128 v[124:127], v23 offset:17248
  s_mul_i32 s68, s64, 55296
  s_waitcnt lgkmcnt(10)
  v_mfma_f32_32x32x16_bf16 v[144:159], v[80:83], v[84:87], v[144:159]
  ds_read_b128 v[32:35], v23 offset:384
  ds_read_b128 v[36:39], v23 offset:17280
  s_lshl_b32 s65, s7, 9
  s_waitcnt lgkmcnt(10)
  v_mfma_f32_32x32x16_bf16 v[144:159], v[88:91], v[92:95], v[144:159]
  ds_read_b128 v[40:43], v23 offset:416
  ds_read_b128 v[44:47], v23 offset:17312
  s_add_u32 s68, s68, s65
  s_waitcnt lgkmcnt(10)
  v_mfma_f32_32x32x16_bf16 v[144:159], v[96:99], v[100:103], v[144:159]
  buffer_load_dwordx4 v[228:231], v199, s[36:39], s77 offen offset:16 sc1
  ds_read_b128 v[48:51], v23 offset:448
  ds_read_b128 v[52:55], v23 offset:17344
  s_add_u32 s68, s68, 0x400000
  s_and_b32 s65, s62, 3
  s_waitcnt lgkmcnt(10)
  v_mfma_f32_32x32x16_bf16 v[144:159], v[104:107], v[108:111], v[144:159]
  ds_read_b128 v[56:59], v23 offset:480
  ds_read_b128 v[60:63], v23 offset:17376
  s_cmp_eq_u32 s65, 3
  s_waitcnt lgkmcnt(10)
  v_mfma_f32_32x32x16_bf16 v[144:159], v[112:115], v[116:119], v[144:159]
  s_cselect_b32 s66, 0x40000000, s68
  v_min_u32 v19, 39, v1
  s_waitcnt lgkmcnt(8)
  v_mfma_f32_32x32x16_bf16 v[144:159], v[120:123], v[124:127], v[144:159]
  v_lshlrev_b32 v19, 4, v19
  s_mov_b32 s24, 0x50000
  s_waitcnt lgkmcnt(6)
  v_mfma_f32_32x32x16_bf16 v[144:159], v[32:35], v[36:39], v[144:159]
  s_add_u32 s44, s34, 0xb00000
  s_addc_u32 s45, s35, 0
  s_waitcnt lgkmcnt(4)
  v_mfma_f32_32x32x16_bf16 v[144:159], v[40:43], v[44:47], v[144:159]
  s_mov_b32 s46, 0x230000
  s_mov_b32 s47, 0x00020000
  s_waitcnt lgkmcnt(2)
  v_mfma_f32_32x32x16_bf16 v[144:159], v[48:51], v[52:55], v[144:159]
  s_add_u32 s48, s34, 0x400000
  s_addc_u32 s49, s35, 0
  s_waitcnt lgkmcnt(0)
  v_mfma_f32_32x32x16_bf16 v[144:159], v[56:59], v[60:63], v[144:159]
  s_mov_b32 s50, 0x6c0000
  s_mov_b32 s51, 0x00020000
  s_barrier
  buffer_load_dwordx4 v[232:235], v199, s[36:39], s69 offen offset:0 sc1
  v_and_b32 v24, 31, v1
  v_lshrrev_b32 v25, 5, v1
  v_lshlrev_b32 v24, 4, v24
  v_sub_u32 v24, s74, v24
  v_lshlrev_b32 v26, 9, v25
  v_sub_u32 v27, v24, v26
  v_sub_u32 v28, v27, v26
  v_cmp_eq_u32 vcc, 0, v1
  v_lshlrev_b32 v26, 16, v203
  s_nop 0
  v_cndmask_b32 v26, 0, v26, vcc
  v_add_f32 v144, v144, v26
  v_and_b32 v26, 1, v1
  v_cmp_eq_u32 vcc, 1, v26
  v_cvt_pk_bf16_f32 v32, v151, v150
  v_cvt_pk_bf16_f32 v33, v149, v148
  v_cvt_pk_bf16_f32 v34, v147, v146
  v_cvt_pk_bf16_f32 v35, v145, v144
  ds_write_b128 v27, v[32:35] offset:4080
  v_cvt_pk_bf16_f32 v36, v159, v151
  v_cvt_pk_bf16_f32 v37, v150, v149
  v_cvt_pk_bf16_f32 v38, v148, v147
  v_cvt_pk_bf16_f32 v39, v146, v145
  ds_write_b128 v27, v[36:39] offset:8240
  v_cvt_pk_bf16_f32 v40, v154, v154
  v_cvt_pk_bf16_f32 v41, v153, v153
  v_cvt_pk_bf16_f32 v42, v153, v152
  v_cvt_pk_bf16_f32 v43, v152, v152
  ds_write_b128 v27, v[40:43] offset:3056
  v_mov_b32 v44, v40
  v_cvt_pk_bf16_f32 v45, v154, v153
  v_mov_b32 v46, v41
  v_mov_b32 v47, v43
  ds_write_b128 v27, v[44:47] offset:7216
  v_cndmask_b32 v56, v155, v156, vcc
  v_cvt_pk_bf16_f32 v48, v156, v156
  v_cvt_pk_bf16_f32 v49, v156, v56
  v_cvt_pk_bf16_f32 v50, v155, v155
  v_mov_b32 v51, v50
  ds_write_b128 v28, v[48:51] offset:2032
  v_mov_b32 v52, v48
  buffer_load_dwordx4 v[236:239], v199, s[36:39], s69 offen offset:16 sc1
  v_mov_b32 v53, v48
  v_cvt_pk_bf16_f32 v54, v56, v155
  v_mov_b32 v55, v50
  ds_write_b128 v28, v[52:55] offset:6192
  v_cndmask_b32 v68, v157, v158, vcc
  v_cvt_pk_bf16_f32 v60, v158, v158
  v_cvt_pk_bf16_f32 v61, v158, v68
  v_cvt_pk_bf16_f32 v62, v157, v157
  v_mov_b32 v63, v62
  ds_write_b128 v28, v[60:63] offset:1520
  v_mov_b32 v64, v60
  v_mov_b32 v65, v60
  v_cvt_pk_bf16_f32 v66, v68, v157
  v_mov_b32 v67, v62
  ds_write_b128 v28, v[64:67] offset:5680
  v_mov_b32 v72, 0
  v_mov_b32 v73, 0
  v_lshl_add_u32 v74, v1, 3, s67
  ds_write_b64 v74, v[72:73]
  v_cvt_pk_bf16_f32 v75, v144, v72
  v_cmp_eq_u32 vcc, 0, v1
  v_lshl_add_u32 v74, v1, 2, s74
  s_nop 0
  v_cndmask_b32 v75, v72, v75, vcc
  s_mov_b64 exec, 0xffff
  ds_write_b32 v74, v72 offset:4096
  ds_write_b32 v74, v75 offset:8256
  s_mov_b64 exec, -1
  s_waitcnt vmcnt(11)
  v_lshlrev_b32 v76, 16, v208
  v_and_b32 v77, 0xffff0000, v208
  v_lshlrev_b32 v78, 16, v209
  v_and_b32 v79, 0xffff0000, v209
  s_waitcnt vmcnt(10)
  v_lshlrev_b32 v80, 16, v210
  v_and_b32 v81, 0xffff0000, v210
  v_lshlrev_b32 v82, 16, v211
  v_and_b32 v83, 0xffff0000, v211
  v_perm_b32 v240, v210, v208, s20
  v_perm_b32 v242, v210, v208, s21
  v_perm_b32 v244, v211, v209, s20
  v_perm_b32 v246, v211, v209, s21
  s_waitcnt vmcnt(9)
  v_lshlrev_b32 v84, 16, v212
  v_and_b32 v85, 0xffff0000, v212
  v_lshlrev_b32 v86, 16, v213
  v_and_b32 v87, 0xffff0000, v213
  s_waitcnt vmcnt(8)
  v_lshlrev_b32 v88, 16, v214
  v_and_b32 v89, 0xffff0000, v214
  v_lshlrev_b32 v90, 16, v215
  v_and_b32 v91, 0xffff0000, v215
  v_perm_b32 v241, v214, v212, s20
  ds_write_b64 v201, v[240:241] offset:0
  v_perm_b32 v243, v214, v212, s21
  ds_write_b64 v201, v[242:243] offset:4112
  v_perm_b32 v245, v215, v213, s20
  ds_write_b64 v201, v[244:245] offset:8224
  v_perm_b32 v247, v215, v213, s21
  ds_write_b64 v201, v[246:247] offset:12336
  s_waitcnt vmcnt(7)
  v_lshlrev_b32 v92, 16, v216
  v_and_b32 v93, 0xffff0000, v216
  v_lshlrev_b32 v94, 16, v217
  v_and_b32 v95, 0xffff0000, v217
  s_waitcnt vmcnt(6)
  v_lshlrev_b32 v96, 16, v218
  v_and_b32 v97, 0xffff0000, v218
  v_lshlrev_b32 v98, 16, v219
  v_and_b32 v99, 0xffff0000, v219
  v_perm_b32 v248, v218, v216, s20
  v_perm_b32 v250, v218, v216, s21
  v_perm_b32 v252, v219, v217, s20
  v_perm_b32 v254, v219, v217, s21
  s_waitcnt vmcnt(5)
  v_lshlrev_b32 v100, 16, v220
  v_and_b32 v101, 0xffff0000, v220
  v_lshlrev_b32 v102, 16, v221
  v_and_b32 v103, 0xffff0000, v221
  s_waitcnt vmcnt(4)
  v_lshlrev_b32 v104, 16, v222
  v_and_b32 v105, 0xffff0000, v222
  v_lshlrev_b32 v106, 16, v223
  v_and_b32 v107, 0xffff0000, v223
  v_perm_b32 v249, v222, v220, s20
  ds_write_b64 v201, v[248:249] offset:2048
  v_perm_b32 v251, v222, v220, s21
  ds_write_b64 v201, v[250:251] offset:6160
  v_perm_b32 v253, v223, v221, s20
  ds_write_b64 v201, v[252:253] offset:10272
  v_perm_b32 v255, v223, v221, s21
  ds_write_b64 v201, v[254:255] offset:14384
  s_waitcnt vmcnt(3)
  v_cmp_ne_u32 vcc, s56, v225
  v_cmp_ne_u32 s[22:23], s56, v227
  s_waitcnt vmcnt(2)
  v_cmp_ne_u32 s[26:27], s56, v229
  s_or_b64 vcc, vcc, s[22:23]
  v_cmp_ne_u32 s[22:23], s56, v231
  s_or_b64 vcc, vcc, s[26:27]
  s_waitcnt vmcnt(1)
  v_cmp_ne_u32 s[26:27], s56, v233
  s_or_b64 vcc, vcc, s[22:23]
  v_cmp_ne_u32 s[22:23], s56, v235
  s_or_b64 vcc, vcc, s[26:27]
  s_waitcnt vmcnt(0)
  v_cmp_ne_u32 s[26:27], s56, v237
  s_or_b64 vcc, vcc, s[22:23]
  v_cmp_ne_u32 s[22:23], s56, v239
  s_or_b64 vcc, vcc, s[26:27]
  s_or_b64 vcc, vcc, s[22:23]
  s_cbranch_vccnz sequential_preLN__ssm_conv_s4__geglu_ffn__prompt_kernel_st1
sequential_preLN__ssm_conv_s4__geglu_ffn__prompt_kernel_st1_b:
  v_and_b32 v225, 0xffff0000, v224
  v_and_b32 v227, 0xffff0000, v226
  v_and_b32 v229, 0xffff0000, v228
  v_and_b32 v231, 0xffff0000, v230
  v_rcp_f32 v225, v225
  v_lshlrev_b32 v224, 16, v224
  v_rcp_f32 v227, v227
  v_lshlrev_b32 v226, 16, v226
  v_rcp_f32 v229, v229
  v_lshlrev_b32 v228, 16, v228
  v_rcp_f32 v231, v231
  v_lshlrev_b32 v230, 16, v230
  v_mul_f32 v224, v224, v225
  v_mul_f32 v226, v226, v227
  v_mul_f32 v228, v228, v229
  v_mul_f32 v230, v230, v231
  v_pk_fma_f32 v[76:77], v[76:77], v[224:225], v[224:225] op_sel:[0,1,0] op_sel_hi:[1,1,0] neg_lo:[0,0,1] neg_hi:[0,0,1]
  v_pk_fma_f32 v[78:79], v[78:79], v[224:225], v[224:225] op_sel:[0,1,0] op_sel_hi:[1,1,0] neg_lo:[0,0,1] neg_hi:[0,0,1]
  v_pk_fma_f32 v[80:81], v[80:81], v[226:227], v[226:227] op_sel:[0,1,0] op_sel_hi:[1,1,0] neg_lo:[0,0,1] neg_hi:[0,0,1]
  v_pk_fma_f32 v[82:83], v[82:83], v[226:227], v[226:227] op_sel:[0,1,0] op_sel_hi:[1,1,0] neg_lo:[0,0,1] neg_hi:[0,0,1]
  v_pk_fma_f32 v[84:85], v[84:85], v[228:229], v[228:229] op_sel:[0,1,0] op_sel_hi:[1,1,0] neg_lo:[0,0,1] neg_hi:[0,0,1]
  v_pk_fma_f32 v[86:87], v[86:87], v[228:229], v[228:229] op_sel:[0,1,0] op_sel_hi:[1,1,0] neg_lo:[0,0,1] neg_hi:[0,0,1]
  v_pk_fma_f32 v[88:89], v[88:89], v[230:231], v[230:231] op_sel:[0,1,0] op_sel_hi:[1,1,0] neg_lo:[0,0,1] neg_hi:[0,0,1]
  v_pk_fma_f32 v[90:91], v[90:91], v[230:231], v[230:231] op_sel:[0,1,0] op_sel_hi:[1,1,0] neg_lo:[0,0,1] neg_hi:[0,0,1]
  v_cvt_pk_bf16_f32 v108, v76, v80
  v_cvt_pk_bf16_f32 v110, v77, v81
  v_cvt_pk_bf16_f32 v112, v78, v82
  v_cvt_pk_bf16_f32 v114, v79, v83
  v_cvt_pk_bf16_f32 v109, v84, v88
  ds_write_b64 v200, v[108:109] offset:0
  v_cvt_pk_bf16_f32 v111, v85, v89
  ds_write_b64 v200, v[110:111] offset:4608
  v_cvt_pk_bf16_f32 v113, v86, v90
  ds_write_b64 v200, v[112:113] offset:9216
  v_cvt_pk_bf16_f32 v115, v87, v91
  ds_write_b64 v200, v[114:115] offset:13824
  v_and_b32 v233, 0xffff0000, v232
  v_and_b32 v235, 0xffff0000, v234
  v_and_b32 v237, 0xffff0000, v236
  v_and_b32 v239, 0xffff0000, v238
  v_rcp_f32 v233, v233
  v_lshlrev_b32 v232, 16, v232
  v_rcp_f32 v235, v235
  v_lshlrev_b32 v234, 16, v234
  v_rcp_f32 v237, v237
  v_lshlrev_b32 v236, 16, v236
  v_rcp_f32 v239, v239
  v_lshlrev_b32 v238, 16, v238
  v_mul_f32 v232, v232, v233
  v_mul_f32 v234, v234, v235
  v_mul_f32 v236, v236, v237
  v_mul_f32 v238, v238, v239
  v_pk_fma_f32 v[92:93], v[92:93], v[232:233], v[232:233] op_sel:[0,1,0] op_sel_hi:[1,1,0] neg_lo:[0,0,1] neg_hi:[0,0,1]
  v_pk_fma_f32 v[94:95], v[94:95], v[232:233], v[232:233] op_sel:[0,1,0] op_sel_hi:[1,1,0] neg_lo:[0,0,1] neg_hi:[0,0,1]
  v_pk_fma_f32 v[96:97], v[96:97], v[234:235], v[234:235] op_sel:[0,1,0] op_sel_hi:[1,1,0] neg_lo:[0,0,1] neg_hi:[0,0,1]
  v_pk_fma_f32 v[98:99], v[98:99], v[234:235], v[234:235] op_sel:[0,1,0] op_sel_hi:[1,1,0] neg_lo:[0,0,1] neg_hi:[0,0,1]
  v_pk_fma_f32 v[100:101], v[100:101], v[236:237], v[236:237] op_sel:[0,1,0] op_sel_hi:[1,1,0] neg_lo:[0,0,1] neg_hi:[0,0,1]
  v_pk_fma_f32 v[102:103], v[102:103], v[236:237], v[236:237] op_sel:[0,1,0] op_sel_hi:[1,1,0] neg_lo:[0,0,1] neg_hi:[0,0,1]
  v_pk_fma_f32 v[104:105], v[104:105], v[238:239], v[238:239] op_sel:[0,1,0] op_sel_hi:[1,1,0] neg_lo:[0,0,1] neg_hi:[0,0,1]
  v_pk_fma_f32 v[106:107], v[106:107], v[238:239], v[238:239] op_sel:[0,1,0] op_sel_hi:[1,1,0] neg_lo:[0,0,1] neg_hi:[0,0,1]
  v_cvt_pk_bf16_f32 v116, v92, v96
  v_cvt_pk_bf16_f32 v118, v93, v97
  v_cvt_pk_bf16_f32 v120, v94, v98
  v_cvt_pk_bf16_f32 v122, v95, v99
  v_cvt_pk_bf16_f32 v117, v100, v104
  ds_write_b64 v200, v[116:117] offset:2048
  v_cvt_pk_bf16_f32 v119, v101, v105
  ds_write_b64 v200, v[118:119] offset:6656
  v_cvt_pk_bf16_f32 v121, v102, v106
  ds_write_b64 v200, v[120:121] offset:11264
  v_cvt_pk_bf16_f32 v123, v103, v107
  ds_write_b64 v200, v[122:123] offset:15872
  s_waitcnt lgkmcnt(0)
  s_barrier
  ds_read2_b32 v[32:33], v188 offset0:240 offset1:241
  ds_read2_b32 v[34:35], v188 offset0:242 offset1:243
  ds_read_b128 a[252:255], v196 offset:4064
  ds_read2_b32 v[64:65], v188 offset0:112 offset1:113
  ds_read2_b32 v[66:67], v188 offset0:114 offset1:115
  ds_read_b128 a[220:223], v196 offset:3552
  ds_read_b128 a[188:191], v196 offset:3040
  ds_read_b128 a[156:159], v196 offset:2528
  ds_read_b128 a[124:127], v196 offset:2016
  ds_read_b128 a[92:95], v196 offset:1504
  ds_read_b128 a[60:63], v196 offset:992
  ds_read_b128 a[28:31], v196 offset:480
  s_waitcnt lgkmcnt(9)
  v_mfma_f32_16x16x32_bf16 v[156:159], v[32:35], a[252:255], 0
  ds_read2_b32 v[36:37], v188 offset0:224 offset1:225
  s_waitcnt lgkmcnt(7)
  v_mfma_f32_16x16x32_bf16 v[156:159], v[64:67], a[220:223], v[156:159]
  ds_read2_b32 v[38:39], v188 offset0:226 offset1:227
  v_mfma_f32_16x16x32_bf16 v[152:155], v[32:35], a[220:223], 0
  ds_read_b128 a[24:27], v196 offset:416
  s_waitcnt lgkmcnt(8)
  v_mfma_f32_16x16x32_bf16 v[152:155], v[64:67], a[188:191], v[152:155]
  ds_read2_b32 v[68:69], v188 offset0:96 offset1:97
  v_mfma_f32_16x16x32_bf16 v[148:151], v[32:35], a[188:191], 0
  ds_read2_b32 v[70:71], v188 offset0:98 offset1:99
  s_waitcnt lgkmcnt(8)
  v_mfma_f32_16x16x32_bf16 v[148:151], v[64:67], a[156:159], v[148:151]
  ds_read_b128 a[56:59], v196 offset:928
  v_mfma_f32_16x16x32_bf16 v[144:147], v[32:35], a[156:159], 0
  ds_read_b128 a[88:91], v196 offset:1440
  v_mfma_f32_16x16x32_bf16 v[144:147], v[64:67], a[124:127], v[144:147]
  ds_read_b128 a[120:123], v196 offset:1952
  v_mfma_f32_16x16x32_bf16 v[140:143], v[32:35], a[124:127], 0
  ds_read_b128 a[152:155], v196 offset:2464
  s_waitcnt lgkmcnt(7)
  v_mfma_f32_16x16x32_bf16 v[140:143], v[64:67], a[92:95], v[140:143]
  ds_read_b128 a[184:187], v196 offset:2976
  v_mfma_f32_16x16x32_bf16 v[136:139], v[32:35], a[92:95], 0
  v_mfma_f32_16x16x32_bf16 v[136:139], v[64:67], a[60:63], v[136:139]
  ds_read_b128 a[216:219], v196 offset:3488
  v_mfma_f32_16x16x32_bf16 v[132:135], v[32:35], a[60:63], 0
  v_mfma_f32_16x16x32_bf16 v[132:135], v[64:67], a[28:31], v[132:135]
  ds_read_b128 a[248:251], v196 offset:4000
  v_mfma_f32_16x16x32_bf16 v[128:131], v[32:35], a[28:31], 0
  ds_read2_b32 v[40:41], v188 offset0:208 offset1:209
  s_waitcnt lgkmcnt(7)
  v_mfma_f32_16x16x32_bf16 v[128:131], v[36:39], a[24:27], v[128:131]
  ds_read2_b32 v[42:43], v188 offset0:210 offset1:211
  v_mfma_f32_16x16x32_bf16 v[132:135], v[68:71], a[24:27], v[132:135]
  ds_read_b128 a[244:247], v196 offset:3936
  v_mfma_f32_16x16x32_bf16 v[132:135], v[36:39], a[56:59], v[132:135]
  ds_read2_b32 v[72:73], v188 offset0:80 offset1:81
  v_mfma_f32_16x16x32_bf16 v[136:139], v[68:71], a[56:59], v[136:139]
  ds_read2_b32 v[74:75], v188 offset0:82 offset1:83
  s_waitcnt lgkmcnt(7)
  v_mfma_f32_16x16x32_bf16 v[136:139], v[36:39], a[88:91], v[136:139]
  ds_read_b128 a[212:215], v196 offset:3424
  v_mfma_f32_16x16x32_bf16 v[140:143], v[68:71], a[88:91], v[140:143]
  ds_read_b128 a[180:183], v196 offset:2912
  v_mfma_f32_16x16x32_bf16 v[140:143], v[36:39], a[120:123], v[140:143]
  ds_read_b128 a[148:151], v196 offset:2400
  v_mfma_f32_16x16x32_bf16 v[144:147], v[68:71], a[120:123], v[144:147]
  ds_read_b128 a[116:119], v196 offset:1888
  v_mfma_f32_16x16x32_bf16 v[144:147], v[36:39], a[152:155], v[144:147]
  ds_read_b128 a[84:87], v196 offset:1376
  v_mfma_f32_16x16x32_bf16 v[148:151], v[68:71], a[152:155], v[148:151]
  v_mfma_f32_16x16x32_bf16 v[148:151], v[36:39], a[184:187], v[148:151]
  ds_read_b128 a[52:55], v196 offset:864
  v_mfma_f32_16x16x32_bf16 v[152:155], v[68:71], a[184:187], v[152:155]
  s_waitcnt lgkmcnt(7)
  v_mfma_f32_16x16x32_bf16 v[152:155], v[36:39], a[216:219], v[152:155]
  ds_read_b128 a[20:23], v196 offset:352
  v_mfma_f32_16x16x32_bf16 v[156:159], v[68:71], a[216:219], v[156:159]
  v_mfma_f32_16x16x32_bf16 v[156:159], v[36:39], a[248:251], v[156:159]
  ds_read2_b32 v[44:45], v188 offset0:192 offset1:193
  v_mfma_f32_16x16x32_bf16 v[156:159], v[40:43], a[244:247], v[156:159]
  ds_read2_b32 v[46:47], v188 offset0:194 offset1:195
  s_waitcnt lgkmcnt(6)
  v_mfma_f32_16x16x32_bf16 v[156:159], v[72:75], a[212:215], v[156:159]
  ds_read_b128 a[16:19], v196 offset:288
  v_mfma_f32_16x16x32_bf16 v[152:155], v[40:43], a[212:215], v[152:155]
  ds_read2_b32 v[76:77], v188 offset0:64 offset1:65
  v_mfma_f32_16x16x32_bf16 v[152:155], v[72:75], a[180:183], v[152:155]
  ds_read2_b32 v[78:79], v188 offset0:66 offset1:67
  v_mfma_f32_16x16x32_bf16 v[148:151], v[40:43], a[180:183], v[148:151]
  ds_read_b128 a[48:51], v196 offset:800
  v_mfma_f32_16x16x32_bf16 v[148:151], v[72:75], a[148:151], v[148:151]
  ds_read_b128 a[80:83], v196 offset:1312
  v_mfma_f32_16x16x32_bf16 v[144:147], v[40:43], a[148:151], v[144:147]
  ds_read_b128 a[112:115], v196 offset:1824
  s_waitcnt lgkmcnt(8)
  v_mfma_f32_16x16x32_bf16 v[144:147], v[72:75], a[116:119], v[144:147]
  ds_read_b128 a[144:147], v196 offset:2336
  v_mfma_f32_16x16x32_bf16 v[140:143], v[40:43], a[116:119], v[140:143]
  v_mfma_f32_16x16x32_bf16 v[140:143], v[72:75], a[84:87], v[140:143]
  ds_read_b128 a[176:179], v196 offset:2848
  v_mfma_f32_16x16x32_bf16 v[136:139], v[40:43], a[84:87], v[136:139]
  v_mfma_f32_16x16x32_bf16 v[136:139], v[72:75], a[52:55], v[136:139]
  buffer_load_dword v14, v12, s[36:39], s18 offen offset:0 sc1
  ds_read_b128 a[208:211], v196 offset:3360
  v_mfma_f32_16x16x32_bf16 v[132:135], v[40:43], a[52:55], v[132:135]
  v_mfma_f32_16x16x32_bf16 v[132:135], v[72:75], a[20:23], v[132:135]
  ds_read_b128 a[240:243], v196 offset:3872
  v_mfma_f32_16x16x32_bf16 v[128:131], v[40:43], a[20:23], v[128:131]
  ds_read2_b32 v[48:49], v188 offset0:176 offset1:177
  s_waitcnt lgkmcnt(6)
  v_mfma_f32_16x16x32_bf16 v[128:131], v[44:47], a[16:19], v[128:131]
  ds_read2_b32 v[50:51], v188 offset0:178 offset1:179
  v_mfma_f32_16x16x32_bf16 v[132:135], v[76:79], a[16:19], v[132:135]
  ds_read_b128 a[236:239], v196 offset:3808
  v_mfma_f32_16x16x32_bf16 v[132:135], v[44:47], a[48:51], v[132:135]
  ds_read2_b32 v[80:81], v188 offset0:48 offset1:49
  v_mfma_f32_16x16x32_bf16 v[136:139], v[76:79], a[48:51], v[136:139]
  ds_read2_b32 v[82:83], v188 offset0:50 offset1:51
  v_mfma_f32_16x16x32_bf16 v[136:139], v[44:47], a[80:83], v[136:139]
  ds_read_b128 a[204:207], v196 offset:3296
  v_mfma_f32_16x16x32_bf16 v[140:143], v[76:79], a[80:83], v[140:143]
  ds_read_b128 a[172:175], v196 offset:2784
  s_waitcnt lgkmcnt(8)
  v_mfma_f32_16x16x32_bf16 v[140:143], v[44:47], a[112:115], v[140:143]
  ds_read_b128 a[140:143], v196 offset:2272
  v_mfma_f32_16x16x32_bf16 v[144:147], v[76:79], a[112:115], v[144:147]
  ds_read_b128 a[108:111], v196 offset:1760
  v_mfma_f32_16x16x32_bf16 v[144:147], v[44:47], a[144:147], v[144:147]
  ds_read_b128 a[76:79], v196 offset:1248
  v_mfma_f32_16x16x32_bf16 v[148:151], v[76:79], a[144:147], v[148:151]
  v_mfma_f32_16x16x32_bf16 v[148:151], v[44:47], a[176:179], v[148:151]
  ds_read_b128 a[44:47], v196 offset:736
  v_mfma_f32_16x16x32_bf16 v[152:155], v[76:79], a[176:179], v[152:155]
  v_mfma_f32_16x16x32_bf16 v[152:155], v[44:47], a[208:211], v[152:155]
  ds_read_b128 a[12:15], v196 offset:224
  v_mfma_f32_16x16x32_bf16 v[156:159], v[76:79], a[208:211], v[156:159]
  s_waitcnt lgkmcnt(6)
  v_mfma_f32_16x16x32_bf16 v[156:159], v[44:47], a[240:243], v[156:159]
  ds_read2_b32 v[52:53], v188 offset0:160 offset1:161
  v_mfma_f32_16x16x32_bf16 v[156:159], v[48:51], a[236:239], v[156:159]
  ds_read2_b32 v[54:55], v188 offset0:162 offset1:163
  v_mfma_f32_16x16x32_bf16 v[156:159], v[80:83], a[204:207], v[156:159]
  ds_read_b128 a[8:11], v196 offset:160
  v_mfma_f32_16x16x32_bf16 v[152:155], v[48:51], a[204:207], v[152:155]
  ds_read2_b32 v[84:85], v188 offset0:32 offset1:33
  s_waitcnt lgkmcnt(6)
  v_mfma_f32_16x16x32_bf16 v[152:155], v[80:83], a[172:175], v[152:155]
  ds_read2_b32 v[86:87], v188 offset0:34 offset1:35
  v_mfma_f32_16x16x32_bf16 v[148:151], v[48:51], a[172:175], v[148:151]
  ds_read_b128 a[40:43], v196 offset:672
  v_mfma_f32_16x16x32_bf16 v[148:151], v[80:83], a[140:143], v[148:151]
  ds_read_b64 v[174:175], v192 offset:3584
  ds_read_b128 a[72:75], v196 offset:1184
  v_mfma_f32_16x16x32_bf16 v[144:147], v[48:51], a[140:143], v[144:147]
  ds_read_b128 a[104:107], v196 offset:1696
  v_mfma_f32_16x16x32_bf16 v[144:147], v[80:83], a[108:111], v[144:147]
  ds_read_b64 v[160:161], v192 offset:0
  ds_read_b128 a[136:139], v196 offset:2208
  v_mfma_f32_16x16x32_bf16 v[140:143], v[48:51], a[108:111], v[140:143]
  v_mfma_f32_16x16x32_bf16 v[140:143], v[80:83], a[76:79], v[140:143]
  ds_read_b64 v[162:163], v192 offset:512
  ds_read_b128 a[168:171], v196 offset:2720
  v_mfma_f32_16x16x32_bf16 v[136:139], v[48:51], a[76:79], v[136:139]
  s_waitcnt vmcnt(0)
  v_cmp_ne_u32 vcc, s56, v14
  s_mov_b32 s26, 0
  s_cbranch_vccz sequential_preLN__ssm_conv_s4__geglu_ffn__prompt_kernel_fw3_ok
sequential_preLN__ssm_conv_s4__geglu_ffn__prompt_kernel_fw3:
  buffer_load_dword v14, v12, s[36:39], s18 offen offset:0 sc1
  s_add_u32 s26, s26, 1
  s_waitcnt vmcnt(0)
  v_cmp_ne_u32 vcc, s56, v14
  s_cmp_gt_u32 s26, 0x40000
  s_cbranch_scc1 sequential_preLN__ssm_conv_s4__geglu_ffn__prompt_kernel_fw3_ok
  s_cbranch_vccnz sequential_preLN__ssm_conv_s4__geglu_ffn__prompt_kernel_fw3
sequential_preLN__ssm_conv_s4__geglu_ffn__prompt_kernel_fw3_ok:
  s_waitcnt lgkmcnt(2)
  v_mfma_f32_16x16x32_bf16 v[136:139], v[80:83], a[44:47], v[136:139]
  ds_read_b64 v[164:165], v192 offset:1024
  s_add_u32 s27, s63, 0
  s_add_u32 m0, s6, 0
  s_nop 0
  buffer_load_dwordx4 v3, s[36:39], s27 offen offset:0 sc1 lds
  ds_read_b128 a[200:203], v196 offset:3232
  v_mfma_f32_16x16x32_bf16 v[132:135], v[48:51], a[44:47], v[132:135]
  v_mfma_f32_16x16x32_bf16 v[132:135], v[80:83], a[12:15], v[132:135]
  ds_read_b64 v[166:167], v192 offset:1536
  ds_read_b128 a[232:235], v196 offset:3744
  v_mfma_f32_16x16x32_bf16 v[128:131], v[48:51], a[12:15], v[128:131]
  ds_read2_b32 v[56:57], v188 offset0:144 offset1:145
  v_mfma_f32_16x16x32_bf16 v[128:131], v[52:55], a[8:11], v[128:131]
  ds_read_b64 v[168:169], v192 offset:2048
  buffer_load_dwordx4 v3, s[36:39], s27 offen offset:1024 sc1 lds
  ds_read2_b32 v[58:59], v188 offset0:146 offset1:147
  v_mfma_f32_16x16x32_bf16 v[132:135], v[84:87], a[8:11], v[132:135]
  ds_read_b128 a[228:231], v196 offset:3680
  v_mfma_f32_16x16x32_bf16 v[132:135], v[52:55], a[40:43], v[132:135]
  ds_read_b64 v[170:171], v192 offset:2560
  ds_read2_b32 v[88:89], v188 offset0:16 offset1:17
  v_mfma_f32_16x16x32_bf16 v[136:139], v[84:87], a[40:43], v[136:139]
  ds_read2_b32 v[90:91], v188 offset0:18 offset1:19
  v_mfma_f32_16x16x32_bf16 v[136:139], v[52:55], a[72:75], v[136:139]
  ds_read_b64 v[172:173], v192 offset:3072
  buffer_load_dwordx4 v3, s[36:39], s27 offen offset:2048 sc1 lds
  ds_read_b128 a[196:199], v196 offset:3168
  v_mfma_f32_16x16x32_bf16 v[140:143], v[84:87], a[72:75], v[140:143]
  ds_read_b128 a[164:167], v196 offset:2656
  v_mfma_f32_16x16x32_bf16 v[140:143], v[52:55], a[104:107], v[140:143]
  ds_read_b128 a[132:135], v196 offset:2144
  v_mfma_f32_16x16x32_bf16 v[144:147], v[84:87], a[104:107], v[144:147]
  ds_read_b128 a[100:103], v196 offset:1632
  v_mfma_f32_16x16x32_bf16 v[144:147], v[52:55], a[136:139], v[144:147]
  buffer_load_dwordx4 v[24:27], v19, s[36:39], s24 offen sc1
  ds_read_b128 a[68:71], v196 offset:1120
  v_mfma_f32_16x16x32_bf16 v[148:151], v[84:87], a[136:139], v[148:151]
  s_waitcnt lgkmcnt(7)
  v_mfma_f32_16x16x32_bf16 v[148:151], v[52:55], a[168:171], v[148:151]
  buffer_load_dwordx4 v3, s[36:39], s27 offen offset:3072 sc1 lds
  ds_read_b128 a[36:39], v196 offset:608
  v_mfma_f32_16x16x32_bf16 v[152:155], v[84:87], a[168:171], v[152:155]
  v_mfma_f32_16x16x32_bf16 v[152:155], v[52:55], a[200:203], v[152:155]
  s_add_u32 s27, s63, 16384
  s_add_u32 m0, s6, 16384
  s_nop 0
  buffer_load_dwordx4 v3, s[36:39], s27 offen offset:0 sc1 lds
  ds_read_b128 a[4:7], v196 offset:96
  v_mfma_f32_16x16x32_bf16 v[156:159], v[84:87], a[200:203], v[156:159]
  v_mfma_f32_16x16x32_bf16 v[156:159], v[52:55], a[232:235], v[156:159]
  ds_read2_b32 v[60:61], v188 offset0:128 offset1:129
  v_mfma_f32_16x16x32_bf16 v[156:159], v[56:59], a[228:231], v[156:159]
  v_lshlrev_b32 v180, 16, v174
  v_and_b32 v181, 0xffff0000, v174
  ds_read2_b32 v[62:63], v188 offset0:130 offset1:131
  s_waitcnt lgkmcnt(4)
  v_mfma_f32_16x16x32_bf16 v[156:159], v[88:91], a[196:199], v[156:159]
  ds_read_b128 a[0:3], v196 offset:32
  v_mfma_f32_16x16x32_bf16 v[152:155], v[56:59], a[196:199], v[152:155]
  v_lshlrev_b32 v182, 16, v175
  v_and_b32 v183, 0xffff0000, v175
  ds_read2_b32 v[92:93], v188 offset0:0 offset1:1
  v_mfma_f32_16x16x32_bf16 v[152:155], v[88:91], a[164:167], v[152:155]
  buffer_load_dwordx4 v3, s[36:39], s27 offen offset:1024 sc1 lds
  ds_read2_b32 v[94:95], v188 offset0:2 offset1:3
  v_mfma_f32_16x16x32_bf16 v[148:151], v[56:59], a[164:167], v[148:151]
  ds_read_b128 a[32:35], v196 offset:544
  v_mfma_f32_16x16x32_bf16 v[148:151], v[88:91], a[132:135], v[148:151]
  v_add_f32 v156, v156, v180
  v_add_f32 v157, v157, v181
  ds_read_b128 a[64:67], v196 offset:1056
  v_mfma_f32_16x16x32_bf16 v[144:147], v[56:59], a[132:135], v[144:147]
  v_add_f32 v158, v158, v182
  v_add_f32 v159, v159, v183
  ds_read_b128 a[96:99], v196 offset:1568
  v_mfma_f32_16x16x32_bf16 v[144:147], v[88:91], a[100:103], v[144:147]
  buffer_load_dwordx4 v3, s[36:39], s27 offen offset:2048 sc1 lds
  ds_read_b128 a[128:131], v196 offset:2080
  v_mfma_f32_16x16x32_bf16 v[140:143], v[56:59], a[100:103], v[140:143]
  v_mfma_f32_16x16x32_bf16 v[140:143], v[88:91], a[68:71], v[140:143]
  ds_read_b128 a[160:163], v196 offset:2592
  v_mfma_f32_16x16x32_bf16 v[136:139], v[56:59], a[68:71], v[136:139]
  ds_read_b128 a[192:195], v196 offset:3104
  s_waitcnt lgkmcnt(5)
  v_mfma_f32_16x16x32_bf16 v[136:139], v[88:91], a[36:39], v[136:139]
  buffer_load_dwordx4 v3, s[36:39], s27 offen offset:3072 sc1 lds
  v_mfma_f32_16x16x32_bf16 v[132:135], v[56:59], a[36:39], v[132:135]
  ds_read_b128 a[224:227], v196 offset:3616
  v_mfma_f32_16x16x32_bf16 v[132:135], v[88:91], a[4:7], v[132:135]
  v_mfma_f32_16x16x32_bf16 v[128:131], v[56:59], a[4:7], v[128:131]
  ds_read2_b32 v[96:97], v189 offset0:240 offset1:241
  v_mfma_f32_16x16x32_bf16 v[128:131], v[60:63], a[0:3], v[128:131]
  s_add_u32 s27, s63, 32768
  s_add_u32 m0, s6, 32768
  s_nop 0
  buffer_load_dwordx4 v3, s[36:39], s27 offen offset:0 sc1 lds
  ds_read2_b32 v[98:99], v189 offset0:242 offset1:243
  v_mfma_f32_16x16x32_bf16 v[132:135], v[92:95], a[0:3], v[132:135]
  v_lshlrev_b32 v176, 16, v160
  v_and_b32 v177, 0xffff0000, v160
  ds_read2_b32 v[100:101], v189 offset0:224 offset1:225
  v_mfma_f32_16x16x32_bf16 v[132:135], v[60:63], a[32:35], v[132:135]
  v_lshlrev_b32 v178, 16, v161
  v_and_b32 v179, 0xffff0000, v161
  ds_read2_b32 v[102:103], v189 offset0:226 offset1:227
  v_mfma_f32_16x16x32_bf16 v[136:139], v[92:95], a[32:35], v[136:139]
  v_add_f32 v128, v128, v176
  v_add_f32 v129, v129, v177
  ds_read2_b32 v[104:105], v189 offset0:208 offset1:209
  s_waitcnt lgkmcnt(4)
  v_mfma_f32_16x16x32_bf16 v[136:139], v[60:63], a[64:67], v[136:139]
  v_add_f32 v130, v130, v178
  v_add_f32 v131, v131, v179
  buffer_load_dwordx4 v3, s[36:39], s27 offen offset:1024 sc1 lds
  v_mfma_f32_16x16x32_bf16 v[140:143], v[92:95], a[64:67], v[140:143]
  v_cvt_pk_bf16_f32 v184, v128, v129
  v_cvt_pk_bf16_f32 v185, v130, v131
  s_waitcnt vmcnt(7)
  v_cmp_ne_u32 vcc, s56, v24
  v_cmp_ne_u32 s[22:23], s56, v25
  v_cmp_ne_u32 s[98:99], s56, v26
  ds_read2_b32 v[106:107], v189 offset0:210 offset1:211
  v_mfma_f32_16x16x32_bf16 v[140:143], v[60:63], a[96:99], v[140:143]
  ds_write_b64 v193, v[184:185] offset:0
  v_mfma_f32_16x16x32_bf16 v[144:147], v[92:95], a[96:99], v[144:147]
  v_lshlrev_b32 v180, 16, v162
  v_and_b32 v181, 0xffff0000, v162
  s_or_b64 vcc, vcc, s[22:23]
  v_cmp_ne_u32 s[22:23], s56, v27
  s_or_b64 vcc, vcc, s[98:99]
  s_or_b64 vcc, vcc, s[22:23]
  s_cbranch_vccnz sequential_preLN__ssm_conv_s4__geglu_ffn__prompt_kernel_hw2
sequential_preLN__ssm_conv_s4__geglu_ffn__prompt_kernel_hw2_b:
  ds_read2_b32 v[108:109], v189 offset0:192 offset1:193
  v_mfma_f32_16x16x32_bf16 v[144:147], v[60:63], a[128:131], v[144:147]
  v_lshlrev_b32 v182, 16, v163
  v_and_b32 v183, 0xffff0000, v163
  buffer_load_dwordx4 v3, s[36:39], s27 offen offset:2048 sc1 lds
  v_mfma_f32_16x16x32_bf16 v[148:151], v[92:95], a[128:131], v[148:151]
  ds_read2_b32 v[110:111], v189 offset0:194 offset1:195
  v_mfma_f32_16x16x32_bf16 v[148:151], v[60:63], a[160:163], v[148:151]
  v_mfma_f32_16x16x32_bf16 v[152:155], v[92:95], a[160:163], v[152:155]
  ds_read2_b32 v[112:113], v189 offset0:176 offset1:177
  v_mfma_f32_16x16x32_bf16 v[152:155], v[60:63], a[192:195], v[152:155]
  v_add_f32 v132, v132, v180
  v_add_f32 v133, v133, v181
  buffer_load_dwordx4 v3, s[36:39], s27 offen offset:3072 sc1 lds
  v_mfma_f32_16x16x32_bf16 v[156:159], v[92:95], a[192:195], v[156:159]
  v_add_f32 v134, v134, v182
  v_add_f32 v135, v135, v183
  ds_read2_b32 v[114:115], v189 offset0:178 offset1:179
  v_mfma_f32_16x16x32_bf16 v[156:159], v[60:63], a[224:227], v[156:159]
  v_cvt_pk_bf16_f32 v186, v132, v133
  v_cvt_pk_bf16_f32 v187, v134, v135
  ds_write_b64 v193, v[186:187] offset:512
  s_waitcnt lgkmcnt(10)
  v_mfma_f32_16x16x32_bf16 v[156:159], v[96:99], a[188:191], v[156:159]
  ds_read2_b32 v[116:117], v189 offset0:160 offset1:161
  s_waitcnt lgkmcnt(9)
  v_mfma_f32_16x16x32_bf16 v[156:159], v[100:103], a[184:187], v[156:159]
  s_add_u32 s27, s63, 49152
  s_add_u32 m0, s6, 49152
  s_nop 0
  buffer_load_dwordx4 v3, s[36:39], s27 offen offset:0 sc1 lds
  v_mfma_f32_16x16x32_bf16 v[152:155], v[100:103], a[152:155], v[152:155]
  s_waitcnt lgkmcnt(1)
  s_barrier
  ds_read_b64_tr_b16 v[208:209], v194 offset:0
  ds_read_b64_tr_b16 v[210:211], v194 offset:32
  ds_read2_b32 v[118:119], v189 offset0:162 offset1:163
  v_mfma_f32_16x16x32_bf16 v[152:155], v[96:99], a[156:159], v[152:155]
  v_mfma_f32_16x16x32_bf16 v[148:151], v[96:99], a[124:127], v[148:151]
  s_and_b32 s64, s4, -2
  ds_read2_b32 v[120:121], v189 offset0:144 offset1:145
  v_mfma_f32_16x16x32_bf16 v[148:151], v[100:103], a[120:123], v[148:151]
  buffer_load_dwordx4 v3, s[36:39], s27 offen offset:1024 sc1 lds
  v_mfma_f32_16x16x32_bf16 v[144:147], v[100:103], a[88:91], v[144:147]
  s_lshr_b32 s65, s62, 2
  ds_read2_b32 v[122:123], v189 offset0:146 offset1:147
  v_mfma_f32_16x16x32_bf16 v[144:147], v[96:99], a[92:95], v[144:147]
  s_waitcnt lgkmcnt(3)
  v_min_u32 v211, -2, v211
  buffer_store_dwordx4 v[208:211], v195, s[36:39], s70 offen sc1
  v_mfma_f32_16x16x32_bf16 v[140:143], v[96:99], a[60:63], v[140:143]
  s_lshl1_add_u32 s65, s64, s65
  ds_read2_b32 v[124:125], v189 offset0:128 offset1:129
  v_mfma_f32_16x16x32_bf16 v[140:143], v[100:103], a[56:59], v[140:143]
  s_lshl_b32 s64, s61, 2
  v_mfma_f32_16x16x32_bf16 v[136:139], v[100:103], a[24:27], v[136:139]
  s_mul_i32 s75, s65, 40960
  ds_read2_b32 v[126:127], v189 offset0:130 offset1:131
  v_mfma_f32_16x16x32_bf16 v[136:139], v[96:99], a[28:31], v[136:139]
  buffer_load_dwordx4 v3, s[36:39], s27 offen offset:2048 sc1 lds
  v_mfma_f32_16x16x32_bf16 v[136:139], v[104:107], a[20:23], v[136:139]
  s_and_b32 s65, s62, 3
  ds_read2_b32 v[32:33], v189 offset0:112 offset1:113
  v_mfma_f32_16x16x32_bf16 v[136:139], v[108:111], a[16:19], v[136:139]
  s_lshl_b32 s65, s65, 6
  v_mfma_f32_16x16x32_bf16 v[140:143], v[108:111], a[48:51], v[140:143]
  s_add_u32 s75, s75, s65
  ds_read2_b32 v[34:35], v189 offset0:114 offset1:115
  v_mfma_f32_16x16x32_bf16 v[140:143], v[104:107], a[52:55], v[140:143]
  buffer_load_dwordx4 v3, s[36:39], s27 offen offset:3072 sc1 lds
  v_mfma_f32_16x16x32_bf16 v[144:147], v[104:107], a[84:87], v[144:147]
  s_mul_i32 s65, s57, 10240
  ds_read2_b32 v[36:37], v189 offset0:96 offset1:97
  v_mfma_f32_16x16x32_bf16 v[144:147], v[108:111], a[80:83], v[144:147]
  s_add_u32 s75, s75, s65
  v_mfma_f32_16x16x32_bf16 v[148:151], v[108:111], a[112:115], v[148:151]
  s_add_u32 s75, s75, 0x100000
  ds_read2_b32 v[38:39], v189 offset0:98 offset1:99
  v_mfma_f32_16x16x32_bf16 v[148:151], v[104:107], a[116:119], v[148:151]
  s_add_u32 s27, s63, 65536
  s_add_u32 m0, s6, 65536
  s_nop 0
  buffer_load_dwordx4 v3, s[36:39], s27 offen offset:0 sc1 lds
  v_mfma_f32_16x16x32_bf16 v[152:155], v[104:107], a[148:151], v[152:155]
  s_add_u32 s76, s75, 4096
  ds_read2_b32 v[40:41], v189 offset0:80 offset1:81
  v_mfma_f32_16x16x32_bf16 v[152:155], v[108:111], a[144:147], v[152:155]
  s_add_u32 s77, s75, 8192
  v_mfma_f32_16x16x32_bf16 v[156:159], v[108:111], a[176:179], v[156:159]
  s_add_u32 s64, s64, s57
  ds_read2_b32 v[42:43], v189 offset0:82 offset1:83
  v_mfma_f32_16x16x32_bf16 v[156:159], v[104:107], a[180:183], v[156:159]
  buffer_load_dwordx4 v3, s[36:39], s27 offen offset:1024 sc1 lds
  v_mfma_f32_16x16x32_bf16 v[156:159], v[112:115], a[172:175], v[156:159]
  s_mul_i32 s64, s64, 40960
  ds_read2_b32 v[44:45], v189 offset0:64 offset1:65
  s_waitcnt lgkmcnt(11)
  v_mfma_f32_16x16x32_bf16 v[156:159], v[116:119], a[168:171], v[156:159]
  s_add_u32 s64, s64, 0x100000
  v_mfma_f32_16x16x32_bf16 v[152:155], v[116:119], a[136:139], v[152:155]
  s_and_b32 s21, s62, 7
  ds_read2_b32 v[46:47], v189 offset0:66 offset1:67
  v_mfma_f32_16x16x32_bf16 v[152:155], v[112:115], a[140:143], v[152:155]
  buffer_load_dwordx4 v3, s[36:39], s27 offen offset:2048 sc1 lds
  v_mfma_f32_16x16x32_bf16 v[148:151], v[112:115], a[108:111], v[148:151]
  s_lshl_b32 s21, s21, 2
  ds_read2_b32 v[48:49], v189 offset0:48 offset1:49
  v_mfma_f32_16x16x32_bf16 v[148:151], v[116:119], a[104:107], v[148:151]
  s_lshr_b32 s21, 0x10210210, s21
  v_mfma_f32_16x16x32_bf16 v[144:147], v[116:119], a[72:75], v[144:147]
  s_and_b32 s21, s21, 15
  ds_read2_b32 v[50:51], v189 offset0:50 offset1:51
  v_mfma_f32_16x16x32_bf16 v[144:147], v[112:115], a[76:79], v[144:147]
  buffer_load_dwordx4 v3, s[36:39], s27 offen offset:3072 sc1 lds
  v_mfma_f32_16x16x32_bf16 v[140:143], v[112:115], a[44:47], v[140:143]
  s_lshr_b32 s20, s62, 3
  ds_read2_b32 v[52:53], v189 offset0:32 offset1:33
  v_mfma_f32_16x16x32_bf16 v[140:143], v[116:119], a[40:43], v[140:143]
  s_mul_i32 s20, s20, 5
  v_mfma_f32_16x16x32_bf16 v[136:139], v[116:119], a[8:11], v[136:139]
  s_add_u32 s20, s20, s21
  ds_read2_b32 v[54:55], v189 offset0:34 offset1:35
  v_mfma_f32_16x16x32_bf16 v[136:139], v[112:115], a[12:15], v[136:139]
  s_add_u32 s27, s63, 81920
  s_add_u32 m0, s6, 81920
  s_nop 0
  buffer_load_dwordx4 v3, s[36:39], s27 offen offset:0 sc1 lds
  s_waitcnt lgkmcnt(14)
  v_mfma_f32_16x16x32_bf16 v[136:139], v[120:123], a[4:7], v[136:139]
  s_add_u32 s65, s20, 0
  ds_read2_b32 v[56:57], v189 offset0:16 offset1:17
  s_waitcnt lgkmcnt(13)
  v_mfma_f32_16x16x32_bf16 v[136:139], v[124:127], a[0:3], v[136:139]
  s_cmp_ge_u32 s65, 10
  s_cselect_b32 s21, 10, 0
  v_mfma_f32_16x16x32_bf16 v[140:143], v[124:127], a[32:35], v[140:143]
  s_sub_u32 s65, s65, s21
  ds_read2_b32 v[58:59], v189 offset0:18 offset1:19
  v_mfma_f32_16x16x32_bf16 v[140:143], v[120:123], a[36:39], v[140:143]
  buffer_load_dwordx4 v3, s[36:39], s27 offen offset:1024 sc1 lds
  v_mfma_f32_16x16x32_bf16 v[144:147], v[120:123], a[68:71], v[144:147]
  v_lshlrev_b32 v176, 16, v164
  v_and_b32 v177, 0xffff0000, v164
  ds_read2_b32 v[60:61], v189 offset0:0 offset1:1
  v_mfma_f32_16x16x32_bf16 v[144:147], v[124:127], a[64:67], v[144:147]
  v_lshlrev_b32 v178, 16, v165
  v_and_b32 v179, 0xffff0000, v165
  buffer_load_dword v14, v13, s[36:39], s19 offen offset:0 sc1
  v_mfma_f32_16x16x32_bf16 v[148:151], v[124:127], a[96:99], v[148:151]
  v_add_f32 v136, v136, v176
  v_add_f32 v137, v137, v177
  ds_read2_b32 v[62:63], v189 offset0:2 offset1:3
  v_mfma_f32_16x16x32_bf16 v[148:151], v[120:123], a[100:103], v[148:151]
  v_add_f32 v138, v138, v178
  v_add_f32 v139, v139, v179
  buffer_load_dwordx4 v3, s[36:39], s27 offen offset:2048 sc1 lds
  v_mfma_f32_16x16x32_bf16 v[152:155], v[120:123], a[132:135], v[152:155]
  v_cvt_pk_bf16_f32 v184, v136, v137
  v_cvt_pk_bf16_f32 v185, v138, v139
  ds_read2_b32 v[64:65], v190 offset0:240 offset1:241
  v_mfma_f32_16x16x32_bf16 v[152:155], v[124:127], a[128:131], v[152:155]
  ds_write_b64 v193, v[184:185] offset:4352
  v_mfma_f32_16x16x32_bf16 v[156:159], v[124:127], a[160:163], v[156:159]
  s_lshl_b32 s65, s65, 12
  ds_read2_b32 v[66:67], v190 offset0:242 offset1:243
  v_mfma_f32_16x16x32_bf16 v[156:159], v[120:123], a[164:167], v[156:159]
  buffer_load_dwordx4 v3, s[36:39], s27 offen offset:3072 sc1 lds
  s_waitcnt lgkmcnt(15)
  v_mfma_f32_16x16x32_bf16 v[156:159], v[32:35], a[156:159], v[156:159]
  s_add_u32 s8, s65, s64
  ds_read2_b32 v[68:69], v190 offset0:224 offset1:225
  v_mfma_f32_16x16x32_bf16 v[156:159], v[36:39], a[152:155], v[156:159]
  s_add_u32 s65, s20, 1
  v_mfma_f32_16x16x32_bf16 v[152:155], v[36:39], a[120:123], v[152:155]
  s_cmp_ge_u32 s65, 10
  s_cselect_b32 s21, 10, 0
  ds_read2_b32 v[70:71], v190 offset0:226 offset1:227
  v_mfma_f32_16x16x32_bf16 v[152:155], v[32:35], a[124:127], v[152:155]
  s_sub_u32 s65, s65, s21
  v_mfma_f32_16x16x32_bf16 v[148:151], v[32:35], a[92:95], v[148:151]
  s_lshl_b32 s65, s65, 12
  ds_read2_b32 v[72:73], v190 offset0:208 offset1:209
  v_mfma_f32_16x16x32_bf16 v[148:151], v[36:39], a[88:91], v[148:151]
  s_add_u32 s27, s63, 98304
  s_add_u32 m0, s6, 98304
  s_nop 0
  buffer_load_dwordx4 v3, s[36:39], s27 offen offset:0 sc1 lds
  v_mfma_f32_16x16x32_bf16 v[144:147], v[36:39], a[56:59], v[144:147]
  s_add_u32 s9, s65, s64
  ds_read2_b32 v[74:75], v190 offset0:210 offset1:211
  v_mfma_f32_16x16x32_bf16 v[144:147], v[32:35], a[60:63], v[144:147]
  s_add_u32 s65, s20, 2
  v_mfma_f32_16x16x32_bf16 v[140:143], v[32:35], a[28:31], v[140:143]
  s_cmp_ge_u32 s65, 10
  s_cselect_b32 s21, 10, 0
  ds_read2_b32 v[76:77], v190 offset0:192 offset1:193
  v_mfma_f32_16x16x32_bf16 v[140:143], v[36:39], a[24:27], v[140:143]
  buffer_load_dwordx4 v3, s[36:39], s27 offen offset:1024 sc1 lds
  s_waitcnt lgkmcnt(15)
  v_mfma_f32_16x16x32_bf16 v[140:143], v[40:43], a[20:23], v[140:143]
  s_sub_u32 s65, s65, s21
  ds_read2_b32 v[78:79], v190 offset0:194 offset1:195
  v_mfma_f32_16x16x32_bf16 v[140:143], v[44:47], a[16:19], v[140:143]
  s_lshl_b32 s65, s65, 12
  v_mfma_f32_16x16x32_bf16 v[144:147], v[44:47], a[48:51], v[144:147]
  s_add_u32 s10, s65, s64
  ds_read2_b32 v[80:81], v190 offset0:176 offset1:177
  v_mfma_f32_16x16x32_bf16 v[144:147], v[40:43], a[52:55], v[144:147]
  buffer_load_dwordx4 v3, s[36:39], s27 offen offset:2048 sc1 lds
  v_mfma_f32_16x16x32_bf16 v[148:151], v[40:43], a[84:87], v[148:151]
  s_add_u32 s65, s20, 3
  ds_read2_b32 v[82:83], v190 offset0:178 offset1:179
  v_mfma_f32_16x16x32_bf16 v[148:151], v[44:47], a[80:83], v[148:151]
  s_cmp_ge_u32 s65, 10
  s_cselect_b32 s21, 10, 0
  v_mfma_f32_16x16x32_bf16 v[152:155], v[44:47], a[112:115], v[152:155]
  s_sub_u32 s65, s65, s21
  ds_read2_b32 v[84:85], v190 offset0:160 offset1:161
  v_mfma_f32_16x16x32_bf16 v[152:155], v[40:43], a[116:119], v[152:155]
  buffer_load_dwordx4 v3, s[36:39], s27 offen offset:3072 sc1 lds
  v_mfma_f32_16x16x32_bf16 v[156:159], v[40:43], a[148:151], v[156:159]
  s_lshl_b32 s65, s65, 12
  ds_read2_b32 v[86:87], v190 offset0:162 offset1:163
  v_mfma_f32_16x16x32_bf16 v[156:159], v[44:47], a[144:147], v[156:159]
  s_add_u32 s11, s65, s64
  s_waitcnt lgkmcnt(15)
  v_mfma_f32_16x16x32_bf16 v[156:159], v[48:51], a[140:143], v[156:159]
  s_add_u32 s65, s20, 4
  ds_read2_b32 v[88:89], v190 offset0:144 offset1:145
  v_mfma_f32_16x16x32_bf16 v[156:159], v[52:55], a[136:139], v[156:159]
  s_cmp_ge_u32 s65, 10
  s_cselect_b32 s21, 10, 0
  v_mfma_f32_16x16x32_bf16 v[152:155], v[52:55], a[104:107], v[152:155]
  s_sub_u32 s65, s65, s21
  ds_read2_b32 v[90:91], v190 offset0:146 offset1:147
  v_mfma_f32_16x16x32_bf16 v[152:155], v[48:51], a[108:111], v[152:155]
  s_lshl_b32 s65, s65, 12
  v_mfma_f32_16x16x32_bf16 v[148:151], v[48:51], a[76:79], v[148:151]
  s_add_u32 s12, s65, s64
  ds_read2_b32 v[92:93], v190 offset0:128 offset1:129
  v_mfma_f32_16x16x32_bf16 v[148:151], v[52:55], a[72:75], v[148:151]
  s_add_u32 s65, s20, 5
  v_mfma_f32_16x16x32_bf16 v[144:147], v[52:55], a[40:43], v[144:147]
  s_cmp_ge_u32 s65, 10
  s_cselect_b32 s21, 10, 0
  ds_read2_b32 v[94:95], v190 offset0:130 offset1:131
  v_mfma_f32_16x16x32_bf16 v[144:147], v[48:51], a[44:47], v[144:147]
  s_sub_u32 s65, s65, s21
  v_mfma_f32_16x16x32_bf16 v[140:143], v[48:51], a[12:15], v[140:143]
  s_lshl_b32 s65, s65, 12
  ds_read2_b32 v[96:97], v190 offset0:112 offset1:113
  v_mfma_f32_16x16x32_bf16 v[140:143], v[52:55], a[8:11], v[140:143]
  v_lshlrev_b32 v180, 16, v166
  v_and_b32 v181, 0xffff0000, v166
  v_mfma_f32_16x16x32_bf16 v[140:143], v[56:59], a[4:7], v[140:143]
  v_lshlrev_b32 v182, 16, v167
  v_and_b32 v183, 0xffff0000, v167
  ds_read2_b32 v[98:99], v190 offset0:114 offset1:115
  s_waitcnt lgkmcnt(15)
  v_mfma_f32_16x16x32_bf16 v[140:143], v[60:63], a[0:3], v[140:143]
  s_add_u32 s13, s65, s64
  v_mfma_f32_16x16x32_bf16 v[144:147], v[60:63], a[32:35], v[144:147]
  s_add_u32 s65, s20, 6
  ds_read2_b32 v[100:101], v190 offset0:96 offset1:97
  v_mfma_f32_16x16x32_bf16 v[144:147], v[56:59], a[36:39], v[144:147]
  s_cmp_ge_u32 s65, 10
  s_cselect_b32 s21, 10, 0
  v_mfma_f32_16x16x32_bf16 v[148:151], v[56:59], a[68:71], v[148:151]
  v_add_f32 v140, v140, v180
  v_add_f32 v141, v141, v181
  ds_read2_b32 v[102:103], v190 offset0:98 offset1:99
  v_mfma_f32_16x16x32_bf16 v[148:151], v[60:63], a[64:67], v[148:151]
  v_add_f32 v142, v142, v182
  v_add_f32 v143, v143, v183
  v_mfma_f32_16x16x32_bf16 v[152:155], v[60:63], a[96:99], v[152:155]
  v_cvt_pk_bf16_f32 v186, v140, v141
  v_cvt_pk_bf16_f32 v187, v142, v143
  ds_write_b64 v193, v[186:187] offset:4864
  ds_read2_b32 v[104:105], v190 offset0:80 offset1:81
  v_mfma_f32_16x16x32_bf16 v[152:155], v[56:59], a[100:103], v[152:155]
  s_sub_u32 s65, s65, s21
  v_mfma_f32_16x16x32_bf16 v[156:159], v[56:59], a[132:135], v[156:159]
  s_lshl_b32 s65, s65, 12
  ds_read2_b32 v[106:107], v190 offset0:82 offset1:83
  v_mfma_f32_16x16x32_bf16 v[156:159], v[60:63], a[128:131], v[156:159]
  s_waitcnt lgkmcnt(2)
  s_barrier
  ds_read_b64_tr_b16 v[212:213], v194 offset:4352
  ds_read_b64_tr_b16 v[214:215], v194 offset:4384
  v_mfma_f32_16x16x32_bf16 v[156:159], v[64:67], a[124:127], v[156:159]
  s_add_u32 s14, s65, s64
  ds_read2_b32 v[108:109], v190 offset0:64 offset1:65
  v_mfma_f32_16x16x32_bf16 v[156:159], v[68:71], a[120:123], v[156:159]
  s_add_u32 s65, s20, 7
  v_mfma_f32_16x16x32_bf16 v[152:155], v[68:71], a[88:91], v[152:155]
  s_cmp_ge_u32 s65, 10
  s_cselect_b32 s21, 10, 0
  ds_read2_b32 v[110:111], v190 offset0:66 offset1:67
  v_mfma_f32_16x16x32_bf16 v[152:155], v[64:67], a[92:95], v[152:155]
  s_waitcnt lgkmcnt(2)
  v_min_u32 v215, -2, v215
  buffer_store_dwordx4 v[212:215], v195, s[36:39], s71 offen sc1
  v_mfma_f32_16x16x32_bf16 v[148:151], v[64:67], a[60:63], v[148:151]
  s_sub_u32 s65, s65, s21
  ds_read2_b32 v[112:113], v190 offset0:48 offset1:49
  v_mfma_f32_16x16x32_bf16 v[148:151], v[68:71], a[56:59], v[148:151]
  s_lshl_b32 s65, s65, 12
  v_mfma_f32_16x16x32_bf16 v[144:147], v[68:71], a[24:27], v[144:147]
  s_add_u32 s15, s65, s64
  ds_read2_b32 v[114:115], v190 offset0:50 offset1:51
  v_mfma_f32_16x16x32_bf16 v[144:147], v[64:67], a[28:31], v[144:147]
  s_add_u32 s65, s20, 8
  v_mfma_f32_16x16x32_bf16 v[144:147], v[72:75], a[20:23], v[144:147]
  s_cmp_ge_u32 s65, 10
  s_cselect_b32 s21, 10, 0
  ds_read2_b32 v[116:117], v190 offset0:32 offset1:33
  v_mfma_f32_16x16x32_bf16 v[144:147], v[76:79], a[16:19], v[144:147]
  s_sub_u32 s65, s65, s21
  v_mfma_f32_16x16x32_bf16 v[148:151], v[76:79], a[48:51], v[148:151]
  s_lshl_b32 s65, s65, 12
  ds_read2_b32 v[118:119], v190 offset0:34 offset1:35
  v_mfma_f32_16x16x32_bf16 v[148:151], v[72:75], a[52:55], v[148:151]
  s_add_u32 s16, s65, s64
  v_mfma_f32_16x16x32_bf16 v[152:155], v[72:75], a[84:87], v[152:155]
  s_waitcnt vmcnt(7)
  v_cmp_ne_u32 vcc, s56, v14
  s_mov_b32 s26, 0
  s_cbranch_vccz sequential_preLN__ssm_conv_s4__geglu_ffn__prompt_kernel_fw4_ok
sequential_preLN__ssm_conv_s4__geglu_ffn__prompt_kernel_fw4:
  buffer_load_dword v14, v13, s[36:39], s19 offen offset:0 sc1
  s_add_u32 s26, s26, 1
  s_waitcnt vmcnt(0)
  v_cmp_ne_u32 vcc, s56, v14
  s_cmp_gt_u32 s26, 0x40000
  s_cbranch_scc1 sequential_preLN__ssm_conv_s4__geglu_ffn__prompt_kernel_fw4_ok
  s_cbranch_vccnz sequential_preLN__ssm_conv_s4__geglu_ffn__prompt_kernel_fw4
sequential_preLN__ssm_conv_s4__geglu_ffn__prompt_kernel_fw4_ok:
  ds_read2_b32 v[120:121], v190 offset0:16 offset1:17
  v_mfma_f32_16x16x32_bf16 v[152:155], v[76:79], a[80:83], v[152:155]
  buffer_load_dwordx4 a[252:255], v0, s[44:47], 0 offen offset:0 sc1
  v_mfma_f32_16x16x32_bf16 v[156:159], v[76:79], a[112:115], v[156:159]
  s_add_u32 s65, s20, 9
  ds_read2_b32 v[122:123], v190 offset0:18 offset1:19
  v_mfma_f32_16x16x32_bf16 v[156:159], v[72:75], a[116:119], v[156:159]
  s_cmp_ge_u32 s65, 10
  s_cselect_b32 s21, 10, 0
  v_mfma_f32_16x16x32_bf16 v[156:159], v[80:83], a[108:111], v[156:159]
  s_sub_u32 s65, s65, s21
  ds_read2_b32 v[124:125], v190 offset0:0 offset1:1
  v_mfma_f32_16x16x32_bf16 v[156:159], v[84:87], a[104:107], v[156:159]
  s_lshl_b32 s65, s65, 12
  v_mfma_f32_16x16x32_bf16 v[152:155], v[84:87], a[72:75], v[152:155]
  s_add_u32 s17, s65, s64
  ds_read2_b32 v[126:127], v190 offset0:2 offset1:3
  v_mfma_f32_16x16x32_bf16 v[152:155], v[80:83], a[76:79], v[152:155]
  buffer_load_dwordx4 a[248:251], v0, s[44:47], 0 offen offset:1024 sc1
  v_mfma_f32_16x16x32_bf16 v[148:151], v[80:83], a[44:47], v[148:151]
  v_lshrrev_b32 v22, 2, v1
  ds_read2_b32 v[32:33], v191 offset0:240 offset1:241
  v_mfma_f32_16x16x32_bf16 v[148:151], v[84:87], a[40:43], v[148:151]
  v_and_b32 v23, 3, v1
  v_mfma_f32_16x16x32_bf16 v[144:147], v[84:87], a[8:11], v[144:147]
  v_lshlrev_b32 v9, 8, v22
  ds_read2_b32 v[34:35], v191 offset0:242 offset1:243
  v_mfma_f32_16x16x32_bf16 v[144:147], v[80:83], a[12:15], v[144:147]
  buffer_load_dwordx4 a[244:247], v0, s[44:47], 0 offen offset:2048 sc1
  v_mfma_f32_16x16x32_bf16 v[144:147], v[88:91], a[4:7], v[144:147]
  v_lshl_add_u32 v9, v23, 4, v9
  ds_read2_b32 v[36:37], v191 offset0:224 offset1:225
  v_mfma_f32_16x16x32_bf16 v[144:147], v[92:95], a[0:3], v[144:147]
  v_lshrrev_b32 v22, 5, v1
  v_mfma_f32_16x16x32_bf16 v[148:151], v[92:95], a[32:35], v[148:151]
  v_lshl_add_u32 v10, v22, 30, v9
  ds_read2_b32 v[38:39], v191 offset0:226 offset1:227
  v_mfma_f32_16x16x32_bf16 v[148:151], v[88:91], a[36:39], v[148:151]
  v_mfma_f32_16x16x32_bf16 v[152:155], v[88:91], a[68:71], v[152:155]
  v_lshlrev_b32 v176, 16, v168
  v_and_b32 v177, 0xffff0000, v168
  ds_read2_b32 v[40:41], v191 offset0:208 offset1:209
  v_mfma_f32_16x16x32_bf16 v[152:155], v[92:95], a[64:67], v[152:155]
  v_lshlrev_b32 v178, 16, v169
  v_and_b32 v179, 0xffff0000, v169
  buffer_load_dwordx4 a[240:243], v0, s[44:47], 0 offen offset:3072 sc1
  v_mfma_f32_16x16x32_bf16 v[156:159], v[92:95], a[96:99], v[156:159]
  v_add_f32 v144, v144, v176
  v_add_f32 v145, v145, v177
  ds_read2_b32 v[42:43], v191 offset0:210 offset1:211
  v_mfma_f32_16x16x32_bf16 v[156:159], v[88:91], a[100:103], v[156:159]
  v_add_f32 v146, v146, v178
  v_add_f32 v147, v147, v179
  v_mfma_f32_16x16x32_bf16 v[156:159], v[96:99], a[92:95], v[156:159]
  v_cvt_pk_bf16_f32 v184, v144, v145
  v_cvt_pk_bf16_f32 v185, v146, v147
  ds_read2_b32 v[44:45], v191 offset0:192 offset1:193
  v_mfma_f32_16x16x32_bf16 v[156:159], v[100:103], a[88:91], v[156:159]
  ds_write_b64 v193, v[184:185] offset:0
  buffer_load_dwordx4 a[236:239], v0, s[44:47], s100 offen sc1
  v_add_u32 v0, 40960, v0
  v_mfma_f32_16x16x32_bf16 v[152:155], v[100:103], a[56:59], v[152:155]
  ds_read2_b32 v[46:47], v191 offset0:194 offset1:195
  v_mfma_f32_16x16x32_bf16 v[152:155], v[96:99], a[60:63], v[152:155]
  v_mfma_f32_16x16x32_bf16 v[148:151], v[96:99], a[28:31], v[148:151]
  ds_read2_b32 v[48:49], v191 offset0:176 offset1:177
  v_mfma_f32_16x16x32_bf16 v[148:151], v[100:103], a[24:27], v[148:151]
  v_mfma_f32_16x16x32_bf16 v[148:151], v[104:107], a[20:23], v[148:151]
  ds_read2_b32 v[50:51], v191 offset0:178 offset1:179
  s_waitcnt lgkmcnt(15)
  v_mfma_f32_16x16x32_bf16 v[148:151], v[108:111], a[16:19], v[148:151]
  buffer_load_dwordx4 a[232:235], v0, s[44:47], 0 offen offset:0 sc1
  v_mfma_f32_16x16x32_bf16 v[152:155], v[108:111], a[48:51], v[152:155]
  ds_read2_b32 v[52:53], v191 offset0:160 offset1:161
  v_mfma_f32_16x16x32_bf16 v[152:155], v[104:107], a[52:55], v[152:155]
  v_mfma_f32_16x16x32_bf16 v[156:159], v[104:107], a[84:87], v[156:159]
  ds_read2_b32 v[54:55], v191 offset0:162 offset1:163
  v_mfma_f32_16x16x32_bf16 v[156:159], v[108:111], a[80:83], v[156:159]
  v_mfma_f32_16x16x32_bf16 v[156:159], v[112:115], a[76:79], v[156:159]
  ds_read2_b32 v[56:57], v191 offset0:144 offset1:145
  v_mfma_f32_16x16x32_bf16 v[156:159], v[116:119], a[72:75], v[156:159]
  buffer_load_dwordx4 a[228:231], v0, s[44:47], 0 offen offset:1024 sc1
  v_mfma_f32_16x16x32_bf16 v[152:155], v[116:119], a[40:43], v[152:155]
  ds_read2_b32 v[58:59], v191 offset0:146 offset1:147
  v_mfma_f32_16x16x32_bf16 v[152:155], v[112:115], a[44:47], v[152:155]
  v_mfma_f32_16x16x32_bf16 v[148:151], v[112:115], a[12:15], v[148:151]
  ds_read2_b32 v[60:61], v191 offset0:128 offset1:129
  v_mfma_f32_16x16x32_bf16 v[148:151], v[116:119], a[8:11], v[148:151]
  v_lshlrev_b32 v180, 16, v170
  v_and_b32 v181, 0xffff0000, v170
  buffer_load_dwordx4 a[224:227], v0, s[44:47], 0 offen offset:2048 sc1
  s_waitcnt lgkmcnt(15)
  v_mfma_f32_16x16x32_bf16 v[148:151], v[120:123], a[4:7], v[148:151]
  v_lshlrev_b32 v182, 16, v171
  v_and_b32 v183, 0xffff0000, v171
  ds_read2_b32 v[62:63], v191 offset0:130 offset1:131
  v_mfma_f32_16x16x32_bf16 v[148:151], v[124:127], a[0:3], v[148:151]
  v_mfma_f32_16x16x32_bf16 v[152:155], v[124:127], a[32:35], v[152:155]
  ds_read2_b32 v[64:65], v191 offset0:112 offset1:113
  v_mfma_f32_16x16x32_bf16 v[152:155], v[120:123], a[36:39], v[152:155]
  v_mfma_f32_16x16x32_bf16 v[156:159], v[120:123], a[68:71], v[156:159]
  s_nop 3
  v_add_f32 v148, v148, v180
  v_add_f32 v149, v149, v181
  ds_read2_b32 v[66:67], v191 offset0:114 offset1:115
  v_mfma_f32_16x16x32_bf16 v[156:159], v[124:127], a[64:67], v[156:159]
  v_add_f32 v150, v150, v182
  v_add_f32 v151, v151, v183
  buffer_load_dwordx4 a[220:223], v0, s[44:47], 0 offen offset:3072 sc1
  s_waitcnt lgkmcnt(15)
  v_mfma_f32_16x16x32_bf16 v[156:159], v[32:35], a[60:63], v[156:159]
  v_cvt_pk_bf16_f32 v186, v148, v149
  v_cvt_pk_bf16_f32 v187, v150, v151
  ds_write_b64 v193, v[186:187] offset:512
  ds_read2_b32 v[68:69], v191 offset0:96 offset1:97
  v_mfma_f32_16x16x32_bf16 v[156:159], v[36:39], a[56:59], v[156:159]
  ds_read2_b32 v[70:71], v191 offset0:98 offset1:99
  v_mfma_f32_16x16x32_bf16 v[152:155], v[36:39], a[24:27], v[152:155]
  ds_read2_b32 v[72:73], v191 offset0:80 offset1:81
  v_mfma_f32_16x16x32_bf16 v[152:155], v[32:35], a[28:31], v[152:155]
  s_waitcnt lgkmcnt(3)
  s_barrier
  ds_read_b64_tr_b16 v[208:209], v194 offset:0
  ds_read_b64_tr_b16 v[210:211], v194 offset:32
  buffer_load_dwordx4 a[216:219], v0, s[44:47], s100 offen sc1
  v_add_u32 v0, 40960, v0
  ds_read2_b32 v[74:75], v191 offset0:82 offset1:83
  v_mfma_f32_16x16x32_bf16 v[152:155], v[40:43], a[20:23], v[152:155]
  ds_read2_b32 v[76:77], v191 offset0:64 offset1:65
  v_mfma_f32_16x16x32_bf16 v[152:155], v[44:47], a[16:19], v[152:155]
  ds_read2_b32 v[78:79], v191 offset0:66 offset1:67
  v_mfma_f32_16x16x32_bf16 v[156:159], v[44:47], a[48:51], v[156:159]
  ds_read2_b32 v[80:81], v191 offset0:48 offset1:49
  v_mfma_f32_16x16x32_bf16 v[156:159], v[40:43], a[52:55], v[156:159]
  s_waitcnt lgkmcnt(4)
  v_min_u32 v211, -2, v211
  buffer_store_dwordx4 v[208:211], v195, s[36:39], s72 offen sc1
  ds_read2_b32 v[82:83], v191 offset0:50 offset1:51
  v_mfma_f32_16x16x32_bf16 v[156:159], v[48:51], a[44:47], v[156:159]
  ds_read2_b32 v[84:85], v191 offset0:32 offset1:33
  v_mfma_f32_16x16x32_bf16 v[156:159], v[52:55], a[40:43], v[156:159]
  buffer_load_dwordx4 a[212:215], v0, s[44:47], 0 offen offset:0 sc1
  ds_read2_b32 v[86:87], v191 offset0:34 offset1:35
  v_mfma_f32_16x16x32_bf16 v[152:155], v[52:55], a[8:11], v[152:155]
  ds_read2_b32 v[88:89], v191 offset0:16 offset1:17
  ds_read2_b32 v[90:91], v191 offset0:18 offset1:19
  v_mfma_f32_16x16x32_bf16 v[152:155], v[48:51], a[12:15], v[152:155]
  ds_read2_b32 v[92:93], v191 offset0:0 offset1:1
  ds_read2_b32 v[94:95], v191 offset0:2 offset1:3
  v_mfma_f32_16x16x32_bf16 v[152:155], v[56:59], a[4:7], v[152:155]
  v_mfma_f32_16x16x32_bf16 v[152:155], v[60:63], a[0:3], v[152:155]
  buffer_load_dwordx4 a[208:211], v0, s[44:47], 0 offen offset:1024 sc1
  v_mfma_f32_16x16x32_bf16 v[156:159], v[60:63], a[32:35], v[156:159]
  v_mfma_f32_16x16x32_bf16 v[156:159], v[56:59], a[36:39], v[156:159]
  v_lshlrev_b32 v176, 16, v172
  v_and_b32 v177, 0xffff0000, v172
  v_mfma_f32_16x16x32_bf16 v[156:159], v[64:67], a[28:31], v[156:159]
  v_lshlrev_b32 v178, 16, v173
  v_and_b32 v179, 0xffff0000, v173
  v_mfma_f32_16x16x32_bf16 v[156:159], v[68:71], a[24:27], v[156:159]
  v_add_f32 v152, v152, v176
  v_add_f32 v153, v153, v177
  s_waitcnt lgkmcnt(10)
  v_mfma_f32_16x16x32_bf16 v[156:159], v[72:75], a[20:23], v[156:159]
  v_add_f32 v154, v154, v178
  v_add_f32 v155, v155, v179
  s_waitcnt lgkmcnt(8)
  v_mfma_f32_16x16x32_bf16 v[156:159], v[76:79], a[16:19], v[156:159]
  v_cvt_pk_bf16_f32 v184, v152, v153
  v_cvt_pk_bf16_f32 v185, v154, v155
  s_waitcnt lgkmcnt(6)
  v_mfma_f32_16x16x32_bf16 v[156:159], v[80:83], a[12:15], v[156:159]
  ds_write_b64 v193, v[184:185] offset:4352
  s_waitcnt lgkmcnt(5)
  v_mfma_f32_16x16x32_bf16 v[156:159], v[84:87], a[8:11], v[156:159]
  s_waitcnt lgkmcnt(3)
  v_mfma_f32_16x16x32_bf16 v[156:159], v[88:91], a[4:7], v[156:159]
  s_waitcnt lgkmcnt(1)
  v_mfma_f32_16x16x32_bf16 v[156:159], v[92:95], a[0:3], v[156:159]
  s_nop 7
  v_cvt_pk_bf16_f32 v186, v156, v157
  v_cvt_pk_bf16_f32 v187, v158, v159
  ds_write_b64 v193, v[186:187] offset:4864
  s_waitcnt vmcnt(14)
  s_waitcnt lgkmcnt(0)
  s_barrier
  ds_read_b64_tr_b16 v[212:213], v194 offset:4352
  ds_read_b64_tr_b16 v[214:215], v194 offset:4384
  s_waitcnt lgkmcnt(0)
  v_min_u32 v215, -2, v215
  buffer_store_dwordx4 v[212:215], v195, s[36:39], s73 offen sc1
  s_branch sequential_preLN__ssm_conv_s4__geglu_ffn__prompt_kernel_join
sequential_preLN__ssm_conv_s4__geglu_ffn__prompt_kernel_rep:
  s_mul_i32 s60, s58, 12
  s_mul_i32 s64, s64, 3
  s_sub_u32 s65, s65, 1
  s_mul_i32 s65, s65, s66
  s_add_u32 s74, s64, s65
  s_add_u32 s60, s60, s74
  v_lshrrev_b32 v16, 5, v0
  s_lshl_b32 s98, s60, 3
  v_add_u32 v14, s98, v16
  s_movk_i32 s98, 1280
  v_mul_lo_u32 v2, v14, s98
  v_and_b32 v17, 31, v0
  v_lshl_add_u32 v4, v17, 3, v2
  v_lshl_add_u32 v2, v17, 4, v2
  v_mul_u32_u24 v5, 768, v17
  v_add_u32 v14, v14, v5
  v_mov_b32 v5, 0x40000000
  v_cmp_gt_u32 vcc, 2048, v14
  s_mov_b32 s98, 0x10000
  v_lshl_add_u32 v14, v14, 3, s98
  v_cndmask_b32 v14, v5, v14, vcc
  s_and_b32 s64, s58, 1
  s_xor_b32 s64, s64, 1
  s_lshr_b32 s65, s58, 1
  s_lshl2_add_u32 s64, s64, s65
  s_mul_i32 s64, s64, 12
  s_add_u32 s64, s64, s74
  s_lshl2_add_u32 s71, s64, s57
  s_add_u32 s71, s71, 4
  s_sub_u32 s64, s71, 378
  s_cmp_lt_u32 s64, 4
  s_cselect_b32 s71, s64, s71
  s_min_u32 s71, s71, 383
  s_mul_i32 s68, s71, 4682
  s_lshr_b32 s68, s68, 16
  s_mul_i32 s64, s68, 14
  s_sub_u32 s64, s71, s64
  s_and_b32 s69, s64, 1
  s_lshr_b32 s70, s64, 1
  s_mov_b32 s46, 2211840
  s_mov_b32 s47, 0x00020000
  s_mul_i32 s72, s70, 331776
  s_lshl_b32 s64, s68, 7
  s_add_u32 s72, s72, s64
  s_cmp_ge_u32 s71, 378
  s_cselect_b32 s72, 0x40000000, s72
  s_mul_i32 s73, s57, 12288
  v_lshrrev_b32 v21, 3, v1
  v_mul_u32_u24 v20, 3456, v21
  v_and_b32 v21, 6, v21
  v_and_b32 v22, 7, v1
  v_xor_b32 v21, v21, v22
  v_lshl_add_u32 v20, v21, 4, v20
  s_mov_b32 s98, 983040
  s_mov_b32 s99, 1966080
  s_waitcnt lgkmcnt(0)
  s_mov_b32 s40, s4
  s_mov_b32 s41, s5
  buffer_load_dwordx4 v[128:131], v2, s[40:43], 0 offen
  buffer_load_dwordx4 v[132:135], v2, s[40:43], 0 offen offset:512
  buffer_load_dwordx2 v[136:137], v4, s[40:43], 0 offen offset:1024
  s_mov_b32 s36, s34
  s_mov_b32 s37, s35
  buffer_load_dword v9, v9, s[36:39], 0 offen sc1
  s_mov_b32 s52, s30
  s_mov_b32 s53, s31
  buffer_load_dwordx4 v[138:141], v2, s[40:43], s98 offen
  buffer_load_dwordx4 v[142:145], v2, s[40:43], s98 offen offset:512
  buffer_load_dwordx2 v[146:147], v4, s[40:43], s98 offen offset:1024
  buffer_load_dwordx4 v[148:151], v2, s[40:43], s99 offen
  buffer_load_dwordx4 v[152:155], v2, s[40:43], s99 offen offset:512
  buffer_load_dwordx2 v[156:157], v4, s[40:43], s99 offen offset:1024
  s_cmp_eq_u32 s69, 0
  s_cselect_b32 s44, s24, s26
  s_cselect_b32 s45, s25, s27
  s_add_u32 m0, s73, 0
  s_nop 0
  buffer_load_dwordx4 v20, s[44:47], s72 offen lds
  s_add_u32 s72, s72, 27648
  s_lshl_b32 s64, s68, 2
  s_add_u32 s64, s64, 0
  s_mul_i32 s65, s64, 19
  s_lshr_b32 s65, s65, 9
  s_mul_i32 s66, s65, 27
  s_sub_u32 s66, s64, s66
  s_mul_i32 s66, s66, 37
  s_lshr_b32 s66, s66, 8
  s_lshl_b32 s65, s65, 2
  s_add_u32 s65, s65, s66
  s_and_b32 s66, s65, 7
  s_lshl_b32 s66, s66, 2
  s_lshr_b32 s66, 0x10210210, s66
  s_and_b32 s66, s66, 15
  s_add_u32 m0, s73, 1024
  s_nop 0
  buffer_load_dwordx4 v20, s[44:47], s72 offen lds
  s_add_u32 s72, s72, 27648
  s_lshr_b32 s65, s65, 3
  s_mul_i32 s65, s65, 5
  s_add_u32 s65, s65, s66
  s_lshl_b32 s65, s65, 2
  s_mul_i32 s66, s70, 6
  s_add_u32 s66, s66, s69
  s_add_u32 s66, s66, 40
  s_sub_u32 s66, s66, s65
  s_mul_i32 s64, s64, 41
  s_add_u32 s65, s66, 0
  s_cmp_ge_u32 s65, 40
  s_cselect_b32 s67, 40, 0
  s_sub_u32 s65, s65, s67
  s_add_u32 s65, s65, s64
  s_add_u32 m0, s73, 2048
  s_nop 0
  buffer_load_dwordx4 v20, s[44:47], s72 offen lds
  s_add_u32 s72, s72, 27648
  s_lshl_b32 s65, s65, 10
  s_add_u32 s4, s65, 0xe00000
  s_add_u32 s65, s66, 2
  s_cmp_ge_u32 s65, 40
  s_cselect_b32 s67, 40, 0
  s_sub_u32 s65, s65, s67
  s_add_u32 s65, s65, s64
  s_lshl_b32 s65, s65, 10
  s_add_u32 s5, s65, 0xe00000
  s_add_u32 s65, s66, 4
  s_cmp_ge_u32 s65, 40
  s_cselect_b32 s67, 40, 0
  s_sub_u32 s65, s65, s67
  s_add_u32 s65, s65, s64
  s_add_u32 m0, s73, 3072
  s_nop 0
  buffer_load_dwordx4 v20, s[44:47], s72 offen lds
  s_add_u32 s72, s72, 27648
  s_lshl_b32 s65, s65, 10
  s_add_u32 s6, s65, 0xe00000
  s_cmp_eq_u32 s70, 6
  s_cselect_b32 s6, 0x40000000, s6
  s_cmp_ge_u32 s71, 378
  s_cselect_b32 s4, 0x40000000, s4
  s_cselect_b32 s5, 0x40000000, s5
  s_cselect_b32 s6, 0x40000000, s6
  s_lshl_b32 s64, s68, 2
  s_add_u32 s64, s64, 1
  s_mul_i32 s65, s64, 19
  s_lshr_b32 s65, s65, 9
  s_mul_i32 s66, s65, 27
  s_sub_u32 s66, s64, s66
  s_add_u32 m0, s73, 4096
  s_nop 0
  buffer_load_dwordx4 v20, s[44:47], s72 offen lds
  s_add_u32 s72, s72, 27648
  s_mul_i32 s66, s66, 37
  s_lshr_b32 s66, s66, 8
  s_lshl_b32 s65, s65, 2
  s_add_u32 s65, s65, s66
  s_and_b32 s66, s65, 7
  s_lshl_b32 s66, s66, 2
  s_lshr_b32 s66, 0x10210210, s66
  s_and_b32 s66, s66, 15
  s_lshr_b32 s65, s65, 3
  s_mul_i32 s65, s65, 5
  s_add_u32 s65, s65, s66
  s_lshl_b32 s65, s65, 2
  s_mul_i32 s66, s70, 6
  s_add_u32 s66, s66, s69
  s_add_u32 m0, s73, 5120
  s_nop 0
  buffer_load_dwordx4 v20, s[44:47], s72 offen lds
  s_add_u32 s72, s72, 27648
  s_add_u32 s66, s66, 40
  s_sub_u32 s66, s66, s65
  s_mul_i32 s64, s64, 41
  s_add_u32 s65, s66, 0
  s_cmp_ge_u32 s65, 40
  s_cselect_b32 s67, 40, 0
  s_sub_u32 s65, s65, s67
  s_add_u32 s65, s65, s64
  s_lshl_b32 s65, s65, 10
  s_add_u32 s7, s65, 0xe00000
  s_add_u32 s65, s66, 2
  s_cmp_ge_u32 s65, 40
  s_cselect_b32 s67, 40, 0
  s_sub_u32 s65, s65, s67
  s_add_u32 m0, s73, 6144
  s_nop 0
  buffer_load_dwordx4 v20, s[44:47], s72 offen lds
  s_add_u32 s72, s72, 27648
  s_add_u32 s65, s65, s64
  s_lshl_b32 s65, s65, 10
  s_add_u32 s8, s65, 0xe00000
  s_add_u32 s65, s66, 4
  s_cmp_ge_u32 s65, 40
  s_cselect_b32 s67, 40, 0
  s_sub_u32 s65, s65, s67
  s_add_u32 s65, s65, s64
  s_lshl_b32 s65, s65, 10
  s_add_u32 s9, s65, 0xe00000
  s_cmp_eq_u32 s70, 6
  s_cselect_b32 s9, 0x40000000, s9
  s_cmp_ge_u32 s71, 378
  s_cselect_b32 s7, 0x40000000, s7
  s_cselect_b32 s8, 0x40000000, s8
  s_cselect_b32 s9, 0x40000000, s9
  s_add_u32 m0, s73, 7168
  s_nop 0
  buffer_load_dwordx4 v20, s[44:47], s72 offen lds
  s_add_u32 s72, s72, 27648
  s_lshl_b32 s64, s68, 2
  s_add_u32 s64, s64, 2
  s_mul_i32 s65, s64, 19
  s_lshr_b32 s65, s65, 9
  s_mul_i32 s66, s65, 27
  s_sub_u32 s66, s64, s66
  s_mul_i32 s66, s66, 37
  s_lshr_b32 s66, s66, 8
  s_lshl_b32 s65, s65, 2
  s_add_u32 s65, s65, s66
  s_and_b32 s66, s65, 7
  s_lshl_b32 s66, s66, 2
  s_add_u32 m0, s73, 8192
  s_nop 0
  buffer_load_dwordx4 v20, s[44:47], s72 offen lds
  s_add_u32 s72, s72, 27648
  s_lshr_b32 s66, 0x10210210, s66
  s_and_b32 s66, s66, 15
  s_lshr_b32 s65, s65, 3
  s_mul_i32 s65, s65, 5
  s_add_u32 s65, s65, s66
  s_lshl_b32 s65, s65, 2
  s_mul_i32 s66, s70, 6
  s_add_u32 s66, s66, s69
  s_add_u32 s66, s66, 40
  s_sub_u32 s66, s66, s65
  s_mul_i32 s64, s64, 41
  s_add_u32 s65, s66, 0
  s_cmp_ge_u32 s65, 40
  s_cselect_b32 s67, 40, 0
  s_add_u32 m0, s73, 9216
  s_nop 0
  buffer_load_dwordx4 v20, s[44:47], s72 offen lds
  s_add_u32 s72, s72, 27648
  s_sub_u32 s65, s65, s67
  s_add_u32 s65, s65, s64
  s_lshl_b32 s65, s65, 10
  s_add_u32 s10, s65, 0xe00000
  s_add_u32 s65, s66, 2
  s_cmp_ge_u32 s65, 40
  s_cselect_b32 s67, 40, 0
  s_sub_u32 s65, s65, s67
  s_add_u32 s65, s65, s64
  s_lshl_b32 s65, s65, 10
  s_add_u32 s11, s65, 0xe00000
  s_add_u32 s65, s66, 4
  s_cmp_ge_u32 s65, 40
  s_cselect_b32 s67, 40, 0
  s_add_u32 m0, s73, 10240
  s_nop 0
  buffer_load_dwordx4 v20, s[44:47], s72 offen lds
  s_add_u32 s72, s72, 27648
  s_sub_u32 s65, s65, s67
  s_add_u32 s65, s65, s64
  s_lshl_b32 s65, s65, 10
  s_add_u32 s12, s65, 0xe00000
  s_cmp_eq_u32 s70, 6
  s_cselect_b32 s12, 0x40000000, s12
  s_cmp_ge_u32 s71, 378
  s_cselect_b32 s10, 0x40000000, s10
  s_cselect_b32 s11, 0x40000000, s11
  s_cselect_b32 s12, 0x40000000, s12
  s_lshl_b32 s64, s68, 2
  s_add_u32 s64, s64, 3
  s_mul_i32 s65, s64, 19
  s_lshr_b32 s65, s65, 9
  s_add_u32 m0, s73, 11264
  s_nop 0
  buffer_load_dwordx4 v20, s[44:47], s72 offen lds
  s_add_u32 s72, s72, 27648
  s_mul_i32 s66, s65, 27
  s_sub_u32 s66, s64, s66
  s_mul_i32 s66, s66, 37
  s_lshr_b32 s66, s66, 8
  s_lshl_b32 s65, s65, 2
  s_add_u32 s65, s65, s66
  s_and_b32 s66, s65, 7
  s_lshl_b32 s66, s66, 2
  s_lshr_b32 s66, 0x10210210, s66
  s_and_b32 s66, s66, 15
  s_lshr_b32 s65, s65, 3
  s_mul_i32 s65, s65, 5
  s_add_u32 s65, s65, s66
  s_lshl_b32 s65, s65, 2
  s_mov_b32 s22, 0x3f803f80
  s_waitcnt vmcnt(21)
  v_dot2_f32_bf16 v16, v128, s22, 0
  v_dot2_f32_bf16 v17, v128, v128, 0
  v_dot2_f32_bf16 v16, v129, s22, v16
  v_dot2_f32_bf16 v17, v129, v129, v17
  v_dot2_f32_bf16 v16, v130, s22, v16
  v_dot2_f32_bf16 v17, v130, v130, v17
  v_dot2_f32_bf16 v16, v131, s22, v16
  v_dot2_f32_bf16 v17, v131, v131, v17
  s_waitcnt vmcnt(20)
  v_dot2_f32_bf16 v16, v132, s22, v16
  v_dot2_f32_bf16 v17, v132, v132, v17
  v_dot2_f32_bf16 v16, v133, s22, v16
  v_dot2_f32_bf16 v17, v133, v133, v17
  v_dot2_f32_bf16 v16, v134, s22, v16
  v_dot2_f32_bf16 v17, v134, v134, v17
  v_dot2_f32_bf16 v16, v135, s22, v16
  v_dot2_f32_bf16 v17, v135, v135, v17
  s_waitcnt vmcnt(19)
  v_dot2_f32_bf16 v16, v136, s22, v16
  v_dot2_f32_bf16 v17, v136, v136, v17
  v_dot2_f32_bf16 v16, v137, s22, v16
  v_dot2_f32_bf16 v17, v137, v137, v17
  s_mov_b32 s23, 1664525
  s_waitcnt vmcnt(18)
  v_mul_lo_u32 v9, v9, s23
  v_add_u32 v2, 1013904223, v9
  s_nop 0
  v_readfirstlane_b32 s56, v2
  s_waitcnt vmcnt(17)
  v_dot2_f32_bf16 v4, v138, s22, 0
  v_dot2_f32_bf16 v5, v138, v138, 0
  v_dot2_f32_bf16 v4, v139, s22, v4
  v_dot2_f32_bf16 v5, v139, v139, v5
  v_dot2_f32_bf16 v4, v140, s22, v4
  v_dot2_f32_bf16 v5, v140, v140, v5
  v_dot2_f32_bf16 v4, v141, s22, v4
  v_dot2_f32_bf16 v5, v141, v141, v5
  s_waitcnt vmcnt(16)
  v_dot2_f32_bf16 v4, v142, s22, v4
  v_dot2_f32_bf16 v5, v142, v142, v5
  v_dot2_f32_bf16 v4, v143, s22, v4
  v_dot2_f32_bf16 v5, v143, v143, v5
  v_dot2_f32_bf16 v4, v144, s22, v4
  v_dot2_f32_bf16 v5, v144, v144, v5
  v_dot2_f32_bf16 v4, v145, s22, v4
  v_dot2_f32_bf16 v5, v145, v145, v5
  s_waitcnt vmcnt(15)
  v_dot2_f32_bf16 v4, v146, s22, v4
  v_dot2_f32_bf16 v5, v146, v146, v5
  v_dot2_f32_bf16 v4, v147, s22, v4
  v_dot2_f32_bf16 v5, v147, v147, v5
  s_waitcnt vmcnt(14)
  v_dot2_f32_bf16 v6, v148, s22, 0
  v_dot2_f32_bf16 v7, v148, v148, 0
  v_dot2_f32_bf16 v6, v149, s22, v6
  v_dot2_f32_bf16 v7, v149, v149, v7
  v_dot2_f32_bf16 v6, v150, s22, v6
  v_dot2_f32_bf16 v7, v150, v150, v7
  v_dot2_f32_bf16 v6, v151, s22, v6
  v_dot2_f32_bf16 v7, v151, v151, v7
  s_waitcnt vmcnt(13)
  v_dot2_f32_bf16 v6, v152, s22, v6
  v_dot2_f32_bf16 v7, v152, v152, v7
  v_dot2_f32_bf16 v6, v153, s22, v6
  v_dot2_f32_bf16 v7, v153, v153, v7
  v_dot2_f32_bf16 v6, v154, s22, v6
  v_dot2_f32_bf16 v7, v154, v154, v7
  v_dot2_f32_bf16 v6, v155, s22, v6
  v_dot2_f32_bf16 v7, v155, v155, v7
  s_waitcnt vmcnt(12)
  v_dot2_f32_bf16 v6, v156, s22, v6
  v_dot2_f32_bf16 v7, v156, v156, v7
  v_dot2_f32_bf16 v6, v157, s22, v6
  v_dot2_f32_bf16 v7, v157, v157, v7
  v_and_b32 v8, 15, v1
  v_cmp_eq_u32 vcc, 1, v8
  v_cmp_eq_u32 s[22:23], 2, v8
  v_add_f32 v16, v16, v16 row_ror:8
  v_add_f32 v17, v17, v17 row_ror:8
  v_add_f32 v4, v4, v4 row_ror:8
  v_add_f32 v5, v5, v5 row_ror:8
  v_add_f32 v6, v6, v6 row_ror:8
  v_add_f32 v7, v7, v7 row_ror:8
  v_add_f32 v16, v16, v16 row_ror:4
  v_add_f32 v17, v17, v17 row_ror:4
  v_add_f32 v4, v4, v4 row_ror:4
  v_add_f32 v5, v5, v5 row_ror:4
  v_add_f32 v6, v6, v6 row_ror:4
  v_add_f32 v7, v7, v7 row_ror:4
  v_add_f32 v16, v16, v16 row_ror:2
  v_add_f32 v17, v17, v17 row_ror:2
  v_add_f32 v4, v4, v4 row_ror:2
  v_add_f32 v5, v5, v5 row_ror:2
  v_add_f32 v6, v6, v6 row_ror:2
  v_add_f32 v7, v7, v7 row_ror:2
  v_add_f32 v16, v16, v16 row_ror:1
  v_add_f32 v17, v17, v17 row_ror:1
  v_add_f32 v4, v4, v4 row_ror:1
  v_add_f32 v5, v5, v5 row_ror:1
  v_add_f32 v6, v6, v6 row_ror:1
  v_add_f32 v7, v7, v7 row_ror:1
  v_cndmask_b32 v16, v16, v4, vcc
  v_cndmask_b32 v17, v17, v5, vcc
  v_cndmask_b32 v16, v16, v6, s[22:23]
  v_cndmask_b32 v17, v17, v7, s[22:23]
  v_mov_b32 v4, v16
  v_mov_b32 v5, v17
  s_nop 0
  v_permlane16_swap_b32 v16, v4
  v_permlane16_swap_b32 v17, v5
  v_add_f32 v16, v16, v4
  v_add_f32 v17, v17, v5
  v_mul_f32 v16, 0x3acccccd, v16
  v_mul_f32 v17, 0x3acccccd, v17
  v_fma_f32 v17, -v16, v16, v17
  v_max_f32 v17, 0, v17
  v_cvt_pk_bf16_f32 v17, v17, v17
  v_and_b32 v17, 0xffff0000, v17
  v_add_f32 v17, 0x3727c5ac, v17
  v_cvt_pk_bf16_f32 v17, v17, v17
  v_and_b32 v17, 0xffff0000, v17
  v_sqrt_f32 v17, v17
  s_nop 0
  v_cvt_pk_bf16_f32 v16, v16, v17
  v_mov_b32 v17, v2
  buffer_store_dwordx2 v[16:17], v14, s[36:39], 0 offen sc1
  s_mul_i32 s66, s70, 6
  s_add_u32 s66, s66, s69
  s_add_u32 s66, s66, 40
  s_sub_u32 s66, s66, s65
  s_mul_i32 s64, s64, 41
  s_add_u32 s65, s66, 0
  s_cmp_ge_u32 s65, 40
  s_cselect_b32 s67, 40, 0
  s_sub_u32 s65, s65, s67
  s_add_u32 s65, s65, s64
  s_lshl_b32 s65, s65, 10
  s_add_u32 s13, s65, 0xe00000
  s_add_u32 s65, s66, 2
  s_cmp_ge_u32 s65, 40
  s_cselect_b32 s67, 40, 0
  s_sub_u32 s65, s65, s67
  s_add_u32 s65, s65, s64
  s_lshl_b32 s65, s65, 10
  s_add_u32 s14, s65, 0xe00000
  s_add_u32 s65, s66, 4
  s_cmp_ge_u32 s65, 40
  s_cselect_b32 s67, 40, 0
  s_sub_u32 s65, s65, s67
  s_add_u32 s65, s65, s64
  s_lshl_b32 s65, s65, 10
  s_add_u32 s15, s65, 0xe00000
  s_cmp_eq_u32 s70, 6
  s_cselect_b32 s15, 0x40000000, s15
  s_cmp_ge_u32 s71, 378
  s_cselect_b32 s13, 0x40000000, s13
  s_cselect_b32 s14, 0x40000000, s14
  s_cselect_b32 s15, 0x40000000, s15
  v_lshrrev_b32 v24, 2, v1
  v_lshlrev_b32 v25, 7, v24
  v_and_b32 v26, 3, v1
  v_lshl_add_u32 v25, v26, 3, v25
  v_add_u32 v25, s73, v25
  v_bfe_u32 v24, v1, 3, 2
  v_bfe_u32 v26, v1, 2, 2
  v_mov_b32 v27, 0x3f803f80
  v_xor_b32 v23, 0, v24
  v_lshl_add_u32 v28, v23, 5, v25
  v_cmp_eq_u32 vcc, 0, v26
  s_nop 1
  v_cndmask_b32 v32, 0, v27, vcc
  v_mov_b32 v33, v32
  v_mov_b32 v34, v32
  v_mov_b32 v35, v32
  v_xor_b32 v23, 1, v24
  v_lshl_add_u32 v29, v23, 5, v25
  v_cmp_eq_u32 vcc, 1, v26
  s_nop 1
  v_cndmask_b32 v36, 0, v27, vcc
  v_mov_b32 v37, v36
  v_mov_b32 v38, v36
  v_mov_b32 v39, v36
  v_xor_b32 v23, 2, v24
  v_lshl_add_u32 v30, v23, 5, v25
  v_cmp_eq_u32 vcc, 2, v26
  s_nop 1
  v_cndmask_b32 v40, 0, v27, vcc
  v_mov_b32 v41, v40
  v_mov_b32 v42, v40
  v_mov_b32 v43, v40
  v_xor_b32 v23, 3, v24
  v_lshl_add_u32 v31, v23, 5, v25
  v_cmp_eq_u32 vcc, 3, v26
  s_nop 1
  v_cndmask_b32 v44, 0, v27, vcc
  v_mov_b32 v45, v44
  v_mov_b32 v46, v44
  v_mov_b32 v47, v44
  v_lshrrev_b32 v24, 4, v1
  v_mul_u32_u24 v24, 41984, v24
  v_and_b32 v26, 15, v1
  v_lshl_add_u32 v24, v26, 2, v24
  s_mul_i32 s64, s68, 167936
  s_lshl_b32 s65, s69, 9
  s_add_u32 s64, s64, s65
  s_lshl_b32 s65, s70, 6
  s_add_u32 s64, s64, s65
  s_add_u32 s64, s64, 0xe0a000
  s_cmp_ge_u32 s71, 378
  s_cselect_b32 s16, 0x40000000, s64
  s_cmp_eq_u32 s70, 6
  s_cselect_b32 s17, s16, 0x40000000
  s_lshl_b32 s66, s71, 5
  s_add_u32 s18, s66, 0x40000
  s_mov_b32 s48, s28
  s_mov_b32 s49, s29
  s_mov_b32 s50, 0x21c000
  s_mov_b32 s51, 0x00020000
  s_mul_i32 s64, s58, 7
  s_add_u32 s77, s64, s74
  s_lshr_b32 s64, s58, 1
  s_mul_i32 s65, s64, 14
  s_sub_u32 s65, s77, s65
  s_mul_i32 s64, s64, 27
  s_and_b32 s66, s65, 1
  s_mul_i32 s66, s66, 14
  s_add_u32 s64, s64, s66
  s_lshr_b32 s66, s65, 1
  s_add_u32 s64, s64, s66
  s_cmp_eq_u32 s65, 13
  s_cselect_b32 s66, 0, 7
  s_lshr_b32 s65, s57, 1
  s_mul_i32 s66, s66, s65
  s_add_u32 s64, s64, s66
  s_lshl_b32 s64, s64, 1
  s_and_b32 s65, s57, 1
  s_add_u32 s64, s64, s65
  s_mul_i32 s75, s64, 10240
  s_cmp_ge_u32 s74, 7
  s_cselect_b32 s75, 0x40000000, s75
  s_lshl_b32 s79, s65, 2
  s_mul_i32 s76, s57, 10240
  s_add_u32 s76, s76, 49152
  s_waitcnt vmcnt(9)
  ds_read_b64_tr_b16 v[96:97], v28 offset:0
  ds_read_b64_tr_b16 v[98:99], v28 offset:2048
  ds_read_b64_tr_b16 v[100:101], v29 offset:0
  ds_read_b64_tr_b16 v[102:103], v29 offset:2048
  ds_read_b64_tr_b16 v[104:105], v30 offset:0
  ds_read_b64_tr_b16 v[106:107], v30 offset:2048
  ds_read_b64_tr_b16 v[108:109], v31 offset:0
  ds_read_b64_tr_b16 v[110:111], v31 offset:2048
  s_waitcnt lgkmcnt(6)
  buffer_store_dwordx4 v[96:99], v3, s[36:39], s4 offen sc1
  v_mfma_f32_16x16x32_bf16 v[48:51], v[32:35], v[96:99], 0
  s_waitcnt lgkmcnt(4)
  buffer_store_dwordx4 v[100:103], v3, s[36:39], s7 offen sc1
  v_mfma_f32_16x16x32_bf16 v[48:51], v[36:39], v[100:103], v[48:51]
  s_waitcnt lgkmcnt(2)
  buffer_store_dwordx4 v[104:107], v3, s[36:39], s10 offen sc1
  v_mfma_f32_16x16x32_bf16 v[48:51], v[40:43], v[104:107], v[48:51]
  s_waitcnt lgkmcnt(0)
  buffer_store_dwordx4 v[108:111], v3, s[36:39], s13 offen sc1
  v_mfma_f32_16x16x32_bf16 v[48:51], v[44:47], v[108:111], v[48:51]
  s_waitcnt vmcnt(9)
  ds_read_b64_tr_b16 v[112:113], v28 offset:4096
  ds_read_b64_tr_b16 v[114:115], v28 offset:6144
  ds_read_b64_tr_b16 v[116:117], v29 offset:4096
  ds_read_b64_tr_b16 v[118:119], v29 offset:6144
  ds_read_b64_tr_b16 v[120:121], v30 offset:4096
  ds_read_b64_tr_b16 v[122:123], v30 offset:6144
  ds_read_b64_tr_b16 v[124:125], v31 offset:4096
  ds_read_b64_tr_b16 v[126:127], v31 offset:6144
  s_waitcnt lgkmcnt(6)
  buffer_store_dwordx4 v[112:115], v3, s[36:39], s5 offen sc1
  v_mfma_f32_16x16x32_bf16 v[48:51], v[32:35], v[112:115], v[48:51]
  s_waitcnt lgkmcnt(4)
  buffer_store_dwordx4 v[116:119], v3, s[36:39], s8 offen sc1
  v_mfma_f32_16x16x32_bf16 v[48:51], v[36:39], v[116:119], v[48:51]
  s_waitcnt lgkmcnt(2)
  buffer_store_dwordx4 v[120:123], v3, s[36:39], s11 offen sc1
  v_mfma_f32_16x16x32_bf16 v[48:51], v[40:43], v[120:123], v[48:51]
  s_waitcnt lgkmcnt(0)
  buffer_store_dwordx4 v[124:127], v3, s[36:39], s14 offen sc1
  v_mfma_f32_16x16x32_bf16 v[48:51], v[44:47], v[124:127], v[48:51]
  s_waitcnt vmcnt(9)
  ds_read_b64_tr_b16 v[128:129], v28 offset:8192
  ds_read_b64_tr_b16 v[130:131], v28 offset:10240
  ds_read_b64_tr_b16 v[132:133], v29 offset:8192
  ds_read_b64_tr_b16 v[134:135], v29 offset:10240
  ds_read_b64_tr_b16 v[136:137], v30 offset:8192
  ds_read_b64_tr_b16 v[138:139], v30 offset:10240
  ds_read_b64_tr_b16 v[140:141], v31 offset:8192
  ds_read_b64_tr_b16 v[142:143], v31 offset:10240
  s_waitcnt lgkmcnt(6)
  buffer_store_dwordx4 v[128:131], v3, s[36:39], s6 offen sc1
  v_mfma_f32_16x16x32_bf16 v[48:51], v[32:35], v[128:131], v[48:51]
  s_waitcnt lgkmcnt(4)
  buffer_store_dwordx4 v[132:135], v3, s[36:39], s9 offen sc1
  v_mfma_f32_16x16x32_bf16 v[48:51], v[36:39], v[132:135], v[48:51]
  s_waitcnt lgkmcnt(2)
  buffer_store_dwordx4 v[136:139], v3, s[36:39], s12 offen sc1
  v_mfma_f32_16x16x32_bf16 v[48:51], v[40:43], v[136:139], v[48:51]
  s_waitcnt lgkmcnt(0)
  buffer_store_dwordx4 v[140:143], v3, s[36:39], s15 offen sc1
  v_mfma_f32_16x16x32_bf16 v[48:51], v[44:47], v[140:143], v[48:51]
  s_nop 7
  v_cvt_pk_bf16_f32 v52, v48, v48
  v_and_b32 v52, 0xffff0000, v52
  v_sub_f32 v53, v48, v52
  v_cvt_pk_bf16_f32 v52, v52, v53
  v_mov_b32 v53, 0
  buffer_store_dword v52, v24, s[36:39], s16 offen sc1
  buffer_store_dword v53, v24, s[36:39], s17 offen offset:64 sc1
  s_cmp_ge_u32 s74, 7
  s_cbranch_scc1 sequential_preLN__ssm_conv_s4__geglu_ffn__prompt_kernel_dx5
  v_add_u32 v56, 0, v1
  v_mul_u32_u24 v57, 205, v56
  v_bfe_u32 v57, v57, 14, 2
  v_or_b32 v57, s79, v57
  v_lshlrev_b32 v57, 5, v57
  v_lshlrev_b32 v56, 4, v56
  v_xor_b32 v56, v56, v57
  s_add_u32 m0, s76, 0
  s_nop 0
  buffer_load_dwordx4 v56, s[48:51], s75 offen lds
  v_add_u32 v58, 64, v1
  v_mul_u32_u24 v59, 205, v58
  v_bfe_u32 v59, v59, 14, 2
  v_or_b32 v59, s79, v59
  v_lshlrev_b32 v59, 5, v59
  v_lshlrev_b32 v58, 4, v58
  v_xor_b32 v58, v58, v59
  s_add_u32 m0, s76, 1024
  s_nop 0
  buffer_load_dwordx4 v58, s[48:51], s75 offen lds
  v_add_u32 v56, 128, v1
  v_mul_u32_u24 v57, 205, v56
  v_bfe_u32 v57, v57, 14, 2
  v_or_b32 v57, s79, v57
  v_lshlrev_b32 v57, 5, v57
  v_lshlrev_b32 v56, 4, v56
  v_xor_b32 v56, v56, v57
  s_add_u32 m0, s76, 2048
  s_nop 0
  buffer_load_dwordx4 v56, s[48:51], s75 offen lds
  v_add_u32 v58, 192, v1
  v_mul_u32_u24 v59, 205, v58
  v_bfe_u32 v59, v59, 14, 2
  v_or_b32 v59, s79, v59
  v_lshlrev_b32 v59, 5, v59
  v_lshlrev_b32 v58, 4, v58
  v_xor_b32 v58, v58, v59
  s_add_u32 m0, s76, 3072
  s_nop 0
  buffer_load_dwordx4 v58, s[48:51], s75 offen lds
  v_add_u32 v56, 256, v1
  v_mul_u32_u24 v57, 205, v56
  v_bfe_u32 v57, v57, 14, 2
  v_or_b32 v57, s79, v57
  v_lshlrev_b32 v57, 5, v57
  v_lshlrev_b32 v56, 4, v56
  v_xor_b32 v56, v56, v57
  s_add_u32 m0, s76, 4096
  s_nop 0
  buffer_load_dwordx4 v56, s[48:51], s75 offen lds
  v_add_u32 v58, 320, v1
  v_mul_u32_u24 v59, 205, v58
  v_bfe_u32 v59, v59, 14, 2
  v_or_b32 v59, s79, v59
  v_lshlrev_b32 v59, 5, v59
  v_lshlrev_b32 v58, 4, v58
  v_xor_b32 v58, v58, v59
  s_add_u32 m0, s76, 5120
  s_nop 0
  buffer_load_dwordx4 v58, s[48:51], s75 offen lds
  v_add_u32 v56, 384, v1
  v_mul_u32_u24 v57, 205, v56
  v_bfe_u32 v57, v57, 14, 2
  v_or_b32 v57, s79, v57
  v_lshlrev_b32 v57, 5, v57
  v_lshlrev_b32 v56, 4, v56
  v_xor_b32 v56, v56, v57
  s_add_u32 m0, s76, 6144
  s_nop 0
  buffer_load_dwordx4 v56, s[48:51], s75 offen lds
  v_add_u32 v58, 448, v1
  v_mul_u32_u24 v59, 205, v58
  v_bfe_u32 v59, v59, 14, 2
  v_or_b32 v59, s79, v59
  v_lshlrev_b32 v59, 5, v59
  v_lshlrev_b32 v58, 4, v58
  v_xor_b32 v58, v58, v59
  s_add_u32 m0, s76, 7168
  s_nop 0
  buffer_load_dwordx4 v58, s[48:51], s75 offen lds
  v_add_u32 v56, 512, v1
  v_mul_u32_u24 v57, 205, v56
  v_bfe_u32 v57, v57, 14, 2
  v_or_b32 v57, s79, v57
  v_lshlrev_b32 v57, 5, v57
  v_lshlrev_b32 v56, 4, v56
  v_xor_b32 v56, v56, v57
  s_add_u32 m0, s76, 8192
  s_nop 0
  buffer_load_dwordx4 v56, s[48:51], s75 offen lds
  v_add_u32 v58, 576, v1
  v_mul_u32_u24 v59, 205, v58
  v_bfe_u32 v59, v59, 14, 2
  v_or_b32 v59, s79, v59
  v_lshlrev_b32 v59, 5, v59
  v_lshlrev_b32 v58, 4, v58
  v_xor_b32 v58, v58, v59
  s_add_u32 m0, s76, 9216
  s_nop 0
  buffer_load_dwordx4 v58, s[48:51], s75 offen lds
  v_lshrrev_b32 v24, 4, v1
  v_mul_u32_u24 v25, 10240, v24
  v_bfe_u32 v26, v1, 2, 2
  v_mul_u32_u24 v27, 1280, v26
  v_add_u32 v25, v25, v27
  v_and_b32 v27, 3, v1
  v_lshl_add_u32 v25, v27, 3, v25
  v_and_b32 v24, 1, v24
  v_lshl_or_b32 v24, v24, 2, v26
  s_lshl_b32 s64, s57, 1
  v_xor_b32 v24, s64, v24
  v_lshl_add_u32 v25, v24, 5, v25
  v_add_u32 v25, 49152, v25
  v_xor_b32 v26, 32, v25
  s_mul_i32 s64, s77, 40960
  s_lshl_b32 s65, s57, 11
  s_add_u32 s64, s64, s65
  s_add_u32 s64, s64, 0xb00000
  s_lshl_b32 s67, s77, 2
  s_add_u32 s67, s67, s57
  s_lshl_b32 s67, s67, 5
  s_add_u32 s67, s67, 0x4c000
  s_waitcnt vmcnt(10)
  buffer_store_dword v2, v15, s[36:39], s18 offen offset:0 sc1
  s_waitcnt vmcnt(1)
  s_barrier
  ds_read_b64_tr_b16 v[160:161], v25 offset:0
  ds_read_b64_tr_b16 v[162:163], v25 offset:5120
  ds_read_b64_tr_b16 v[164:165], v26 offset:0
  ds_read_b64_tr_b16 v[166:167], v26 offset:5120
  ds_read_b64_tr_b16 v[168:169], v25 offset:256
  ds_read_b64_tr_b16 v[170:171], v25 offset:5376
  ds_read_b64_tr_b16 v[172:173], v26 offset:256
  ds_read_b64_tr_b16 v[174:175], v26 offset:5376
  ds_read_b64_tr_b16 v[176:177], v25 offset:512
  ds_read_b64_tr_b16 v[178:179], v25 offset:5632
  ds_read_b64_tr_b16 v[180:181], v26 offset:512
  ds_read_b64_tr_b16 v[182:183], v26 offset:5632
  ds_read_b64_tr_b16 v[184:185], v25 offset:768
  ds_read_b64_tr_b16 v[186:187], v25 offset:5888
  ds_read_b64_tr_b16 v[188:189], v26 offset:768
  ds_read_b64_tr_b16 v[190:191], v26 offset:5888
  ds_read_b64_tr_b16 v[192:193], v25 offset:1024
  ds_read_b64_tr_b16 v[194:195], v25 offset:6144
  ds_read_b64_tr_b16 v[196:197], v26 offset:1024
  ds_read_b64_tr_b16 v[198:199], v26 offset:6144
  s_waitcnt lgkmcnt(15)
  buffer_store_dwordx4 v[160:163], v3, s[36:39], s64 offen offset:0 sc1
  buffer_store_dwordx4 v[164:167], v3, s[36:39], s64 offen offset:1024 sc1
  s_add_u32 s64, s64, 8192
  s_waitcnt lgkmcnt(14)
  buffer_store_dwordx4 v[168:171], v3, s[36:39], s64 offen offset:0 sc1
  s_waitcnt lgkmcnt(12)
  buffer_store_dwordx4 v[172:175], v3, s[36:39], s64 offen offset:1024 sc1
  s_add_u32 s64, s64, 8192
  s_waitcnt lgkmcnt(10)
  buffer_store_dwordx4 v[176:179], v3, s[36:39], s64 offen offset:0 sc1
  s_waitcnt lgkmcnt(8)
  buffer_store_dwordx4 v[180:183], v3, s[36:39], s64 offen offset:1024 sc1
  s_add_u32 s64, s64, 8192
  s_waitcnt lgkmcnt(6)
  buffer_store_dwordx4 v[184:187], v3, s[36:39], s64 offen offset:0 sc1
  s_waitcnt lgkmcnt(4)
  buffer_store_dwordx4 v[188:191], v3, s[36:39], s64 offen offset:1024 sc1
  s_add_u32 s64, s64, 8192
  s_waitcnt lgkmcnt(2)
  buffer_store_dwordx4 v[192:195], v3, s[36:39], s64 offen offset:0 sc1
  s_waitcnt lgkmcnt(0)
  buffer_store_dwordx4 v[196:199], v3, s[36:39], s64 offen offset:1024 sc1
  s_waitcnt vmcnt(0)
  buffer_store_dword v2, v15, s[36:39], s67 offen offset:0 sc1
  s_branch sequential_preLN__ssm_conv_s4__geglu_ffn__prompt_kernel_de6
sequential_preLN__ssm_conv_s4__geglu_ffn__prompt_kernel_dx5:
  s_mul_i32 s19, s58, 5
  s_add_u32 s19, s19, s74
  s_sub_u32 s19, s19, 7
  s_lshl2_add_u32 s19, s19, s57
  s_lshl_b32 s78, s19, 2
  s_add_u32 s78, s78, 0x50000
  s_lshl_b32 s19, s19, 14
  s_add_u32 s19, s19, 0x100000
  v_mov_b32 v60, -1
  v_mov_b32 v61, -1
  v_mov_b32 v62, -1
  v_mov_b32 v63, -1
  buffer_store_dwordx4 v[60:63], v3, s[36:39], s19 offen offset:0 sc1
  buffer_store_dwordx4 v[60:63], v3, s[36:39], s19 offen offset:1024 sc1
  buffer_store_dwordx4 v[60:63], v3, s[36:39], s19 offen offset:2048 sc1
  buffer_store_dwordx4 v[60:63], v3, s[36:39], s19 offen offset:3072 sc1
  s_add_u32 s19, s19, 4096
  buffer_store_dwordx4 v[60:63], v3, s[36:39], s19 offen offset:0 sc1
  buffer_store_dwordx4 v[60:63], v3, s[36:39], s19 offen offset:1024 sc1
  buffer_store_dwordx4 v[60:63], v3, s[36:39], s19 offen offset:2048 sc1
  buffer_store_dwordx4 v[60:63], v3, s[36:39], s19 offen offset:3072 sc1
  s_add_u32 s19, s19, 4096
  buffer_store_dwordx4 v[60:63], v3, s[36:39], s19 offen offset:0 sc1
  buffer_store_dwordx4 v[60:63], v3, s[36:39], s19 offen offset:1024 sc1
  buffer_store_dwordx4 v[60:63], v3, s[36:39], s19 offen offset:2048 sc1
  buffer_store_dwordx4 v[60:63], v3, s[36:39], s19 offen offset:3072 sc1
  s_add_u32 s19, s19, 4096
  buffer_store_dwordx4 v[60:63], v3, s[36:39], s19 offen offset:0 sc1
  buffer_store_dwordx4 v[60:63], v3, s[36:39], s19 offen offset:1024 sc1
  buffer_store_dwordx4 v[60:63], v3, s[36:39], s19 offen offset:2048 sc1
  buffer_store_dwordx4 v[60:63], v3, s[36:39], s19 offen offset:3072 sc1
  s_waitcnt vmcnt(16)
  buffer_store_dword v2, v15, s[36:39], s18 offen offset:0 sc1
  s_waitcnt vmcnt(1)
  buffer_store_dword v2, v15, s[36:39], s78 offen offset:0 sc1
sequential_preLN__ssm_conv_s4__geglu_ffn__prompt_kernel_de6:
  s_barrier
  s_lshr_b32 s64, s58, 1
  s_and_b32 s65, s59, 3
  s_sub_u32 s65, 3, s65
  s_lshl_b32 s65, s65, 2
  s_add_u32 s61, s64, s65
  s_add_u32 s64, s64, 1
  s_and_b32 s64, s64, 3
  s_add_u32 s4, s64, s65
  s_and_b32 s64, s58, 1
  s_lshl1_add_u32 s4, s4, s64
  s_lshl_b32 s64, s64, 3
  s_lshr_b32 s5, s59, 2
  s_add_u32 s62, s64, s5
  s_mul_i32 s64, s62, 7
  s_lshr_b32 s65, s62, 2
  s_sub_u32 s7, s64, s65
  s_mul_i32 s63, s7, 41984
  s_lshl_b32 s6, s57, 12
  s_add_u32 s63, s63, s6
  s_add_u32 s63, s63, 0xe00000
  s_mul_i32 s65, s57, 14
  s_mul_i32 s64, s65, 40960
  s_mul_i32 s25, s5, 5120
  s_add_u32 s79, s64, s25
  v_add_u32 v0, s79, v3
  s_movk_i32 s100, 4096
  s_lshl_b32 s65, s65, 2
  v_min_u32 v13, 55, v1
  v_add_u32 v13, s65, v13
  v_lshlrev_b32 v13, 5, v13
  s_lshr_b32 s64, s7, 2
  s_mul_i32 s64, s64, 14
  s_add_u32 s25, s7, 6
  s_lshr_b32 s25, s25, 2
  s_min_u32 s25, s25, 26
  s_mul_i32 s25, s25, 14
  s_add_u32 s25, s25, 13
  v_add_u32 v12, s64, v1
  v_min_u32 v12, s25, v12
  v_lshlrev_b32 v12, 5, v12
  s_mov_b32 s18, 0x40000
  s_mov_b32 s19, 0x4c000
  v_bfe_u32 v4, v1, 4, 1
  v_mul_u32_u24 v8, 55296, v4
  v_and_b32 v4, 15, v1
  v_lshl_add_u32 v8, v4, 5, v8
  v_lshrrev_b32 v4, 5, v1
  v_lshl_add_u32 v8, v4, 4, v8
  s_lshl_b32 s64, s61, 3
  s_lshl_b32 s65, s57, 1
  s_add_u32 s64, s64, s65
  s_mul_i32 s68, s64, 55296
  s_lshl_b32 s65, s7, 9
  s_add_u32 s68, s68, s65
  s_add_u32 s68, s68, 0x400000
  s_and_b32 s65, s62, 3
  s_cmp_eq_u32 s65, 3
  s_cselect_b32 s66, 0x40000000, s68
  v_min_u32 v19, 39, v1
  v_lshlrev_b32 v19, 4, v19
  s_mov_b32 s24, 0x50000
  s_add_u32 s44, s34, 0xb00000
  s_addc_u32 s45, s35, 0
  s_mov_b32 s46, 0x230000
  s_mov_b32 s47, 0x00020000
  s_add_u32 s48, s34, 0x400000
  s_addc_u32 s49, s35, 0
  s_mov_b32 s50, 0x6c0000
  s_mov_b32 s51, 0x00020000
  buffer_load_dword v14, v12, s[36:39], s18 offen offset:0 sc1
  s_waitcnt vmcnt(0)
  v_cmp_ne_u32 vcc, s56, v14
  s_mov_b32 s26, 0
  s_cbranch_vccz sequential_preLN__ssm_conv_s4__geglu_ffn__prompt_kernel_fw7_ok
sequential_preLN__ssm_conv_s4__geglu_ffn__prompt_kernel_fw7:
  buffer_load_dword v14, v12, s[36:39], s18 offen offset:0 sc1
  s_add_u32 s26, s26, 1
  s_waitcnt vmcnt(0)
  v_cmp_ne_u32 vcc, s56, v14
  s_cmp_gt_u32 s26, 0x40000
  s_cbranch_scc1 sequential_preLN__ssm_conv_s4__geglu_ffn__prompt_kernel_fw7_ok
  s_cbranch_vccnz sequential_preLN__ssm_conv_s4__geglu_ffn__prompt_kernel_fw7
sequential_preLN__ssm_conv_s4__geglu_ffn__prompt_kernel_fw7_ok:
  s_add_u32 s27, s63, 0
  s_add_u32 m0, s6, 0
  s_nop 0
  buffer_load_dwordx4 v3, s[36:39], s27 offen offset:0 sc1 lds
  buffer_load_dwordx4 v3, s[36:39], s27 offen offset:1024 sc1 lds
  buffer_load_dwordx4 v3, s[36:39], s27 offen offset:2048 sc1 lds
  buffer_load_dwordx4 v3, s[36:39], s27 offen offset:3072 sc1 lds
  s_add_u32 s27, s63, 16384
  s_add_u32 m0, s6, 16384
  s_nop 0
  buffer_load_dwordx4 v3, s[36:39], s27 offen offset:0 sc1 lds
  buffer_load_dwordx4 v3, s[36:39], s27 offen offset:1024 sc1 lds
  buffer_load_dwordx4 v3, s[36:39], s27 offen offset:2048 sc1 lds
  buffer_load_dwordx4 v3, s[36:39], s27 offen offset:3072 sc1 lds
  s_add_u32 s27, s63, 32768
  s_add_u32 m0, s6, 32768
  s_nop 0
  buffer_load_dwordx4 v3, s[36:39], s27 offen offset:0 sc1 lds
  buffer_load_dwordx4 v3, s[36:39], s27 offen offset:1024 sc1 lds
  buffer_load_dwordx4 v3, s[36:39], s27 offen offset:2048 sc1 lds
  buffer_load_dwordx4 v3, s[36:39], s27 offen offset:3072 sc1 lds
  s_add_u32 s27, s63, 49152
  s_add_u32 m0, s6, 49152
  s_nop 0
  buffer_load_dwordx4 v3, s[36:39], s27 offen offset:0 sc1 lds
  buffer_load_dwordx4 v3, s[36:39], s27 offen offset:1024 sc1 lds
  buffer_load_dwordx4 v3, s[36:39], s27 offen offset:2048 sc1 lds
  buffer_load_dwordx4 v3, s[36:39], s27 offen offset:3072 sc1 lds
  s_add_u32 s27, s63, 65536
  s_add_u32 m0, s6, 65536
  s_nop 0
  buffer_load_dwordx4 v3, s[36:39], s27 offen offset:0 sc1 lds
  buffer_load_dwordx4 v3, s[36:39], s27 offen offset:1024 sc1 lds
  buffer_load_dwordx4 v3, s[36:39], s27 offen offset:2048 sc1 lds
  buffer_load_dwordx4 v3, s[36:39], s27 offen offset:3072 sc1 lds
  s_add_u32 s27, s63, 81920
  s_add_u32 m0, s6, 81920
  s_nop 0
  buffer_load_dwordx4 v3, s[36:39], s27 offen offset:0 sc1 lds
  buffer_load_dwordx4 v3, s[36:39], s27 offen offset:1024 sc1 lds
  buffer_load_dwordx4 v3, s[36:39], s27 offen offset:2048 sc1 lds
  buffer_load_dwordx4 v3, s[36:39], s27 offen offset:3072 sc1 lds
  s_add_u32 s27, s63, 98304
  s_add_u32 m0, s6, 98304
  s_nop 0
  buffer_load_dwordx4 v3, s[36:39], s27 offen offset:0 sc1 lds
  buffer_load_dwordx4 v3, s[36:39], s27 offen offset:1024 sc1 lds
  buffer_load_dwordx4 v3, s[36:39], s27 offen offset:2048 sc1 lds
  buffer_load_dwordx4 v3, s[36:39], s27 offen offset:3072 sc1 lds
  s_and_b32 s64, s4, -2
  s_lshr_b32 s65, s62, 2
  s_lshl1_add_u32 s65, s64, s65
  s_lshl_b32 s64, s61, 2
  s_mul_i32 s75, s65, 40960
  s_and_b32 s65, s62, 3
  s_lshl_b32 s65, s65, 6
  s_add_u32 s75, s75, s65
  s_mul_i32 s65, s57, 10240
  s_add_u32 s75, s75, s65
  s_add_u32 s75, s75, 0x100000
  s_add_u32 s76, s75, 4096
  s_add_u32 s77, s75, 8192
  s_add_u32 s64, s64, s57
  s_mul_i32 s64, s64, 40960
  s_add_u32 s64, s64, 0x100000
  s_and_b32 s21, s62, 7
  s_lshl_b32 s21, s21, 2
  s_lshr_b32 s21, 0x10210210, s21
  s_and_b32 s21, s21, 15
  s_lshr_b32 s20, s62, 3
  s_mul_i32 s20, s20, 5
  s_add_u32 s20, s20, s21
  s_add_u32 s65, s20, 0
  s_cmp_ge_u32 s65, 10
  s_cselect_b32 s21, 10, 0
  s_sub_u32 s65, s65, s21
  s_lshl_b32 s65, s65, 12
  s_add_u32 s8, s65, s64
  s_add_u32 s65, s20, 1
  s_cmp_ge_u32 s65, 10
  s_cselect_b32 s21, 10, 0
  s_sub_u32 s65, s65, s21
  s_lshl_b32 s65, s65, 12
  s_add_u32 s9, s65, s64
  s_add_u32 s65, s20, 2
  s_cmp_ge_u32 s65, 10
  s_cselect_b32 s21, 10, 0
  s_sub_u32 s65, s65, s21
  s_lshl_b32 s65, s65, 12
  s_add_u32 s10, s65, s64
  s_add_u32 s65, s20, 3
  s_cmp_ge_u32 s65, 10
  s_cselect_b32 s21, 10, 0
  s_sub_u32 s65, s65, s21
  s_lshl_b32 s65, s65, 12
  s_add_u32 s11, s65, s64
  s_add_u32 s65, s20, 4
  s_cmp_ge_u32 s65, 10
  s_cselect_b32 s21, 10, 0
  s_sub_u32 s65, s65, s21
  s_lshl_b32 s65, s65, 12
  s_add_u32 s12, s65, s64
  s_add_u32 s65, s20, 5
  s_cmp_ge_u32 s65, 10
  s_cselect_b32 s21, 10, 0
  s_sub_u32 s65, s65, s21
  s_lshl_b32 s65, s65, 12
  s_add_u32 s13, s65, s64
  s_add_u32 s65, s20, 6
  s_cmp_ge_u32 s65, 10
  s_cselect_b32 s21, 10, 0
  s_sub_u32 s65, s65, s21
  s_lshl_b32 s65, s65, 12
  s_add_u32 s14, s65, s64
  s_add_u32 s65, s20, 7
  s_cmp_ge_u32 s65, 10
  s_cselect_b32 s21, 10, 0
  s_sub_u32 s65, s65, s21
  s_lshl_b32 s65, s65, 12
  s_add_u32 s15, s65, s64
  s_add_u32 s65, s20, 8
  s_cmp_ge_u32 s65, 10
  s_cselect_b32 s21, 10, 0
  s_sub_u32 s65, s65, s21
  s_lshl_b32 s65, s65, 12
  s_add_u32 s16, s65, s64
  s_add_u32 s65, s20, 9
  s_cmp_ge_u32 s65, 10
  s_cselect_b32 s21, 10, 0
  s_sub_u32 s65, s65, s21
  s_lshl_b32 s65, s65, 12
  s_add_u32 s17, s65, s64
  v_lshrrev_b32 v22, 2, v1
  v_and_b32 v23, 3, v1
  v_lshlrev_b32 v9, 8, v22
  v_lshl_add_u32 v9, v23, 4, v9
  v_lshrrev_b32 v22, 5, v1
  v_lshl_add_u32 v10, v22, 30, v9
  s_waitcnt vmcnt(0)
  buffer_load_dwordx4 v[24:27], v19, s[36:39], s24 offen sc1
  buffer_load_dword v14, v13, s[36:39], s19 offen offset:0 sc1
  s_waitcnt vmcnt(1)
  v_cmp_ne_u32 vcc, s56, v24
  v_cmp_ne_u32 s[22:23], s56, v25
  v_cmp_ne_u32 s[98:99], s56, v26
  s_or_b64 vcc, vcc, s[22:23]
  v_cmp_ne_u32 s[22:23], s56, v27
  s_or_b64 vcc, vcc, s[98:99]
  s_or_b64 vcc, vcc, s[22:23]
  s_cbranch_vccnz sequential_preLN__ssm_conv_s4__geglu_ffn__prompt_kernel_hw8
sequential_preLN__ssm_conv_s4__geglu_ffn__prompt_kernel_hw8_b:
  s_waitcnt vmcnt(0)
  v_cmp_ne_u32 vcc, s56, v14
  s_mov_b32 s26, 0
  s_cbranch_vccz sequential_preLN__ssm_conv_s4__geglu_ffn__prompt_kernel_fw9_ok
sequential_preLN__ssm_conv_s4__geglu_ffn__prompt_kernel_fw9:
  buffer_load_dword v14, v13, s[36:39], s19 offen offset:0 sc1
  s_add_u32 s26, s26, 1
  s_waitcnt vmcnt(0)
  v_cmp_ne_u32 vcc, s56, v14
  s_cmp_gt_u32 s26, 0x40000
  s_cbranch_scc1 sequential_preLN__ssm_conv_s4__geglu_ffn__prompt_kernel_fw9_ok
  s_cbranch_vccnz sequential_preLN__ssm_conv_s4__geglu_ffn__prompt_kernel_fw9
sequential_preLN__ssm_conv_s4__geglu_ffn__prompt_kernel_fw9_ok:
  buffer_load_dwordx4 a[252:255], v0, s[44:47], 0 offen offset:0 sc1
  buffer_load_dwordx4 a[248:251], v0, s[44:47], 0 offen offset:1024 sc1
  buffer_load_dwordx4 a[244:247], v0, s[44:47], 0 offen offset:2048 sc1
  buffer_load_dwordx4 a[240:243], v0, s[44:47], 0 offen offset:3072 sc1
  buffer_load_dwordx4 a[236:239], v0, s[44:47], s100 offen sc1
  v_add_u32 v0, 40960, v0
  buffer_load_dwordx4 a[232:235], v0, s[44:47], 0 offen offset:0 sc1
  buffer_load_dwordx4 a[228:231], v0, s[44:47], 0 offen offset:1024 sc1
  buffer_load_dwordx4 a[224:227], v0, s[44:47], 0 offen offset:2048 sc1
  buffer_load_dwordx4 a[220:223], v0, s[44:47], 0 offen offset:3072 sc1
  buffer_load_dwordx4 a[216:219], v0, s[44:47], s100 offen sc1
  v_add_u32 v0, 40960, v0
  buffer_load_dwordx4 a[212:215], v0, s[44:47], 0 offen offset:0 sc1
  buffer_load_dwordx4 a[208:211], v0, s[44:47], 0 offen offset:1024 sc1
  s_barrier
sequential_preLN__ssm_conv_s4__geglu_ffn__prompt_kernel_join:
  buffer_load_dwordx4 v[96:99], v3, s[36:39], s8 offen offset:0 sc1
  v_add_u32 v4, 0x10000, v3
  v_add_u32 v5, 0x20000, v3
  v_and_b32 v20, 15, v1
  v_lshrrev_b32 v21, 4, v1
  v_lshlrev_b32 v14, 4, v20
  v_lshlrev_b32 v7, 7, v21
  v_lshl_add_u32 v7, v20, 2, v7
  v_and_b32 v22, 1, v21
  v_lshrrev_b32 v23, 1, v21
  v_mul_u32_u24 v28, 3584, v23
  v_lshl_add_u32 v28, v20, 5, v28
  buffer_load_dwordx4 v[100:103], v3, s[36:39], s8 offen offset:1024 sc1
  v_lshl_add_u32 v28, v22, 4, v28
  v_lshl_add_u32 v29, v23, 30, v28
  v_and_b32 v23, 3, v1
  v_and_b32 v13, 7, v1
  v_lshlrev_b32 v13, 3, v13
  v_add_u32 v12, 147456, v13
  v_cmp_lt_u32 vcc, 7, v1
  v_mov_b32 v22, 0x40000000
  s_nop 0
  v_cndmask_b32 v13, v13, v22, vcc
  s_lshl_b32 s64, s57, 6
  s_add_u32 s64, s64, 147456
  v_lshl_add_u32 v11, v23, 4, s64
  buffer_load_dwordx4 v[104:107], v3, s[36:39], s8 offen offset:2048 sc1
  v_lshl_add_u32 v11, v21, 2, v11
  v_mov_b32 v22, 0
  v_accvgpr_write_b32 a34, v22
  v_accvgpr_write_b32 a35, v22
  v_accvgpr_write_b32 a38, v22
  v_accvgpr_write_b32 a39, v22
  v_mov_b32 v92, -1
  v_mov_b32 v93, -1
  v_mov_b32 v94, -1
  v_mov_b32 v95, -1
  s_lshl_b32 s64, s61, 10
  s_lshl_b32 s65, s57, 8
  buffer_load_dwordx4 v[108:111], v3, s[36:39], s8 offen offset:3072 sc1
  s_add_u32 s69, s64, s65
  s_add_u32 s69, s69, 0xa000
  s_lshl_b32 s65, s62, 6
  s_lshr_b32 s64, s4, 1
  s_lshl_b32 s64, s64, 10
  s_add_u32 s71, s64, s65
  s_add_u32 s71, s71, 0xa000
  s_cmp_eq_u32 s57, 0
  s_cselect_b32 s71, s71, 0x40000000
  s_mov_b32 s70, 0x3f803f80
  s_lshl_b32 s64, s61, 1
  s_lshr_b32 s65, s57, 1
  buffer_load_dwordx4 v[112:115], v3, s[36:39], s9 offen offset:0 sc1
  s_add_u32 s64, s64, s65
  s_lshl_b32 s64, s64, 4
  s_add_u32 s64, s64, s62
  s_lshl_b32 s64, s64, 1
  s_and_b32 s65, s57, 1
  s_add_u32 s64, s64, s65
  s_lshl_b32 s64, s64, 4
  s_add_u32 s78, s64, 0xa0000
  s_lshl_b32 s64, s4, 9
  s_add_u32 s101, s64, 0xa0000
  s_mul_i32 s20, s57, 13824
  s_add_u32 s21, s57, s5
  buffer_load_dwordx4 v[116:119], v3, s[36:39], s9 offen offset:1024 sc1
  s_lshl_b32 s22, s4, 2
  s_add_u32 s64, s21, 1
  s_and_b32 s64, s64, 3
  s_add_u32 s64, s64, s22
  s_mul_i32 s65, s64, 55296
  s_add_u32 s28, s65, s20
  s_add_u32 s29, s28, 7168
  s_add_u32 s64, s21, 2
  s_and_b32 s64, s64, 3
  s_add_u32 s64, s64, s22
  s_mul_i32 s65, s64, 55296
  s_add_u32 s30, s65, s20
  buffer_load_dwordx4 v[120:123], v3, s[36:39], s9 offen offset:2048 sc1
  s_add_u32 s31, s30, 7168
  s_add_u32 s64, s21, 3
  s_and_b32 s64, s64, 3
  s_add_u32 s64, s64, s22
  s_mul_i32 s65, s64, 55296
  s_add_u32 s32, s65, s20
  s_add_u32 s33, s32, 7168
  s_add_u32 s64, s21, 4
  s_and_b32 s64, s64, 3
  s_add_u32 s64, s64, s22
  s_mul_i32 s65, s64, 55296
  s_add_u32 s34, s65, s20
  buffer_load_dwordx4 v[124:127], v3, s[36:39], s9 offen offset:3072 sc1
  s_add_u32 s35, s34, 7168
  s_mul_i32 s67, s64, 20480
  s_mul_i32 s65, s5, 160
  s_add_u32 s67, s67, s65
  s_lshr_b32 s65, s64, 1
  s_mul_i32 s74, s65, 40960
  s_and_b32 s64, s64, 1
  s_lshl_b32 s64, s64, 3
  s_add_u32 s74, s74, s64
  s_mul_i32 s65, s5, 5120
  s_add_u32 s74, s74, s65
  s_add_u32 s74, s74, 0x100000
  ds_read_b128 a[0:3], v3 offset:0
  ds_read_b128 a[4:7], v3 offset:2048
  ds_read_b128 a[8:11], v3 offset:1024
  ds_read_b128 a[12:15], v3 offset:3072
  ds_read_b128 a[16:19], v3 offset:41984
  ds_read_b128 a[20:23], v3 offset:44032
  s_waitcnt vmcnt(6)
  v_max_u32 v31, v99, v103
  s_waitcnt vmcnt(4)
  v_max3_u32 v31, v31, v107, v111
  v_cmp_eq_u32 vcc, -1, v31
  s_cbranch_vccnz sequential_preLN__ssm_conv_s4__geglu_ffn__prompt_kernel_hr10
sequential_preLN__ssm_conv_s4__geglu_ffn__prompt_kernel_hr10_b:
  v_swap_b32 v98, v100
  v_swap_b32 v99, v101
  v_swap_b32 v106, v108
  v_swap_b32 v107, v109
  s_waitcnt lgkmcnt(4)
  v_mfma_f32_16x16x32_bf16 v[32:35], a[0:3], v[96:99], 0
  ds_read_b128 a[24:27], v3 offset:43008
  v_mfma_f32_16x16x32_bf16 v[32:35], a[4:7], v[104:107], v[32:35]
  buffer_load_dwordx4 v[128:131], v3, s[36:39], s10 offen offset:0 sc1
  v_mfma_f32_16x16x32_bf16 v[36:39], a[4:7], v[108:111], 0
  ds_read_b128 a[28:31], v3 offset:45056
  v_mfma_f32_16x16x32_bf16 v[36:39], a[0:3], v[100:103], v[36:39]
  s_waitcnt lgkmcnt(4)
  v_mfma_f32_16x16x32_bf16 v[44:47], a[8:11], v[100:103], 0
  ds_read_b128 a[0:3], v4 offset:18432
  v_mfma_f32_16x16x32_bf16 v[44:47], a[12:15], v[108:111], v[44:47]
  buffer_load_dwordx4 v[132:135], v3, s[36:39], s10 offen offset:1024 sc1
  v_mfma_f32_16x16x32_bf16 v[40:43], a[12:15], v[104:107], 0
  ds_read_b128 a[4:7], v4 offset:20480
  v_mfma_f32_16x16x32_bf16 v[40:43], a[8:11], v[96:99], v[40:43]
  buffer_load_dwordx4 v[136:139], v3, s[36:39], s10 offen offset:2048 sc1
  s_waitcnt lgkmcnt(4)
  v_mfma_f32_16x16x32_bf16 v[48:51], a[16:19], v[96:99], 0
  ds_read_b128 a[8:11], v4 offset:19456
  v_mfma_f32_16x16x32_bf16 v[48:51], a[20:23], v[104:107], v[48:51]
  buffer_load_dwordx4 v[140:143], v3, s[36:39], s10 offen offset:3072 sc1
  v_mfma_f32_16x16x32_bf16 v[52:55], a[20:23], v[108:111], 0
  ds_read_b128 a[12:15], v4 offset:21504
  v_mfma_f32_16x16x32_bf16 v[52:55], a[16:19], v[100:103], v[52:55]
  s_waitcnt vmcnt(6)
  v_max_u32 v31, v115, v119
  s_waitcnt vmcnt(4)
  v_max3_u32 v31, v31, v123, v127
  s_waitcnt lgkmcnt(4)
  v_mfma_f32_16x16x32_bf16 v[60:63], a[24:27], v[100:103], 0
  ds_read_b128 a[16:19], v4 offset:23552
  v_mfma_f32_16x16x32_bf16 v[60:63], a[28:31], v[108:111], v[60:63]
  buffer_load_dwordx4 v[144:147], v3, s[36:39], s11 offen offset:0 sc1
  v_cmp_eq_u32 vcc, -1, v31
  v_mfma_f32_16x16x32_bf16 v[56:59], a[28:31], v[104:107], 0
  ds_read_b128 a[20:23], v4 offset:25600
  s_cbranch_vccnz sequential_preLN__ssm_conv_s4__geglu_ffn__prompt_kernel_hr11
sequential_preLN__ssm_conv_s4__geglu_ffn__prompt_kernel_hr11_b:
  v_mfma_f32_16x16x32_bf16 v[56:59], a[24:27], v[96:99], v[56:59]
  buffer_load_dwordx4 v[148:151], v3, s[36:39], s11 offen offset:1024 sc1
  v_swap_b32 v114, v116
  s_waitcnt lgkmcnt(4)
  v_mfma_f32_16x16x32_bf16 v[64:67], a[0:3], v[96:99], 0
  ds_read_b128 a[24:27], v4 offset:22528
  v_mfma_f32_16x16x32_bf16 v[64:67], a[4:7], v[104:107], v[64:67]
  v_swap_b32 v115, v117
  v_mfma_f32_16x16x32_bf16 v[68:71], a[4:7], v[108:111], 0
  ds_read_b128 a[28:31], v4 offset:24576
  v_mfma_f32_16x16x32_bf16 v[68:71], a[0:3], v[100:103], v[68:71]
  buffer_load_dwordx4 v[80:83], v9, s[36:39], s75 offen sc1
  v_swap_b32 v122, v124
  s_waitcnt lgkmcnt(4)
  v_mfma_f32_16x16x32_bf16 v[76:79], a[8:11], v[100:103], 0
  ds_read_b128 a[0:3], v3 offset:47104
  v_mfma_f32_16x16x32_bf16 v[76:79], a[12:15], v[108:111], v[76:79]
  buffer_load_dwordx4 v[84:87], v9, s[36:39], s76 offen sc1
  v_swap_b32 v123, v125
  v_mfma_f32_16x16x32_bf16 v[72:75], a[12:15], v[104:107], 0
  ds_read_b128 a[4:7], v3 offset:49152
  v_mfma_f32_16x16x32_bf16 v[72:75], a[8:11], v[96:99], v[72:75]
  buffer_load_dwordx4 v[88:91], v10, s[36:39], s77 offen sc1
  s_waitcnt lgkmcnt(4)
  v_mfma_f32_16x16x32_bf16 v[72:75], a[16:19], v[112:115], v[72:75]
  ds_read_b128 a[8:11], v3 offset:46080
  v_mfma_f32_16x16x32_bf16 v[72:75], a[20:23], v[120:123], v[72:75]
  v_mfma_f32_16x16x32_bf16 v[76:79], a[20:23], v[124:127], v[76:79]
  ds_read_b128 a[12:15], v3 offset:48128
  v_mfma_f32_16x16x32_bf16 v[76:79], a[16:19], v[116:119], v[76:79]
  buffer_load_dwordx4 v[152:155], v3, s[36:39], s11 offen offset:2048 sc1
  s_waitcnt lgkmcnt(4)
  v_mfma_f32_16x16x32_bf16 v[68:71], a[24:27], v[116:119], v[68:71]
  ds_read_b128 a[16:19], v3 offset:5120
  v_mfma_f32_16x16x32_bf16 v[68:71], a[28:31], v[124:127], v[68:71]
  buffer_load_dwordx4 v[156:159], v3, s[36:39], s11 offen offset:3072 sc1
  v_mfma_f32_16x16x32_bf16 v[64:67], a[28:31], v[120:123], v[64:67]
  ds_read_b128 a[20:23], v3 offset:7168
  v_mfma_f32_16x16x32_bf16 v[64:67], a[24:27], v[112:115], v[64:67]
  s_waitcnt lgkmcnt(4)
  v_mfma_f32_16x16x32_bf16 v[56:59], a[0:3], v[112:115], v[56:59]
  ds_read_b128 a[24:27], v3 offset:4096
  v_mfma_f32_16x16x32_bf16 v[56:59], a[4:7], v[120:123], v[56:59]
  buffer_load_dwordx4 v[160:163], v3, s[36:39], s12 offen offset:0 sc1
  v_mfma_f32_16x16x32_bf16 v[60:63], a[4:7], v[124:127], v[60:63]
  ds_read_b128 a[28:31], v3 offset:6144
  v_mfma_f32_16x16x32_bf16 v[60:63], a[0:3], v[116:119], v[60:63]
  s_waitcnt vmcnt(10)
  v_max_u32 v31, v131, v135
  s_waitcnt vmcnt(8)
  v_max3_u32 v31, v31, v139, v143
  s_waitcnt lgkmcnt(4)
  v_mfma_f32_16x16x32_bf16 v[52:55], a[8:11], v[116:119], v[52:55]
  ds_read_b128 a[0:3], v3 offset:8192
  v_mfma_f32_16x16x32_bf16 v[52:55], a[12:15], v[124:127], v[52:55]
  buffer_load_dwordx4 v[164:167], v3, s[36:39], s12 offen offset:1024 sc1
  v_cmp_eq_u32 vcc, -1, v31
  v_mfma_f32_16x16x32_bf16 v[48:51], a[12:15], v[120:123], v[48:51]
  ds_read_b128 a[4:7], v3 offset:10240
  s_cbranch_vccnz sequential_preLN__ssm_conv_s4__geglu_ffn__prompt_kernel_hr12
sequential_preLN__ssm_conv_s4__geglu_ffn__prompt_kernel_hr12_b:
  v_mfma_f32_16x16x32_bf16 v[48:51], a[8:11], v[112:115], v[48:51]
  v_swap_b32 v130, v132
  s_waitcnt lgkmcnt(4)
  v_mfma_f32_16x16x32_bf16 v[40:43], a[16:19], v[112:115], v[40:43]
  ds_read_b128 a[8:11], v3 offset:9216
  v_mfma_f32_16x16x32_bf16 v[40:43], a[20:23], v[120:123], v[40:43]
  buffer_load_dwordx4 v[168:171], v3, s[36:39], s12 offen offset:2048 sc1
  v_swap_b32 v131, v133
  v_mfma_f32_16x16x32_bf16 v[44:47], a[20:23], v[124:127], v[44:47]
  ds_read_b128 a[12:15], v3 offset:11264
  v_mfma_f32_16x16x32_bf16 v[44:47], a[16:19], v[116:119], v[44:47]
  v_swap_b32 v138, v140
  s_waitcnt lgkmcnt(4)
  v_mfma_f32_16x16x32_bf16 v[36:39], a[24:27], v[116:119], v[36:39]
  ds_read_b128 a[16:19], v3 offset:50176
  v_mfma_f32_16x16x32_bf16 v[36:39], a[28:31], v[124:127], v[36:39]
  buffer_load_dwordx4 v[172:175], v3, s[36:39], s12 offen offset:3072 sc1
  v_swap_b32 v139, v141
  v_mfma_f32_16x16x32_bf16 v[32:35], a[28:31], v[120:123], v[32:35]
  ds_read_b128 a[20:23], v3 offset:52224
  v_mfma_f32_16x16x32_bf16 v[32:35], a[24:27], v[112:115], v[32:35]
  s_waitcnt lgkmcnt(4)
  v_mfma_f32_16x16x32_bf16 v[32:35], a[0:3], v[128:131], v[32:35]
  ds_read_b128 a[24:27], v3 offset:51200
  v_mfma_f32_16x16x32_bf16 v[32:35], a[4:7], v[136:139], v[32:35]
  buffer_load_dwordx4 v[176:179], v3, s[36:39], s13 offen offset:0 sc1
  v_mfma_f32_16x16x32_bf16 v[36:39], a[4:7], v[140:143], v[36:39]
  ds_read_b128 a[28:31], v3 offset:53248
  v_mfma_f32_16x16x32_bf16 v[36:39], a[0:3], v[132:135], v[36:39]
  buffer_load_dwordx4 v[180:183], v3, s[36:39], s13 offen offset:1024 sc1
  s_waitcnt lgkmcnt(4)
  v_mfma_f32_16x16x32_bf16 v[44:47], a[8:11], v[132:135], v[44:47]
  ds_read_b128 a[0:3], v4 offset:26624
  v_mfma_f32_16x16x32_bf16 v[44:47], a[12:15], v[140:143], v[44:47]
  v_mfma_f32_16x16x32_bf16 v[40:43], a[12:15], v[136:139], v[40:43]
  ds_read_b128 a[4:7], v4 offset:28672
  v_mfma_f32_16x16x32_bf16 v[40:43], a[8:11], v[128:131], v[40:43]
  buffer_load_dwordx4 v[184:187], v3, s[36:39], s13 offen offset:2048 sc1
  s_waitcnt vmcnt(9)
  v_max3_u32 v31, v83, v87, v91
  v_cmp_eq_u32 vcc, -1, v31
  s_waitcnt lgkmcnt(4)
  v_mfma_f32_16x16x32_bf16 v[48:51], a[16:19], v[128:131], v[48:51]
  ds_read_b128 a[8:11], v4 offset:27648
  v_mfma_f32_16x16x32_bf16 v[48:51], a[20:23], v[136:139], v[48:51]
  s_cbranch_vccnz sequential_preLN__ssm_conv_s4__geglu_ffn__prompt_kernel_sr20
sequential_preLN__ssm_conv_s4__geglu_ffn__prompt_kernel_sr20_b:
  v_mfma_f32_16x16x32_bf16 v[52:55], a[20:23], v[140:143], v[52:55]
  ds_read_b128 a[12:15], v4 offset:29696
  v_mfma_f32_16x16x32_bf16 v[52:55], a[16:19], v[132:135], v[52:55]
  buffer_load_dwordx4 v[188:191], v3, s[36:39], s13 offen offset:3072 sc1
  v_max_u32 v31, v147, v151
  s_waitcnt vmcnt(8)
  v_max3_u32 v31, v31, v155, v159
  v_dot2_f32_bf16 v20, v80, s70, 0
  v_dot2_f32_bf16 v21, v80, v80, 0
  v_dot2_f32_bf16 v22, v82, s70, 0
  v_dot2_f32_bf16 v23, v82, v82, 0
  v_dot2_f32_bf16 v20, v81, s70, v20
  v_dot2_f32_bf16 v21, v81, v81, v21
  v_dot2_f32_bf16 v22, v83, s70, v22
  v_dot2_f32_bf16 v23, v83, v83, v23
  v_dot2_f32_bf16 v20, v84, s70, v20
  v_dot2_f32_bf16 v21, v84, v84, v21
  v_dot2_f32_bf16 v22, v86, s70, v22
  v_dot2_f32_bf16 v23, v86, v86, v23
  v_dot2_f32_bf16 v20, v85, s70, v20
  v_dot2_f32_bf16 v21, v85, v85, v21
  v_dot2_f32_bf16 v22, v87, s70, v22
  v_dot2_f32_bf16 v23, v87, v87, v23
  v_dot2_f32_bf16 v20, v88, s70, v20
  v_dot2_f32_bf16 v21, v88, v88, v21
  v_dot2_f32_bf16 v22, v90, s70, v22
  v_dot2_f32_bf16 v23, v90, v90, v23
  v_dot2_f32_bf16 v20, v89, s70, v20
  v_dot2_f32_bf16 v21, v89, v89, v21
  v_dot2_f32_bf16 v22, v91, s70, v22
  v_dot2_f32_bf16 v23, v91, v91, v23
  s_waitcnt lgkmcnt(4)
  v_mfma_f32_16x16x32_bf16 v[60:63], a[24:27], v[132:135], v[60:63]
  ds_read_b128 a[16:19], v4 offset:31744
  v_mfma_f32_16x16x32_bf16 v[60:63], a[28:31], v[140:143], v[60:63]
  v_cmp_eq_u32 vcc, -1, v31
  v_permlane16_swap_b32 v20, v21
  v_mfma_f32_16x16x32_bf16 v[56:59], a[28:31], v[136:139], v[56:59]
  ds_read_b128 a[20:23], v4 offset:33792
  s_cbranch_vccnz sequential_preLN__ssm_conv_s4__geglu_ffn__prompt_kernel_hr13
sequential_preLN__ssm_conv_s4__geglu_ffn__prompt_kernel_hr13_b:
  v_mfma_f32_16x16x32_bf16 v[56:59], a[24:27], v[128:131], v[56:59]
  buffer_load_dwordx4 v[192:195], v3, s[36:39], s14 offen offset:0 sc1
  v_swap_b32 v146, v148
  s_waitcnt lgkmcnt(4)
  v_mfma_f32_16x16x32_bf16 v[64:67], a[0:3], v[128:131], v[64:67]
  ds_read_b128 a[24:27], v4 offset:30720
  v_mfma_f32_16x16x32_bf16 v[64:67], a[4:7], v[136:139], v[64:67]
  v_swap_b32 v147, v149
  v_mfma_f32_16x16x32_bf16 v[68:71], a[4:7], v[140:143], v[68:71]
  ds_read_b128 a[28:31], v4 offset:32768
  v_permlane16_swap_b32 v22, v23
  v_mfma_f32_16x16x32_bf16 v[68:71], a[0:3], v[132:135], v[68:71]
  buffer_load_dwordx4 v[196:199], v3, s[36:39], s14 offen offset:1024 sc1
  v_swap_b32 v154, v156
  s_waitcnt lgkmcnt(4)
  v_mfma_f32_16x16x32_bf16 v[76:79], a[8:11], v[132:135], v[76:79]
  ds_read_b128 a[0:3], v3 offset:55296
  v_mfma_f32_16x16x32_bf16 v[76:79], a[12:15], v[140:143], v[76:79]
  v_swap_b32 v155, v157
  v_mfma_f32_16x16x32_bf16 v[72:75], a[12:15], v[136:139], v[72:75]
  ds_read_b128 a[4:7], v3 offset:57344
  v_add_f32 v20, v20, v21
  v_mfma_f32_16x16x32_bf16 v[72:75], a[8:11], v[128:131], v[72:75]
  buffer_load_dwordx4 v[200:203], v3, s[36:39], s14 offen offset:2048 sc1
  v_add_f32 v22, v22, v23
  s_waitcnt lgkmcnt(4)
  v_mfma_f32_16x16x32_bf16 v[72:75], a[16:19], v[144:147], v[72:75]
  ds_read_b128 a[8:11], v3 offset:54272
  v_mfma_f32_16x16x32_bf16 v[72:75], a[20:23], v[152:155], v[72:75]
  v_permlane32_swap_b32 v20, v22
  v_mfma_f32_16x16x32_bf16 v[76:79], a[20:23], v[156:159], v[76:79]
  ds_read_b128 a[12:15], v3 offset:56320
  v_add_f32 v20, v20, v22
  v_mfma_f32_16x16x32_bf16 v[76:79], a[16:19], v[148:151], v[76:79]
  buffer_load_dwordx4 v[204:207], v3, s[36:39], s14 offen offset:3072 sc1
  v_add_f32 v20, v20, v20 row_ror:4
  s_waitcnt lgkmcnt(4)
  v_mfma_f32_16x16x32_bf16 v[68:71], a[24:27], v[148:151], v[68:71]
  ds_read_b128 a[16:19], v3 offset:13312
  v_add_f32 v20, v20, v20 row_ror:8
  v_mfma_f32_16x16x32_bf16 v[68:71], a[28:31], v[156:159], v[68:71]
  s_add_u32 s27, s63, 114688
  s_add_u32 m0, s6, 114688
  s_nop 0
  buffer_load_dwordx4 v3, s[36:39], s27 offen offset:0 sc1 lds
  ds_write_b32 v11, v20
  v_mfma_f32_16x16x32_bf16 v[64:67], a[28:31], v[152:155], v[64:67]
  ds_read_b128 a[20:23], v3 offset:15360
  v_mfma_f32_16x16x32_bf16 v[64:67], a[24:27], v[144:147], v[64:67]
  s_waitcnt lgkmcnt(1)
  s_barrier
  v_mfma_f32_16x16x32_bf16 v[56:59], a[0:3], v[144:147], v[56:59]
  ds_read_b128 a[24:27], v3 offset:12288
  ds_read2_b64 v[20:23], v12 offset0:0 offset1:8
  v_mfma_f32_16x16x32_bf16 v[56:59], a[4:7], v[152:155], v[56:59]
  buffer_load_dwordx4 v3, s[36:39], s27 offen offset:1024 sc1 lds
  ds_read2_b64 v[24:27], v12 offset0:16 offset1:24
  v_mfma_f32_16x16x32_bf16 v[60:63], a[4:7], v[156:159], v[60:63]
  ds_read_b128 a[28:31], v3 offset:14336
  v_mfma_f32_16x16x32_bf16 v[60:63], a[0:3], v[148:151], v[60:63]
  s_waitcnt vmcnt(12)
  v_max_u32 v31, v163, v167
  s_waitcnt vmcnt(10)
  v_max3_u32 v31, v31, v171, v175
  v_mfma_f32_16x16x32_bf16 v[52:55], a[8:11], v[148:151], v[52:55]
  ds_read_b128 a[0:3], v3 offset:16384
  v_mfma_f32_16x16x32_bf16 v[52:55], a[12:15], v[156:159], v[52:55]
  buffer_load_dwordx4 v3, s[36:39], s27 offen offset:2048 sc1 lds
  v_cmp_eq_u32 vcc, -1, v31
  v_mfma_f32_16x16x32_bf16 v[48:51], a[12:15], v[152:155], v[48:51]
  ds_read_b128 a[4:7], v3 offset:18432
  s_cbranch_vccnz sequential_preLN__ssm_conv_s4__geglu_ffn__prompt_kernel_hr14
sequential_preLN__ssm_conv_s4__geglu_ffn__prompt_kernel_hr14_b:
  v_mfma_f32_16x16x32_bf16 v[48:51], a[8:11], v[144:147], v[48:51]
  v_swap_b32 v162, v164
  s_waitcnt lgkmcnt(6)
  v_mfma_f32_16x16x32_bf16 v[40:43], a[16:19], v[144:147], v[40:43]
  ds_read_b128 a[8:11], v3 offset:17408
  s_waitcnt lgkmcnt(5)
  v_add_f32 v20, v20, v22
  v_mfma_f32_16x16x32_bf16 v[40:43], a[20:23], v[152:155], v[40:43]
  buffer_load_dwordx4 v3, s[36:39], s27 offen offset:3072 sc1 lds
  v_swap_b32 v163, v165
  v_mfma_f32_16x16x32_bf16 v[44:47], a[20:23], v[156:159], v[44:47]
  ds_read_b128 a[12:15], v3 offset:19456
  v_add_f32 v21, v21, v23
  v_mfma_f32_16x16x32_bf16 v[44:47], a[16:19], v[148:151], v[44:47]
  v_swap_b32 v170, v172
  s_waitcnt lgkmcnt(4)
  v_mfma_f32_16x16x32_bf16 v[36:39], a[24:27], v[148:151], v[36:39]
  ds_read_b128 a[16:19], v3 offset:58368
  v_add_f32 v24, v24, v26
  v_mfma_f32_16x16x32_bf16 v[36:39], a[28:31], v[156:159], v[36:39]
  buffer_load_dwordx4 v[208:211], v3, s[36:39], s15 offen offset:0 sc1
  v_swap_b32 v171, v173
  v_mfma_f32_16x16x32_bf16 v[32:35], a[28:31], v[152:155], v[32:35]
  ds_read_b128 a[20:23], v3 offset:60416
  v_add_f32 v25, v25, v27
  v_mfma_f32_16x16x32_bf16 v[32:35], a[24:27], v[144:147], v[32:35]
  v_add_f32 v20, v20, v24
  s_waitcnt lgkmcnt(4)
  v_mfma_f32_16x16x32_bf16 v[32:35], a[0:3], v[160:163], v[32:35]
  ds_read_b128 a[24:27], v3 offset:59392
  v_add_f32 v21, v21, v25
  v_mfma_f32_16x16x32_bf16 v[32:35], a[4:7], v[168:171], v[32:35]
  buffer_load_dwordx4 v[212:215], v3, s[36:39], s15 offen offset:1024 sc1
  v_mul_f32 v20, 0x3acccccd, v20
  v_mfma_f32_16x16x32_bf16 v[36:39], a[4:7], v[172:175], v[36:39]
  ds_read_b128 a[28:31], v3 offset:61440
  v_mul_f32 v21, 0x3acccccd, v21
  v_mfma_f32_16x16x32_bf16 v[36:39], a[0:3], v[164:167], v[36:39]
  v_fma_f32 v21, -v20, v20, v21
  v_max_f32 v21, 0, v21
  s_waitcnt lgkmcnt(4)
  v_mfma_f32_16x16x32_bf16 v[44:47], a[8:11], v[164:167], v[44:47]
  ds_read_b128 a[0:3], v4 offset:34816
  v_mfma_f32_16x16x32_bf16 v[44:47], a[12:15], v[172:175], v[44:47]
  buffer_load_dwordx4 v[216:219], v3, s[36:39], s15 offen offset:2048 sc1
  v_cvt_pk_bf16_f32 v21, v21, v21
  v_and_b32 v21, 0xffff0000, v21
  v_mfma_f32_16x16x32_bf16 v[40:43], a[12:15], v[168:171], v[40:43]
  ds_read_b128 a[4:7], v4 offset:36864
  v_add_f32 v21, 0x3727c5ac, v21
  v_mfma_f32_16x16x32_bf16 v[40:43], a[8:11], v[160:163], v[40:43]
  buffer_load_dwordx4 v[220:223], v3, s[36:39], s15 offen offset:3072 sc1
  v_cvt_pk_bf16_f32 v21, v21, v21
  s_waitcnt lgkmcnt(4)
  v_mfma_f32_16x16x32_bf16 v[48:51], a[16:19], v[160:163], v[48:51]
  ds_read_b128 a[8:11], v4 offset:35840
  v_and_b32 v21, 0xffff0000, v21
  v_mfma_f32_16x16x32_bf16 v[48:51], a[20:23], v[168:171], v[48:51]
  v_sqrt_f32 v21, v21
  v_mfma_f32_16x16x32_bf16 v[52:55], a[20:23], v[172:175], v[52:55]
  ds_read_b128 a[12:15], v4 offset:37888
  v_mfma_f32_16x16x32_bf16 v[52:55], a[16:19], v[164:167], v[52:55]
  buffer_load_dwordx4 v[224:227], v3, s[36:39], s16 offen offset:0 sc1
  s_waitcnt vmcnt(15)
  v_max_u32 v31, v179, v183
  s_waitcnt vmcnt(13)
  v_max3_u32 v31, v31, v187, v191
  s_waitcnt lgkmcnt(4)
  v_mfma_f32_16x16x32_bf16 v[60:63], a[24:27], v[164:167], v[60:63]
  ds_read_b128 a[16:19], v4 offset:39936
  v_mov_b32 v23, s56
  v_mfma_f32_16x16x32_bf16 v[60:63], a[28:31], v[172:175], v[60:63]
  v_cmp_eq_u32 vcc, -1, v31
  v_cvt_pk_bf16_f32 v22, v20, v21
  v_mfma_f32_16x16x32_bf16 v[56:59], a[28:31], v[168:171], v[56:59]
  ds_read_b128 a[20:23], v4 offset:41984
  s_cbranch_vccnz sequential_preLN__ssm_conv_s4__geglu_ffn__prompt_kernel_hr15
sequential_preLN__ssm_conv_s4__geglu_ffn__prompt_kernel_hr15_b:
  v_mfma_f32_16x16x32_bf16 v[56:59], a[24:27], v[160:163], v[56:59]
  buffer_load_dwordx4 v[228:231], v3, s[36:39], s16 offen offset:1024 sc1
  v_swap_b32 v178, v180
  s_waitcnt lgkmcnt(4)
  v_mfma_f32_16x16x32_bf16 v[64:67], a[0:3], v[160:163], v[64:67]
  ds_read_b128 a[24:27], v4 offset:38912
  v_mfma_f32_16x16x32_bf16 v[64:67], a[4:7], v[168:171], v[64:67]
  v_swap_b32 v179, v181
  v_mfma_f32_16x16x32_bf16 v[68:71], a[4:7], v[172:175], v[68:71]
  ds_read_b128 a[28:31], v4 offset:40960
  v_mfma_f32_16x16x32_bf16 v[68:71], a[0:3], v[164:167], v[68:71]
  buffer_store_dwordx2 v[22:23], v13, s[36:39], s71 offen sc1
  v_swap_b32 v186, v188
  s_waitcnt lgkmcnt(4)
  v_mfma_f32_16x16x32_bf16 v[76:79], a[8:11], v[164:167], v[76:79]
  ds_read_b128 a[0:3], v3 offset:63488
  v_mfma_f32_16x16x32_bf16 v[76:79], a[12:15], v[172:175], v[76:79]
  v_swap_b32 v187, v189
  v_mfma_f32_16x16x32_bf16 v[72:75], a[12:15], v[168:171], v[72:75]
  ds_read_b128 a[4:7], v4 offset:0
  v_mfma_f32_16x16x32_bf16 v[72:75], a[8:11], v[160:163], v[72:75]
  buffer_load_dwordx4 v[232:235], v3, s[36:39], s16 offen offset:2048 sc1
  s_waitcnt lgkmcnt(4)
  v_mfma_f32_16x16x32_bf16 v[72:75], a[16:19], v[176:179], v[72:75]
  ds_read_b128 a[8:11], v3 offset:62464
  v_mfma_f32_16x16x32_bf16 v[72:75], a[20:23], v[184:187], v[72:75]
  v_mfma_f32_16x16x32_bf16 v[76:79], a[20:23], v[188:191], v[76:79]
  ds_read_b128 a[12:15], v3 offset:64512
  v_mfma_f32_16x16x32_bf16 v[76:79], a[16:19], v[180:183], v[76:79]
  buffer_load_dwordx4 v[236:239], v3, s[36:39], s16 offen offset:3072 sc1
  s_waitcnt lgkmcnt(4)
  v_mfma_f32_16x16x32_bf16 v[68:71], a[24:27], v[180:183], v[68:71]
  ds_read_b128 a[16:19], v3 offset:21504
  v_mfma_f32_16x16x32_bf16 v[68:71], a[28:31], v[188:191], v[68:71]
  v_mfma_f32_16x16x32_bf16 v[64:67], a[28:31], v[184:187], v[64:67]
  ds_read_b128 a[20:23], v3 offset:23552
  v_mfma_f32_16x16x32_bf16 v[64:67], a[24:27], v[176:179], v[64:67]
  s_add_u32 s27, s63, 131072
  s_add_u32 m0, s6, 131072
  s_nop 0
  buffer_load_dwordx4 v3, s[36:39], s27 offen offset:0 sc1 lds
  s_waitcnt lgkmcnt(4)
  v_mfma_f32_16x16x32_bf16 v[56:59], a[0:3], v[176:179], v[56:59]
  ds_read_b128 a[24:27], v3 offset:20480
  v_mfma_f32_16x16x32_bf16 v[56:59], a[4:7], v[184:187], v[56:59]
  buffer_load_dwordx4 v3, s[36:39], s27 offen offset:1024 sc1 lds
  v_mfma_f32_16x16x32_bf16 v[60:63], a[4:7], v[188:191], v[60:63]
  ds_read_b128 a[28:31], v3 offset:22528
  v_mfma_f32_16x16x32_bf16 v[60:63], a[0:3], v[180:183], v[60:63]
  s_waitcnt vmcnt(17)
  v_max_u32 v31, v195, v199
  s_waitcnt vmcnt(15)
  v_max3_u32 v31, v31, v203, v207
  s_waitcnt lgkmcnt(4)
  v_mfma_f32_16x16x32_bf16 v[52:55], a[8:11], v[180:183], v[52:55]
  ds_read_b128 a[0:3], v3 offset:24576
  v_mfma_f32_16x16x32_bf16 v[52:55], a[12:15], v[188:191], v[52:55]
  buffer_load_dwordx4 v3, s[36:39], s27 offen offset:2048 sc1 lds
  v_cmp_eq_u32 vcc, -1, v31
  v_mfma_f32_16x16x32_bf16 v[48:51], a[12:15], v[184:187], v[48:51]
  ds_read_b128 a[4:7], v3 offset:26624
  s_cbranch_vccnz sequential_preLN__ssm_conv_s4__geglu_ffn__prompt_kernel_hr16
sequential_preLN__ssm_conv_s4__geglu_ffn__prompt_kernel_hr16_b:
  v_mfma_f32_16x16x32_bf16 v[48:51], a[8:11], v[176:179], v[48:51]
  v_swap_b32 v194, v196
  s_waitcnt lgkmcnt(4)
  v_mfma_f32_16x16x32_bf16 v[40:43], a[16:19], v[176:179], v[40:43]
  ds_read_b128 a[8:11], v3 offset:25600
  v_mfma_f32_16x16x32_bf16 v[40:43], a[20:23], v[184:187], v[40:43]
  buffer_load_dwordx4 v3, s[36:39], s27 offen offset:3072 sc1 lds
  v_swap_b32 v195, v197
  v_mfma_f32_16x16x32_bf16 v[44:47], a[20:23], v[188:191], v[44:47]
  ds_read_b128 a[12:15], v3 offset:27648
  v_mfma_f32_16x16x32_bf16 v[44:47], a[16:19], v[180:183], v[44:47]
  v_swap_b32 v202, v204
  s_waitcnt lgkmcnt(4)
  v_mfma_f32_16x16x32_bf16 v[36:39], a[24:27], v[180:183], v[36:39]
  ds_read_b128 a[16:19], v4 offset:1024
  v_mfma_f32_16x16x32_bf16 v[36:39], a[28:31], v[188:191], v[36:39]
  buffer_load_dwordx4 v[240:243], v3, s[36:39], s17 offen offset:0 sc1
  v_swap_b32 v203, v205
  v_mfma_f32_16x16x32_bf16 v[32:35], a[28:31], v[184:187], v[32:35]
  ds_read_b128 a[20:23], v4 offset:3072
  v_mfma_f32_16x16x32_bf16 v[32:35], a[24:27], v[176:179], v[32:35]
  s_waitcnt lgkmcnt(4)
  v_mfma_f32_16x16x32_bf16 v[32:35], a[0:3], v[192:195], v[32:35]
  ds_read_b128 a[24:27], v4 offset:2048
  v_mfma_f32_16x16x32_bf16 v[32:35], a[4:7], v[200:203], v[32:35]
  buffer_load_dwordx4 v[244:247], v3, s[36:39], s17 offen offset:1024 sc1
  v_mfma_f32_16x16x32_bf16 v[36:39], a[4:7], v[204:207], v[36:39]
  ds_read_b128 a[28:31], v4 offset:4096
  s_waitcnt vmcnt(15)
  s_barrier
  v_mfma_f32_16x16x32_bf16 v[36:39], a[0:3], v[196:199], v[36:39]
  s_waitcnt lgkmcnt(4)
  v_mfma_f32_16x16x32_bf16 v[44:47], a[8:11], v[196:199], v[44:47]
  ds_read_b128 a[0:3], v4 offset:43008
  v_mfma_f32_16x16x32_bf16 v[44:47], a[12:15], v[204:207], v[44:47]
  buffer_load_dwordx4 v[248:251], v3, s[36:39], s17 offen offset:2048 sc1
  v_mfma_f32_16x16x32_bf16 v[40:43], a[12:15], v[200:203], v[40:43]
  ds_read_b128 a[4:7], v4 offset:45056
  v_mfma_f32_16x16x32_bf16 v[40:43], a[8:11], v[192:195], v[40:43]
  s_waitcnt lgkmcnt(4)
  v_mfma_f32_16x16x32_bf16 v[48:51], a[16:19], v[192:195], v[48:51]
  ds_read_b128 a[8:11], v4 offset:44032
  v_mfma_f32_16x16x32_bf16 v[48:51], a[20:23], v[200:203], v[48:51]
  buffer_load_dwordx4 v[252:255], v3, s[36:39], s17 offen offset:3072 sc1
  v_mfma_f32_16x16x32_bf16 v[52:55], a[20:23], v[204:207], v[52:55]
  ds_read_b128 a[12:15], v4 offset:46080
  v_mfma_f32_16x16x32_bf16 v[52:55], a[16:19], v[196:199], v[52:55]
  s_add_u32 s27, s63, 147456
  s_add_u32 m0, s6, 0
  s_nop 0
  buffer_load_dwordx4 v3, s[36:39], s27 offen offset:0 sc1 lds
  s_waitcnt vmcnt(16)
  v_max_u32 v31, v211, v215
  s_waitcnt vmcnt(14)
  v_max3_u32 v31, v31, v219, v223
  s_waitcnt lgkmcnt(4)
  v_mfma_f32_16x16x32_bf16 v[60:63], a[24:27], v[196:199], v[60:63]
  ds_read_b128 a[16:19], v4 offset:48128
  v_mfma_f32_16x16x32_bf16 v[60:63], a[28:31], v[204:207], v[60:63]
  v_cmp_eq_u32 vcc, -1, v31
  v_mfma_f32_16x16x32_bf16 v[56:59], a[28:31], v[200:203], v[56:59]
  ds_read_b128 a[20:23], v4 offset:50176
  s_cbranch_vccnz sequential_preLN__ssm_conv_s4__geglu_ffn__prompt_kernel_hr17
sequential_preLN__ssm_conv_s4__geglu_ffn__prompt_kernel_hr17_b:
  v_mfma_f32_16x16x32_bf16 v[56:59], a[24:27], v[192:195], v[56:59]
  buffer_load_dwordx4 v3, s[36:39], s27 offen offset:1024 sc1 lds
  v_swap_b32 v210, v212
  s_waitcnt lgkmcnt(4)
  v_mfma_f32_16x16x32_bf16 v[64:67], a[0:3], v[192:195], v[64:67]
  ds_read_b128 a[24:27], v4 offset:47104
  v_mfma_f32_16x16x32_bf16 v[64:67], a[4:7], v[200:203], v[64:67]
  v_swap_b32 v211, v213
  v_mfma_f32_16x16x32_bf16 v[68:71], a[4:7], v[204:207], v[68:71]
  ds_read_b128 a[28:31], v4 offset:49152
  v_mfma_f32_16x16x32_bf16 v[68:71], a[0:3], v[196:199], v[68:71]
  buffer_load_dwordx4 v3, s[36:39], s27 offen offset:2048 sc1 lds
  v_swap_b32 v218, v220
  s_waitcnt lgkmcnt(4)
  v_mfma_f32_16x16x32_bf16 v[76:79], a[8:11], v[196:199], v[76:79]
  ds_read_b128 a[0:3], v4 offset:6144
  v_mfma_f32_16x16x32_bf16 v[76:79], a[12:15], v[204:207], v[76:79]
  v_swap_b32 v219, v221
  v_mfma_f32_16x16x32_bf16 v[72:75], a[12:15], v[200:203], v[72:75]
  ds_read_b128 a[4:7], v4 offset:8192
  v_mfma_f32_16x16x32_bf16 v[72:75], a[8:11], v[192:195], v[72:75]
  buffer_load_dwordx4 v3, s[36:39], s27 offen offset:3072 sc1 lds
  s_waitcnt lgkmcnt(4)
  v_mfma_f32_16x16x32_bf16 v[72:75], a[16:19], v[208:211], v[72:75]
  ds_read_b128 a[8:11], v4 offset:5120
  v_mfma_f32_16x16x32_bf16 v[72:75], a[20:23], v[216:219], v[72:75]
  v_mfma_f32_16x16x32_bf16 v[76:79], a[20:23], v[220:223], v[76:79]
  ds_read_b128 a[12:15], v4 offset:7168
  v_mfma_f32_16x16x32_bf16 v[76:79], a[16:19], v[212:215], v[76:79]
  s_add_u32 s27, s63, 196608
  s_add_u32 m0, s6, 49152
  s_nop 0
  buffer_load_dwordx4 v3, s[36:39], s27 offen offset:0 sc1 lds
  s_waitcnt lgkmcnt(4)
  v_mfma_f32_16x16x32_bf16 v[68:71], a[24:27], v[212:215], v[68:71]
  ds_read_b128 a[16:19], v3 offset:29696
  v_mfma_f32_16x16x32_bf16 v[68:71], a[28:31], v[220:223], v[68:71]
  v_mfma_f32_16x16x32_bf16 v[64:67], a[28:31], v[216:219], v[64:67]
  ds_read_b128 a[20:23], v3 offset:31744
  v_mfma_f32_16x16x32_bf16 v[64:67], a[24:27], v[208:211], v[64:67]
  buffer_load_dwordx4 v3, s[36:39], s27 offen offset:1024 sc1 lds
  s_waitcnt lgkmcnt(4)
  v_mfma_f32_16x16x32_bf16 v[56:59], a[0:3], v[208:211], v[56:59]
  ds_read_b128 a[24:27], v3 offset:28672
  v_mfma_f32_16x16x32_bf16 v[56:59], a[4:7], v[216:219], v[56:59]
  v_mfma_f32_16x16x32_bf16 v[60:63], a[4:7], v[220:223], v[60:63]
  ds_read_b128 a[28:31], v3 offset:30720
  v_mfma_f32_16x16x32_bf16 v[60:63], a[0:3], v[212:215], v[60:63]
  buffer_load_dwordx4 v3, s[36:39], s27 offen offset:2048 sc1 lds
  s_waitcnt vmcnt(18)
  v_max_u32 v31, v227, v231
  s_waitcnt vmcnt(15)
  v_max3_u32 v31, v31, v235, v239
  s_waitcnt lgkmcnt(4)
  v_mfma_f32_16x16x32_bf16 v[52:55], a[8:11], v[212:215], v[52:55]
  ds_read_b128 a[0:3], v3 offset:32768
  v_mfma_f32_16x16x32_bf16 v[52:55], a[12:15], v[220:223], v[52:55]
  buffer_load_dwordx4 v3, s[36:39], s27 offen offset:3072 sc1 lds
  v_cmp_eq_u32 vcc, -1, v31
  v_mfma_f32_16x16x32_bf16 v[48:51], a[12:15], v[216:219], v[48:51]
  ds_read_b128 a[4:7], v3 offset:34816
  s_cbranch_vccnz sequential_preLN__ssm_conv_s4__geglu_ffn__prompt_kernel_hr18
sequential_preLN__ssm_conv_s4__geglu_ffn__prompt_kernel_hr18_b:
  v_mfma_f32_16x16x32_bf16 v[48:51], a[8:11], v[208:211], v[48:51]
  v_swap_b32 v226, v228
  s_waitcnt lgkmcnt(4)
  v_mfma_f32_16x16x32_bf16 v[40:43], a[16:19], v[208:211], v[40:43]
  ds_read_b128 a[8:11], v3 offset:33792
  v_mfma_f32_16x16x32_bf16 v[40:43], a[20:23], v[216:219], v[40:43]
  buffer_load_dwordx4 a[204:207], v0, s[44:47], 0 offen offset:2048 sc1
  v_swap_b32 v227, v229
  v_mfma_f32_16x16x32_bf16 v[44:47], a[20:23], v[220:223], v[44:47]
  ds_read_b128 a[12:15], v3 offset:35840
  v_mfma_f32_16x16x32_bf16 v[44:47], a[16:19], v[212:215], v[44:47]
  v_swap_b32 v234, v236
  s_waitcnt lgkmcnt(4)
  v_mfma_f32_16x16x32_bf16 v[36:39], a[24:27], v[212:215], v[36:39]
  ds_read_b128 a[16:19], v4 offset:9216
  v_mfma_f32_16x16x32_bf16 v[36:39], a[28:31], v[220:223], v[36:39]
  buffer_load_dwordx4 v[16:19], v14, s[36:39], s69 offen sc1
  v_swap_b32 v235, v237
  v_mfma_f32_16x16x32_bf16 v[32:35], a[28:31], v[216:219], v[32:35]
  ds_read_b128 a[20:23], v4 offset:11264
  v_mfma_f32_16x16x32_bf16 v[32:35], a[24:27], v[208:211], v[32:35]
  s_waitcnt lgkmcnt(4)
  v_mfma_f32_16x16x32_bf16 v[32:35], a[0:3], v[224:227], v[32:35]
  ds_read_b128 a[24:27], v4 offset:10240
  v_mfma_f32_16x16x32_bf16 v[32:35], a[4:7], v[232:235], v[32:35]
  buffer_load_dwordx4 a[200:203], v0, s[44:47], 0 offen offset:3072 sc1
  v_mfma_f32_16x16x32_bf16 v[36:39], a[4:7], v[236:239], v[36:39]
  ds_read_b128 a[28:31], v4 offset:12288
  s_waitcnt vmcnt(15)
  s_barrier
  v_mfma_f32_16x16x32_bf16 v[36:39], a[0:3], v[228:231], v[36:39]
  s_waitcnt lgkmcnt(4)
  v_mfma_f32_16x16x32_bf16 v[44:47], a[8:11], v[228:231], v[44:47]
  ds_read_b128 a[0:3], v4 offset:51200
  v_mfma_f32_16x16x32_bf16 v[44:47], a[12:15], v[236:239], v[44:47]
  s_add_u32 s27, s63, 163840
  s_add_u32 m0, s6, 16384
  s_nop 0
  buffer_load_dwordx4 v3, s[36:39], s27 offen offset:0 sc1 lds
  v_mfma_f32_16x16x32_bf16 v[40:43], a[12:15], v[232:235], v[40:43]
  ds_read_b128 a[4:7], v4 offset:53248
  v_mfma_f32_16x16x32_bf16 v[40:43], a[8:11], v[224:227], v[40:43]
  s_waitcnt lgkmcnt(4)
  v_mfma_f32_16x16x32_bf16 v[48:51], a[16:19], v[224:227], v[48:51]
  ds_read_b128 a[8:11], v4 offset:52224
  v_mfma_f32_16x16x32_bf16 v[48:51], a[20:23], v[232:235], v[48:51]
  buffer_load_dwordx4 v3, s[36:39], s27 offen offset:1024 sc1 lds
  v_mfma_f32_16x16x32_bf16 v[52:55], a[20:23], v[236:239], v[52:55]
  ds_read_b128 a[12:15], v4 offset:54272
  v_mfma_f32_16x16x32_bf16 v[52:55], a[16:19], v[228:231], v[52:55]
  s_waitcnt vmcnt(15)
  v_max_u32 v31, v243, v247
  s_waitcnt vmcnt(13)
  v_max3_u32 v31, v31, v251, v255
  s_waitcnt lgkmcnt(4)
  v_mfma_f32_16x16x32_bf16 v[60:63], a[24:27], v[228:231], v[60:63]
  ds_read_b128 a[16:19], v4 offset:56320
  v_mfma_f32_16x16x32_bf16 v[60:63], a[28:31], v[236:239], v[60:63]
  buffer_load_dwordx4 v3, s[36:39], s27 offen offset:2048 sc1 lds
  v_cmp_eq_u32 vcc, -1, v31
  v_mfma_f32_16x16x32_bf16 v[56:59], a[28:31], v[232:235], v[56:59]
  ds_read_b128 a[20:23], v4 offset:58368
  s_cbranch_vccnz sequential_preLN__ssm_conv_s4__geglu_ffn__prompt_kernel_hr19
sequential_preLN__ssm_conv_s4__geglu_ffn__prompt_kernel_hr19_b:
  v_mfma_f32_16x16x32_bf16 v[56:59], a[24:27], v[224:227], v[56:59]
  buffer_load_dwordx4 v3, s[36:39], s27 offen offset:3072 sc1 lds
  v_swap_b32 v242, v244
  s_waitcnt lgkmcnt(4)
  v_mfma_f32_16x16x32_bf16 v[64:67], a[0:3], v[224:227], v[64:67]
  ds_read_b128 a[24:27], v4 offset:55296
  v_mfma_f32_16x16x32_bf16 v[64:67], a[4:7], v[232:235], v[64:67]
  v_swap_b32 v243, v245
  v_mfma_f32_16x16x32_bf16 v[68:71], a[4:7], v[236:239], v[68:71]
  ds_read_b128 a[28:31], v4 offset:57344
  v_mfma_f32_16x16x32_bf16 v[68:71], a[0:3], v[228:231], v[68:71]
  buffer_load_dwordx4 a[196:199], v0, s[44:47], s100 offen sc1
  v_add_u32 v0, 40960, v0
  v_swap_b32 v250, v252
  s_waitcnt lgkmcnt(4)
  v_mfma_f32_16x16x32_bf16 v[76:79], a[8:11], v[228:231], v[76:79]
  ds_read_b128 a[0:3], v4 offset:14336
  v_mfma_f32_16x16x32_bf16 v[76:79], a[12:15], v[236:239], v[76:79]
  v_swap_b32 v251, v253
  v_mfma_f32_16x16x32_bf16 v[72:75], a[12:15], v[232:235], v[72:75]
  ds_read_b128 a[4:7], v4 offset:16384
  v_mfma_f32_16x16x32_bf16 v[72:75], a[8:11], v[224:227], v[72:75]
  buffer_load_dwordx4 a[192:195], v0, s[44:47], 0 offen offset:0 sc1
  s_waitcnt lgkmcnt(4)
  v_mfma_f32_16x16x32_bf16 v[72:75], a[16:19], v[240:243], v[72:75]
  ds_read_b128 a[8:11], v4 offset:13312
  v_mfma_f32_16x16x32_bf16 v[72:75], a[20:23], v[248:251], v[72:75]
  v_mfma_f32_16x16x32_bf16 v[76:79], a[20:23], v[252:255], v[76:79]
  ds_read_b128 a[12:15], v4 offset:15360
  v_mfma_f32_16x16x32_bf16 v[76:79], a[16:19], v[244:247], v[76:79]
  buffer_store_dwordx4 v[92:95], v8, s[36:39], s68 offen offset:512 sc1
  s_waitcnt lgkmcnt(4)
  v_mfma_f32_16x16x32_bf16 v[68:71], a[24:27], v[244:247], v[68:71]
  ds_read_b128 a[16:19], v3 offset:37888
  v_mfma_f32_16x16x32_bf16 v[68:71], a[28:31], v[252:255], v[68:71]
  v_mfma_f32_16x16x32_bf16 v[64:67], a[28:31], v[248:251], v[64:67]
  ds_read_b128 a[20:23], v3 offset:39936
  v_mfma_f32_16x16x32_bf16 v[64:67], a[24:27], v[240:243], v[64:67]
  buffer_store_dwordx4 v[92:95], v8, s[36:39], s68 offen offset:1024 sc1
  s_waitcnt lgkmcnt(4)
  v_mfma_f32_16x16x32_bf16 v[56:59], a[0:3], v[240:243], v[56:59]
  ds_read_b128 a[24:27], v3 offset:36864
  v_mfma_f32_16x16x32_bf16 v[56:59], a[4:7], v[248:251], v[56:59]
  v_mfma_f32_16x16x32_bf16 v[60:63], a[4:7], v[252:255], v[60:63]
  ds_read_b128 a[28:31], v3 offset:38912
  s_waitcnt vmcnt(9)
  v_cmp_ne_u32 vcc, s56, v17
  v_cmp_ne_u32 s[72:73], s56, v19
  v_mfma_f32_16x16x32_bf16 v[60:63], a[0:3], v[244:247], v[60:63]
  buffer_store_dwordx4 v[92:95], v8, s[36:39], s68 offen offset:1536 sc1
  s_waitcnt lgkmcnt(4)
  v_mfma_f32_16x16x32_bf16 v[52:55], a[8:11], v[244:247], v[52:55]
  s_or_b64 vcc, vcc, s[72:73]
  s_mov_b32 s65, 0
  s_cbranch_vccz sequential_preLN__ssm_conv_s4__geglu_ffn__prompt_kernel_gr22_ok
sequential_preLN__ssm_conv_s4__geglu_ffn__prompt_kernel_gr22:
  buffer_load_dwordx4 v[16:19], v14, s[36:39], s69 offen sc1
  s_add_u32 s65, s65, 1
  s_waitcnt vmcnt(0)
  v_cmp_ne_u32 vcc, s56, v17
  v_cmp_ne_u32 s[72:73], s56, v19
  s_or_b64 vcc, vcc, s[72:73]
  s_cmp_gt_u32 s65, 0x40000
  s_cbranch_scc1 sequential_preLN__ssm_conv_s4__geglu_ffn__prompt_kernel_gr22_ok
  s_cbranch_vccnz sequential_preLN__ssm_conv_s4__geglu_ffn__prompt_kernel_gr22
sequential_preLN__ssm_conv_s4__geglu_ffn__prompt_kernel_gr22_ok:
  v_add_u32 v7, 0xa000, v7
  ds_read2_b32 a[0:1], v7 offset0:0 offset1:16
  v_mfma_f32_16x16x32_bf16 v[52:55], a[12:15], v[252:255], v[52:55]
  buffer_store_dwordx4 v[92:95], v8, s[36:39], s68 offen offset:2048 sc1
  v_and_b32 v20, 0xffff, v16
  v_mfma_f32_16x16x32_bf16 v[48:51], a[12:15], v[248:251], v[48:51]
  ds_read2_b32 a[4:5], v7 offset0:128 offset1:144
  v_xor_b32 v20, 0x8000, v20
  v_mfma_f32_16x16x32_bf16 v[48:51], a[8:11], v[240:243], v[48:51]
  v_lshl_or_b32 v20, v20, 16, v20
  v_accvgpr_write_b32 a32, v20
  s_waitcnt lgkmcnt(4)
  v_mfma_f32_16x16x32_bf16 v[40:43], a[16:19], v[240:243], v[40:43]
  v_add_u32 v7, 0xa400, v7
  ds_read2_b32 a[8:9], v7 offset0:0 offset1:16
  v_mfma_f32_16x16x32_bf16 v[40:43], a[20:23], v[248:251], v[40:43]
  buffer_store_dwordx4 v[92:95], v8, s[36:39], s68 offen offset:2560 sc1
  v_accvgpr_write_b32 a33, v20
  v_and_b32 v21, 0xffff, v18
  v_mfma_f32_16x16x32_bf16 v[44:47], a[20:23], v[252:255], v[44:47]
  ds_read2_b32 a[12:13], v7 offset0:128 offset1:144
  v_mfma_f32_16x16x32_bf16 v[44:47], a[16:19], v[244:247], v[44:47]
  v_xor_b32 v21, 0x8000, v21
  v_lshl_or_b32 v21, v21, 16, v21
  s_waitcnt lgkmcnt(4)
  v_mfma_f32_16x16x32_bf16 v[36:39], a[24:27], v[244:247], v[36:39]
  v_add_u32 v7, 0xa400, v7
  ds_read2_b32 a[16:17], v7 offset0:0 offset1:16
  v_accvgpr_write_b32 a36, v21
  v_mfma_f32_16x16x32_bf16 v[36:39], a[28:31], v[252:255], v[36:39]
  buffer_store_dwordx4 v[92:95], v8, s[36:39], s66 offen offset:3072 sc1
  v_accvgpr_write_b32 a37, v21
  v_mfma_f32_16x16x32_bf16 v[32:35], a[28:31], v[248:251], v[32:35]
  ds_read2_b32 a[20:21], v7 offset0:128 offset1:144
  v_mfma_f32_16x16x32_bf16 v[32:35], a[24:27], v[240:243], v[32:35]
  s_waitcnt lgkmcnt(4)
  v_mfma_f32_16x16x32_bf16 v[32:35], a[0:3], a[32:35], v[32:35]
  ds_read_b128 a[24:27], v4 offset:60416
  v_and_b32 v11, 0xffff0000, v16
  v_mfma_f32_16x16x32_bf16 v[36:39], a[0:3], a[36:39], v[36:39]
  s_or_b32 s64, s61, s62
  s_or_b32 s64, s64, s57
  s_cselect_b32 s64, 0x40000000, 0
  buffer_store_dword v2, v15, s[36:39], s64 offen sc1
  v_rcp_f32 v10, v11
  v_mfma_f32_16x16x32_bf16 v[44:47], a[4:7], a[36:39], v[44:47]
  ds_read_b128 a[28:31], v4 offset:62464
  v_mul_f32 v11, v11, v11
  v_mfma_f32_16x16x32_bf16 v[40:43], a[4:7], a[32:35], v[40:43]
  v_mul_f32 v9, 0xc0135761, v10
  s_waitcnt lgkmcnt(4)
  v_mfma_f32_16x16x32_bf16 v[48:51], a[8:11], a[32:35], v[48:51]
  ds_read_b128 a[0:3], v4 offset:61440
  v_mul_f32 v10, v10, v10
  v_mfma_f32_16x16x32_bf16 v[52:55], a[8:11], a[36:39], v[52:55]
  buffer_load_dwordx4 a[188:191], v0, s[44:47], 0 offen offset:1024 sc1
  v_mul_f32 v10, 0x3d372713, v10
  v_mul_f32 v10, v10, v9
  v_mfma_f32_16x16x32_bf16 v[60:63], a[12:15], a[36:39], v[60:63]
  ds_read_b128 a[4:7], v4 offset:63488
  v_and_b32 v14, 0xffff0000, v18
  v_mfma_f32_16x16x32_bf16 v[56:59], a[12:15], a[32:35], v[56:59]
  v_rcp_f32 v13, v14
  s_waitcnt lgkmcnt(4)
  v_mfma_f32_16x16x32_bf16 v[64:67], a[16:19], a[32:35], v[64:67]
  ds_read_b128 a[8:11], v5 offset:0
  v_mul_f32 v14, v14, v14
  v_mfma_f32_16x16x32_bf16 v[68:71], a[16:19], a[36:39], v[68:71]
  buffer_load_dwordx4 a[184:187], v0, s[44:47], 0 offen offset:2048 sc1
  v_mul_f32 v12, 0xc0135761, v13
  v_mfma_f32_16x16x32_bf16 v[76:79], a[20:23], a[36:39], v[76:79]
  ds_read_b128 a[12:15], v5 offset:2048
  v_mul_f32 v13, v13, v13
  v_mfma_f32_16x16x32_bf16 v[72:75], a[20:23], a[32:35], v[72:75]
  v_mul_f32 v13, 0x3d372713, v13
  v_mul_f32 v13, v13, v12
  s_waitcnt lgkmcnt(4)
  v_mfma_f32_16x16x32_bf16 v[80:83], a[24:27], v[96:99], 0
  ds_read_b128 a[16:19], v4 offset:64512
  v_and_b32 v18, 15, v1
  v_mfma_f32_16x16x32_bf16 v[80:83], a[28:31], v[104:107], v[80:83]
  buffer_load_dwordx4 a[180:183], v0, s[44:47], 0 offen offset:3072 sc1
  v_lshrrev_b32 v19, 4, v1
  v_mul_f32 v20, v32, v32
  v_mfma_f32_16x16x32_bf16 v[84:87], a[28:31], v[108:111], 0
  ds_read_b128 a[20:23], v5 offset:1024
  v_lshlrev_b32 v16, 8, v19
  v_mfma_f32_16x16x32_bf16 v[84:87], a[24:27], v[100:103], v[84:87]
  buffer_load_dwordx4 a[176:179], v0, s[44:47], s100 offen sc1
  v_add_u32 v0, 40960, v0
  v_mul_f32 v21, v33, v33
  s_waitcnt lgkmcnt(2)
  v_mfma_f32_16x16x32_bf16 v[92:95], a[0:3], v[100:103], 0
  ds_read_b128 a[24:27], v5 offset:3072
  v_lshl_add_u32 v16, v18, 4, v16
  v_mul_u32_u24 v18, 1280, v18
  v_mfma_f32_16x16x32_bf16 v[92:95], a[4:7], v[108:111], v[92:95]
  v_bfe_u32 v30, v1, 4, 1
  v_lshl_add_u32 v17, v30, 5, v18
  v_mul_f32 v22, v34, v34
  v_mfma_f32_16x16x32_bf16 v[88:91], a[4:7], v[104:107], 0
  ds_read_b128 a[28:31], v5 offset:5120
  v_lshrrev_b32 v30, 5, v1
  v_lshl_add_u32 v17, v30, 4, v17
  v_mfma_f32_16x16x32_bf16 v[88:91], a[0:3], v[96:99], v[88:91]
  buffer_load_dwordx4 a[172:175], v0, s[44:47], 0 offen offset:0 sc1
  v_mul_f32 v23, v35, v35
  v_mfma_f32_16x16x32_bf16 v[88:91], a[8:11], v[112:115], v[88:91]
  ds_read_b128 a[0:3], v5 offset:4096
  v_lshl_add_u32 v18, v19, 3, v18
  v_mfma_f32_16x16x32_bf16 v[88:91], a[12:15], v[120:123], v[88:91]
  s_mul_i32 s64, s57, 15360
  v_add_u32 v19, s64, v3
  v_and_b32 v30, 0x1f0, v3
  v_fma_f32 v20, v20, v10, v9
  v_mfma_f32_16x16x32_bf16 v[92:95], a[12:15], v[124:127], v[92:95]
  ds_read_b128 a[4:7], v5 offset:6144
  v_fma_f32 v21, v21, v10, v9
  v_mfma_f32_16x16x32_bf16 v[92:95], a[8:11], v[116:119], v[92:95]
  buffer_load_dwordx4 a[168:171], v0, s[44:47], 0 offen offset:1024 sc1
  v_fma_f32 v22, v22, v10, v9
  s_waitcnt lgkmcnt(2)
  v_mfma_f32_16x16x32_bf16 v[84:87], a[16:19], v[116:119], v[84:87]
  ds_read_b128 a[8:11], v5 offset:8192
  s_waitcnt vmcnt(15)
  s_barrier
  v_mfma_f32_16x16x32_bf16 v[84:87], a[20:23], v[124:127], v[84:87]
  v_fma_f32 v23, v23, v10, v9
  v_mul_f32 v20, v32, v20
  v_mul_f32 v21, v33, v21
  v_mul_f32 v22, v34, v22
  v_mfma_f32_16x16x32_bf16 v[80:83], a[20:23], v[120:123], v[80:83]
  ds_read_b128 a[12:15], v5 offset:10240
  v_mul_f32 v23, v35, v23
  v_mfma_f32_16x16x32_bf16 v[80:83], a[16:19], v[112:115], v[80:83]
  s_add_u32 s27, s63, 180224
  s_add_u32 m0, s6, 32768
  s_nop 0
  buffer_load_dwordx4 v3, s[36:39], s27 offen offset:0 sc1 lds
  v_exp_f32 v20, v20
  v_mfma_f32_16x16x32_bf16 v[80:83], a[24:27], v[128:131], v[80:83]
  ds_read_b128 a[16:19], v5 offset:7168
  v_mul_f32 v40, v32, v40
  v_mfma_f32_16x16x32_bf16 v[80:83], a[28:31], v[136:139], v[80:83]
  v_exp_f32 v21, v21
  v_mul_f32 v41, v33, v41
  v_exp_f32 v22, v22
  v_mfma_f32_16x16x32_bf16 v[84:87], a[28:31], v[140:143], v[84:87]
  ds_read_b128 a[20:23], v5 offset:9216
  v_mul_f32 v42, v34, v42
  v_mfma_f32_16x16x32_bf16 v[84:87], a[24:27], v[132:135], v[84:87]
  buffer_load_dwordx4 v3, s[36:39], s27 offen offset:1024 sc1 lds
  s_waitcnt lgkmcnt(2)
  v_mfma_f32_16x16x32_bf16 v[92:95], a[0:3], v[132:135], v[92:95]
  ds_read_b128 a[24:27], v5 offset:11264
  v_exp_f32 v23, v23
  v_mfma_f32_16x16x32_bf16 v[92:95], a[4:7], v[140:143], v[92:95]
  v_mul_f32 v43, v35, v43
  v_fma_f32 v20, v20, v11, v11
  v_fma_f32 v21, v21, v11, v11
  v_fma_f32 v22, v22, v11, v11
  v_mfma_f32_16x16x32_bf16 v[88:91], a[4:7], v[136:139], v[88:91]
  ds_read_b128 a[28:31], v5 offset:13312
  v_fma_f32 v23, v23, v11, v11
  v_mfma_f32_16x16x32_bf16 v[88:91], a[0:3], v[128:131], v[88:91]
  buffer_load_dwordx4 v3, s[36:39], s27 offen offset:2048 sc1 lds
  v_rcp_f32 v20, v20
  v_mfma_f32_16x16x32_bf16 v[88:91], a[8:11], v[144:147], v[88:91]
  ds_read_b128 a[0:3], v5 offset:12288
  v_rcp_f32 v21, v21
  v_mfma_f32_16x16x32_bf16 v[88:91], a[12:15], v[152:155], v[88:91]
  v_rcp_f32 v22, v22
  v_mfma_f32_16x16x32_bf16 v[92:95], a[12:15], v[156:159], v[92:95]
  ds_read_b128 a[4:7], v5 offset:14336
  v_rcp_f32 v23, v23
  v_mul_f32 v40, v40, v20
  v_mfma_f32_16x16x32_bf16 v[92:95], a[8:11], v[148:151], v[92:95]
  buffer_load_dwordx4 v3, s[36:39], s27 offen offset:3072 sc1 lds
  s_waitcnt lgkmcnt(2)
  v_mfma_f32_16x16x32_bf16 v[84:87], a[16:19], v[148:151], v[84:87]
  ds_read_b128 a[8:11], v3 offset:0
  v_mul_f32 v41, v41, v21
  v_mul_f32 v42, v42, v22
  v_mfma_f32_16x16x32_bf16 v[84:87], a[20:23], v[156:159], v[84:87]
  s_add_u32 s27, s63, 212992
  s_add_u32 m0, s6, 65536
  s_nop 0
  buffer_load_dwordx4 v3, s[36:39], s27 offen offset:0 sc1 lds
  v_mfma_f32_16x16x32_bf16 v[80:83], a[20:23], v[152:155], v[80:83]
  ds_read_b128 a[12:15], v3 offset:2048
  v_mul_f32 v43, v43, v23
  v_cvt_pk_bf16_f32 v32, v40, v41
  v_mfma_f32_16x16x32_bf16 v[80:83], a[16:19], v[144:147], v[80:83]
  v_cvt_pk_bf16_f32 v33, v42, v43
  v_mul_f32 v24, v36, v36
  v_mul_f32 v25, v37, v37
  v_mul_f32 v26, v38, v38
  v_mfma_f32_16x16x32_bf16 v[80:83], a[24:27], v[160:163], v[80:83]
  ds_read_b128 a[16:19], v5 offset:15360
  v_mul_f32 v27, v39, v39
  v_fma_f32 v24, v24, v13, v12
  v_mfma_f32_16x16x32_bf16 v[80:83], a[28:31], v[168:171], v[80:83]
  buffer_load_dwordx4 v3, s[36:39], s27 offen offset:1024 sc1 lds
  v_mfma_f32_16x16x32_bf16 v[84:87], a[28:31], v[172:175], v[84:87]
  ds_read_b128 a[20:23], v3 offset:1024
  v_fma_f32 v25, v25, v13, v12
  v_fma_f32 v26, v26, v13, v12
  v_mfma_f32_16x16x32_bf16 v[84:87], a[24:27], v[164:167], v[84:87]
  v_fma_f32 v27, v27, v13, v12
  v_mul_f32 v24, v36, v24
  v_mul_f32 v25, v37, v25
  v_mul_f32 v26, v38, v26
  s_waitcnt lgkmcnt(2)
  v_mfma_f32_16x16x32_bf16 v[92:95], a[0:3], v[164:167], v[92:95]
  ds_read_b128 a[24:27], v3 offset:3072
  v_mul_f32 v27, v39, v27
  v_mfma_f32_16x16x32_bf16 v[92:95], a[4:7], v[172:175], v[92:95]
  buffer_load_dwordx4 v3, s[36:39], s27 offen offset:2048 sc1 lds
  v_exp_f32 v24, v24
  v_mfma_f32_16x16x32_bf16 v[88:91], a[4:7], v[168:171], v[88:91]
  ds_read_b128 a[28:31], v3 offset:5120
  v_mul_f32 v44, v36, v44
  v_mfma_f32_16x16x32_bf16 v[88:91], a[0:3], v[160:163], v[88:91]
  v_exp_f32 v25, v25
  v_mul_f32 v45, v37, v45
  v_mfma_f32_16x16x32_bf16 v[88:91], a[8:11], v[176:179], v[88:91]
  ds_read_b128 a[0:3], v3 offset:4096
  v_exp_f32 v26, v26
  v_mul_f32 v46, v38, v46
  v_mfma_f32_16x16x32_bf16 v[88:91], a[12:15], v[184:187], v[88:91]
  buffer_load_dwordx4 v3, s[36:39], s27 offen offset:3072 sc1 lds
  v_mfma_f32_16x16x32_bf16 v[92:95], a[12:15], v[188:191], v[92:95]
  ds_read_b128 a[4:7], v3 offset:6144
  v_exp_f32 v27, v27
  v_mfma_f32_16x16x32_bf16 v[92:95], a[8:11], v[180:183], v[92:95]
  v_mul_f32 v47, v39, v47
  v_fma_f32 v24, v24, v14, v14
  v_fma_f32 v25, v25, v14, v14
  v_fma_f32 v26, v26, v14, v14
  s_waitcnt lgkmcnt(2)
  v_mfma_f32_16x16x32_bf16 v[84:87], a[16:19], v[180:183], v[84:87]
  ds_read_b128 a[8:11], v3 offset:8192
  v_fma_f32 v27, v27, v14, v14
  v_mfma_f32_16x16x32_bf16 v[84:87], a[20:23], v[188:191], v[84:87]
  s_add_u32 s27, s63, 229376
  s_add_u32 m0, s6, 81920
  s_nop 0
  buffer_load_dwordx4 v3, s[36:39], s27 offen offset:0 sc1 lds
  v_mfma_f32_16x16x32_bf16 v[80:83], a[20:23], v[184:187], v[80:83]
  ds_read_b128 a[12:15], v3 offset:10240
  v_rcp_f32 v24, v24
  v_mfma_f32_16x16x32_bf16 v[80:83], a[16:19], v[176:179], v[80:83]
  v_rcp_f32 v25, v25
  v_rcp_f32 v26, v26
  v_mfma_f32_16x16x32_bf16 v[80:83], a[24:27], v[192:195], v[80:83]
  ds_read_b128 a[16:19], v3 offset:7168
  v_rcp_f32 v27, v27
  v_mfma_f32_16x16x32_bf16 v[80:83], a[28:31], v[200:203], v[80:83]
  buffer_load_dwordx4 v3, s[36:39], s27 offen offset:1024 sc1 lds
  v_mul_f32 v44, v44, v24
  v_mfma_f32_16x16x32_bf16 v[84:87], a[28:31], v[204:207], v[84:87]
  ds_read_b128 a[20:23], v3 offset:9216
  v_mul_f32 v45, v45, v25
  v_mul_f32 v46, v46, v26
  v_mfma_f32_16x16x32_bf16 v[84:87], a[24:27], v[196:199], v[84:87]
  v_mul_f32 v47, v47, v27
  v_cvt_pk_bf16_f32 v34, v44, v45
  v_cvt_pk_bf16_f32 v35, v46, v47
  s_waitcnt lgkmcnt(2)
  v_mfma_f32_16x16x32_bf16 v[92:95], a[0:3], v[196:199], v[92:95]
  ds_read_b128 a[24:27], v3 offset:11264
  v_permlane16_swap_b32 v32, v34
  v_mfma_f32_16x16x32_bf16 v[92:95], a[4:7], v[204:207], v[92:95]
  buffer_load_dwordx4 v3, s[36:39], s27 offen offset:2048 sc1 lds
  v_mfma_f32_16x16x32_bf16 v[88:91], a[4:7], v[200:203], v[88:91]
  ds_read_b128 a[28:31], v3 offset:13312
  v_permlane16_swap_b32 v33, v35
  v_min_u32 v35, -2, v35
  v_mfma_f32_16x16x32_bf16 v[88:91], a[0:3], v[192:195], v[88:91]
  buffer_load_dwordx4 v3, s[36:39], s27 offen offset:3072 sc1 lds
  v_mfma_f32_16x16x32_bf16 v[88:91], a[8:11], v[208:211], v[88:91]
  ds_read_b128 a[0:3], v3 offset:12288
  v_mul_f32 v20, v48, v48
  v_mul_f32 v21, v49, v49
  v_mfma_f32_16x16x32_bf16 v[88:91], a[12:15], v[216:219], v[88:91]
  v_mul_f32 v22, v50, v50
  v_mul_f32 v23, v51, v51
  v_fma_f32 v20, v20, v10, v9
  v_mfma_f32_16x16x32_bf16 v[92:95], a[12:15], v[220:223], v[92:95]
  ds_read_b128 a[4:7], v3 offset:14336
  v_fma_f32 v21, v21, v10, v9
  v_mfma_f32_16x16x32_bf16 v[92:95], a[8:11], v[212:215], v[92:95]
  buffer_store_dwordx4 v[32:35], v8, s[36:39], s68 offen offset:0 sc1
  v_fma_f32 v22, v22, v10, v9
  s_waitcnt lgkmcnt(2)
  v_mfma_f32_16x16x32_bf16 v[84:87], a[16:19], v[212:215], v[84:87]
  ds_read_b128 a[8:11], v3 offset:16384
  v_fma_f32 v23, v23, v10, v9
  v_mfma_f32_16x16x32_bf16 v[84:87], a[20:23], v[220:223], v[84:87]
  v_mul_f32 v20, v48, v20
  v_mul_f32 v21, v49, v21
  v_mul_f32 v22, v50, v22
  v_mfma_f32_16x16x32_bf16 v[80:83], a[20:23], v[216:219], v[80:83]
  ds_read_b128 a[12:15], v3 offset:18432
  v_mul_f32 v23, v51, v23
  v_mfma_f32_16x16x32_bf16 v[80:83], a[16:19], v[208:211], v[80:83]
  s_add_u32 s27, s63, 245760
  s_add_u32 m0, s6, 98304
  s_nop 0
  buffer_load_dwordx4 v3, s[36:39], s27 offen offset:0 sc1 lds
  v_exp_f32 v20, v20
  v_mfma_f32_16x16x32_bf16 v[80:83], a[24:27], v[224:227], v[80:83]
  ds_read_b128 a[16:19], v3 offset:15360
  v_mul_f32 v56, v48, v56
  v_mfma_f32_16x16x32_bf16 v[80:83], a[28:31], v[232:235], v[80:83]
  v_exp_f32 v21, v21
  v_mul_f32 v57, v49, v57
  v_mfma_f32_16x16x32_bf16 v[84:87], a[28:31], v[236:239], v[84:87]
  ds_read_b128 a[20:23], v3 offset:17408
  v_exp_f32 v22, v22
  v_mfma_f32_16x16x32_bf16 v[84:87], a[24:27], v[228:231], v[84:87]
  buffer_load_dwordx4 v3, s[36:39], s27 offen offset:1024 sc1 lds
  s_waitcnt lgkmcnt(2)
  v_mfma_f32_16x16x32_bf16 v[92:95], a[0:3], v[228:231], v[92:95]
  v_add_u32 v7, 0xfffe6400, v7
  ds_read2_b32 a[24:25], v7 offset0:0 offset1:16
  v_mul_f32 v58, v50, v58
  v_mfma_f32_16x16x32_bf16 v[92:95], a[4:7], v[236:239], v[92:95]
  v_exp_f32 v23, v23
  v_mul_f32 v59, v51, v59
  v_fma_f32 v20, v20, v11, v11
  v_mfma_f32_16x16x32_bf16 v[88:91], a[4:7], v[232:235], v[88:91]
  ds_read2_b32 a[28:29], v7 offset0:128 offset1:144
  v_fma_f32 v21, v21, v11, v11
  v_mfma_f32_16x16x32_bf16 v[88:91], a[0:3], v[224:227], v[88:91]
  buffer_load_dwordx4 v3, s[36:39], s27 offen offset:2048 sc1 lds
  v_fma_f32 v22, v22, v11, v11
  v_mfma_f32_16x16x32_bf16 v[88:91], a[8:11], v[240:243], v[88:91]
  ds_read_b128 a[0:3], v3 offset:20480
  v_fma_f32 v23, v23, v11, v11
  v_mfma_f32_16x16x32_bf16 v[88:91], a[12:15], v[248:251], v[88:91]
  v_rcp_f32 v20, v20
  v_rcp_f32 v21, v21
  v_mfma_f32_16x16x32_bf16 v[92:95], a[12:15], v[252:255], v[92:95]
  ds_read_b128 a[4:7], v3 offset:22528
  v_mfma_f32_16x16x32_bf16 v[92:95], a[8:11], v[244:247], v[92:95]
  buffer_load_dwordx4 v3, s[36:39], s27 offen offset:3072 sc1 lds
  v_rcp_f32 v22, v22
  s_waitcnt lgkmcnt(2)
  v_mfma_f32_16x16x32_bf16 v[84:87], a[16:19], v[244:247], v[84:87]
  ds_read_b128 a[8:11], v3 offset:21504
  v_mfma_f32_16x16x32_bf16 v[84:87], a[20:23], v[252:255], v[84:87]
  v_rcp_f32 v23, v23
  v_mul_f32 v56, v56, v20
  v_mul_f32 v57, v57, v21
  v_mfma_f32_16x16x32_bf16 v[80:83], a[20:23], v[248:251], v[80:83]
  ds_read_b128 a[12:15], v3 offset:23552
  v_mul_f32 v58, v58, v22
  v_mfma_f32_16x16x32_bf16 v[80:83], a[16:19], v[240:243], v[80:83]
  buffer_load_dwordx4 a[164:167], v0, s[44:47], 0 offen offset:2048 sc1
  v_mul_f32 v59, v59, v23
  v_mfma_f32_16x16x32_bf16 v[80:83], a[24:27], a[32:35], v[80:83]
  ds_read_b128 a[16:19], v3 offset:25600
  v_cvt_pk_bf16_f32 v48, v56, v57
  v_mfma_f32_16x16x32_bf16 v[84:87], a[24:27], a[36:39], v[84:87]
  buffer_load_dwordx4 a[160:163], v0, s[44:47], 0 offen offset:3072 sc1
  v_cvt_pk_bf16_f32 v49, v58, v59
  v_mfma_f32_16x16x32_bf16 v[92:95], a[28:31], a[36:39], v[92:95]
  ds_read_b128 a[20:23], v3 offset:27648
  v_mul_f32 v24, v52, v52
  v_mfma_f32_16x16x32_bf16 v[88:91], a[28:31], a[32:35], v[88:91]
  v_mul_f32 v25, v53, v53
  v_mul_f32 v26, v54, v54
  v_mul_f32 v27, v55, v55
  s_waitcnt lgkmcnt(2)
  v_mfma_f32_16x16x32_bf16 v[32:35], a[0:3], v[96:99], 0
  ds_read_b128 a[24:27], v3 offset:24576
  v_fma_f32 v24, v24, v13, v12
  v_fma_f32 v25, v25, v13, v12
  v_mfma_f32_16x16x32_bf16 v[32:35], a[4:7], v[104:107], v[32:35]
  buffer_load_dwordx4 a[156:159], v0, s[44:47], s100 offen sc1
  v_add_u32 v0, 40960, v0
  v_mfma_f32_16x16x32_bf16 v[36:39], a[4:7], v[108:111], 0
  ds_read_b128 a[28:31], v3 offset:26624
  v_fma_f32 v26, v26, v13, v12
  v_fma_f32 v27, v27, v13, v12
  v_mfma_f32_16x16x32_bf16 v[36:39], a[0:3], v[100:103], v[36:39]
  v_mul_f32 v24, v52, v24
  v_mul_f32 v25, v53, v25
  v_mul_f32 v26, v54, v26
  v_mfma_f32_16x16x32_bf16 v[44:47], a[8:11], v[100:103], 0
  ds_read_b128 a[0:3], v3 offset:28672
  s_waitcnt vmcnt(16)
  s_barrier
  v_mfma_f32_16x16x32_bf16 v[44:47], a[12:15], v[108:111], v[44:47]
  buffer_load_dwordx4 a[152:155], v0, s[44:47], 0 offen offset:0 sc1
  v_mul_f32 v27, v55, v27
  v_mfma_f32_16x16x32_bf16 v[40:43], a[12:15], v[104:107], 0
  ds_read_b128 a[4:7], v3 offset:30720
  v_exp_f32 v24, v24
  v_mfma_f32_16x16x32_bf16 v[40:43], a[8:11], v[96:99], v[40:43]
  v_mul_f32 v60, v52, v60
  v_exp_f32 v25, v25
  s_waitcnt lgkmcnt(2)
  v_mfma_f32_16x16x32_bf16 v[40:43], a[16:19], v[112:115], v[40:43]
  ds_read_b128 a[8:11], v3 offset:29696
  v_mul_f32 v61, v53, v61
  v_mfma_f32_16x16x32_bf16 v[40:43], a[20:23], v[120:123], v[40:43]
  s_add_u32 s27, s63, 262144
  s_add_u32 m0, s6, 114688
  s_nop 0
  buffer_load_dwordx4 v3, s[36:39], s27 offen offset:0 sc1 lds
  v_mfma_f32_16x16x32_bf16 v[44:47], a[20:23], v[124:127], v[44:47]
  ds_read_b128 a[12:15], v3 offset:31744
  v_exp_f32 v26, v26
  v_mfma_f32_16x16x32_bf16 v[44:47], a[16:19], v[116:119], v[44:47]
  v_mul_f32 v62, v54, v62
  v_exp_f32 v27, v27
  v_mfma_f32_16x16x32_bf16 v[36:39], a[24:27], v[116:119], v[36:39]
  ds_read_b128 a[16:19], v3 offset:33792
  v_mul_f32 v63, v55, v63
  v_fma_f32 v24, v24, v14, v14
  v_mfma_f32_16x16x32_bf16 v[36:39], a[28:31], v[124:127], v[36:39]
  buffer_load_dwordx4 v3, s[36:39], s27 offen offset:1024 sc1 lds
  v_mfma_f32_16x16x32_bf16 v[32:35], a[28:31], v[120:123], v[32:35]
  ds_read_b128 a[20:23], v3 offset:35840
  v_fma_f32 v25, v25, v14, v14
  v_fma_f32 v26, v26, v14, v14
  v_mfma_f32_16x16x32_bf16 v[32:35], a[24:27], v[112:115], v[32:35]
  v_fma_f32 v27, v27, v14, v14
  v_rcp_f32 v24, v24
  s_waitcnt lgkmcnt(2)
  v_mfma_f32_16x16x32_bf16 v[32:35], a[0:3], v[128:131], v[32:35]
  ds_read_b128 a[24:27], v3 offset:32768
  v_rcp_f32 v25, v25
  v_mfma_f32_16x16x32_bf16 v[32:35], a[4:7], v[136:139], v[32:35]
  s_waitcnt vmcnt(10)
  buffer_store_dword v2, v15, s[36:39], s78 offen offset:0 sc1
  v_mfma_f32_16x16x32_bf16 v[36:39], a[4:7], v[140:143], v[36:39]
  ds_read_b128 a[28:31], v3 offset:34816
  v_rcp_f32 v26, v26
  v_mfma_f32_16x16x32_bf16 v[36:39], a[0:3], v[132:135], v[36:39]
  v_rcp_f32 v27, v27
  v_mfma_f32_16x16x32_bf16 v[44:47], a[8:11], v[132:135], v[44:47]
  ds_read_b128 a[0:3], v3 offset:36864
  v_mul_f32 v60, v60, v24
  v_mul_f32 v61, v61, v25
  v_mfma_f32_16x16x32_bf16 v[44:47], a[12:15], v[140:143], v[44:47]
  buffer_load_dwordx4 v3, s[36:39], s27 offen offset:2048 sc1 lds
  v_mfma_f32_16x16x32_bf16 v[40:43], a[12:15], v[136:139], v[40:43]
  ds_read_b128 a[4:7], v3 offset:38912
  v_mul_f32 v62, v62, v26
  v_mul_f32 v63, v63, v27
  v_mfma_f32_16x16x32_bf16 v[40:43], a[8:11], v[128:131], v[40:43]
  buffer_load_dwordx4 v3, s[36:39], s27 offen offset:3072 sc1 lds
  s_waitcnt lgkmcnt(2)
  v_mfma_f32_16x16x32_bf16 v[40:43], a[16:19], v[144:147], v[40:43]
  ds_read_b128 a[8:11], v3 offset:37888
  v_cvt_pk_bf16_f32 v50, v60, v61
  v_cvt_pk_bf16_f32 v51, v62, v63
  v_mfma_f32_16x16x32_bf16 v[40:43], a[20:23], v[152:155], v[40:43]
  v_permlane16_swap_b32 v48, v50
  v_permlane16_swap_b32 v49, v51
  v_mfma_f32_16x16x32_bf16 v[44:47], a[20:23], v[156:159], v[44:47]
  ds_read_b128 a[12:15], v3 offset:39936
  v_min_u32 v51, -2, v51
  v_mfma_f32_16x16x32_bf16 v[44:47], a[16:19], v[148:151], v[44:47]
  s_add_u32 s27, s63, 278528
  s_add_u32 m0, s6, 131072
  s_nop 0
  buffer_load_dwordx4 v3, s[36:39], s27 offen offset:0 sc1 lds
  v_mfma_f32_16x16x32_bf16 v[36:39], a[24:27], v[148:151], v[36:39]
  ds_read_b128 a[16:19], v3 offset:41984
  v_mul_f32 v20, v64, v64
  v_mul_f32 v21, v65, v65
  v_mfma_f32_16x16x32_bf16 v[36:39], a[28:31], v[156:159], v[36:39]
  v_mul_f32 v22, v66, v66
  v_mul_f32 v23, v67, v67
  v_fma_f32 v20, v20, v10, v9
  v_mfma_f32_16x16x32_bf16 v[32:35], a[28:31], v[152:155], v[32:35]
  ds_read_b128 a[20:23], v3 offset:44032
  v_fma_f32 v21, v21, v10, v9
  v_mfma_f32_16x16x32_bf16 v[32:35], a[24:27], v[144:147], v[32:35]
  buffer_store_dwordx4 v[48:51], v8, s[36:39], s68 offen offset:512 sc1
  v_fma_f32 v22, v22, v10, v9
  s_waitcnt lgkmcnt(2)
  v_mfma_f32_16x16x32_bf16 v[32:35], a[0:3], v[160:163], v[32:35]
  ds_read_b128 a[24:27], v3 offset:40960
  v_fma_f32 v23, v23, v10, v9
  v_mfma_f32_16x16x32_bf16 v[32:35], a[4:7], v[168:171], v[32:35]
  v_mul_f32 v20, v64, v20
  v_mul_f32 v21, v65, v21
  v_mul_f32 v22, v66, v22
  v_mfma_f32_16x16x32_bf16 v[36:39], a[4:7], v[172:175], v[36:39]
  ds_read_b128 a[28:31], v3 offset:43008
  v_mul_f32 v23, v67, v23
  v_mfma_f32_16x16x32_bf16 v[36:39], a[0:3], v[164:167], v[36:39]
  buffer_load_dwordx4 v3, s[36:39], s27 offen offset:1024 sc1 lds
  v_exp_f32 v20, v20
  v_mfma_f32_16x16x32_bf16 v[44:47], a[8:11], v[164:167], v[44:47]
  ds_read_b128 a[0:3], v3 offset:45056
  v_mul_f32 v72, v64, v72
  v_mfma_f32_16x16x32_bf16 v[44:47], a[12:15], v[172:175], v[44:47]
  v_exp_f32 v21, v21
  v_mul_f32 v73, v65, v73
  v_mfma_f32_16x16x32_bf16 v[40:43], a[12:15], v[168:171], v[40:43]
  ds_read_b128 a[4:7], v3 offset:47104
  v_exp_f32 v22, v22
  v_mfma_f32_16x16x32_bf16 v[40:43], a[8:11], v[160:163], v[40:43]
  buffer_load_dwordx4 v3, s[36:39], s27 offen offset:2048 sc1 lds
  s_waitcnt lgkmcnt(2)
  v_mfma_f32_16x16x32_bf16 v[40:43], a[16:19], v[176:179], v[40:43]
  ds_read_b128 a[8:11], v3 offset:46080
  v_mul_f32 v74, v66, v74
  v_mfma_f32_16x16x32_bf16 v[40:43], a[20:23], v[184:187], v[40:43]
  v_exp_f32 v23, v23
  v_mul_f32 v75, v67, v75
  v_fma_f32 v20, v20, v11, v11
  v_mfma_f32_16x16x32_bf16 v[44:47], a[20:23], v[188:191], v[44:47]
  ds_read_b128 a[12:15], v3 offset:48128
  v_fma_f32 v21, v21, v11, v11
  v_mfma_f32_16x16x32_bf16 v[44:47], a[16:19], v[180:183], v[44:47]
  buffer_load_dwordx4 v3, s[36:39], s27 offen offset:3072 sc1 lds
  v_fma_f32 v22, v22, v11, v11
  v_mfma_f32_16x16x32_bf16 v[36:39], a[24:27], v[180:183], v[36:39]
  ds_read_b128 a[16:19], v3 offset:50176
  v_fma_f32 v23, v23, v11, v11
  v_mfma_f32_16x16x32_bf16 v[36:39], a[28:31], v[188:191], v[36:39]
  v_rcp_f32 v20, v20
  v_rcp_f32 v21, v21
  v_mfma_f32_16x16x32_bf16 v[32:35], a[28:31], v[184:187], v[32:35]
  ds_read_b128 a[20:23], v3 offset:52224
  v_mfma_f32_16x16x32_bf16 v[32:35], a[24:27], v[176:179], v[32:35]
  s_add_u32 m0, s6, 0
  s_add_u32 s27, s79, 450560
  buffer_load_dwordx4 v3, s[44:47], s27 offen offset:0 sc1 lds
  v_rcp_f32 v22, v22
  s_waitcnt lgkmcnt(2)
  v_mfma_f32_16x16x32_bf16 v[32:35], a[0:3], v[192:195], v[32:35]
  ds_read_b128 a[24:27], v3 offset:49152
  v_mfma_f32_16x16x32_bf16 v[32:35], a[4:7], v[200:203], v[32:35]
  buffer_load_dwordx4 v3, s[44:47], s27 offen offset:1024 sc1 lds
  v_rcp_f32 v23, v23
  v_mfma_f32_16x16x32_bf16 v[36:39], a[4:7], v[204:207], v[36:39]
  ds_read_b128 a[28:31], v3 offset:51200
  v_mul_f32 v72, v72, v20
  v_mfma_f32_16x16x32_bf16 v[36:39], a[0:3], v[196:199], v[36:39]
  v_mul_f32 v73, v73, v21
  v_mul_f32 v74, v74, v22
  v_mul_f32 v75, v75, v23
  v_mfma_f32_16x16x32_bf16 v[44:47], a[8:11], v[196:199], v[44:47]
  ds_read_b128 a[0:3], v3 offset:53248
  v_cvt_pk_bf16_f32 v64, v72, v73
  v_mfma_f32_16x16x32_bf16 v[44:47], a[12:15], v[204:207], v[44:47]
  buffer_load_dwordx4 v3, s[44:47], s27 offen offset:2048 sc1 lds
  v_cvt_pk_bf16_f32 v65, v74, v75
  v_mfma_f32_16x16x32_bf16 v[40:43], a[12:15], v[200:203], v[40:43]
  ds_read_b128 a[4:7], v3 offset:55296
  v_mul_f32 v24, v68, v68
  v_mfma_f32_16x16x32_bf16 v[40:43], a[8:11], v[192:195], v[40:43]
  v_mul_f32 v25, v69, v69
  v_mul_f32 v26, v70, v70
  v_mul_f32 v27, v71, v71
  s_waitcnt lgkmcnt(2)
  v_mfma_f32_16x16x32_bf16 v[40:43], a[16:19], v[208:211], v[40:43]
  ds_read_b128 a[8:11], v3 offset:54272
  v_fma_f32 v24, v24, v13, v12
  v_fma_f32 v25, v25, v13, v12
  v_mfma_f32_16x16x32_bf16 v[40:43], a[20:23], v[216:219], v[40:43]
  buffer_load_dwordx4 v3, s[44:47], s27 offen offset:3072 sc1 lds
  v_mfma_f32_16x16x32_bf16 v[44:47], a[20:23], v[220:223], v[44:47]
  ds_read_b128 a[12:15], v3 offset:56320
  v_fma_f32 v26, v26, v13, v12
  v_fma_f32 v27, v27, v13, v12
  v_mfma_f32_16x16x32_bf16 v[44:47], a[16:19], v[212:215], v[44:47]
  v_mul_f32 v24, v68, v24
  v_mul_f32 v25, v69, v25
  v_mul_f32 v26, v70, v26
  v_mfma_f32_16x16x32_bf16 v[36:39], a[24:27], v[212:215], v[36:39]
  ds_read_b128 a[16:19], v3 offset:58368
  v_mul_f32 v27, v71, v27
  v_mfma_f32_16x16x32_bf16 v[36:39], a[28:31], v[220:223], v[36:39]
  buffer_load_dwordx4 a[148:151], v0, s[44:47], 0 offen offset:1024 sc1
  v_exp_f32 v24, v24
  v_mfma_f32_16x16x32_bf16 v[32:35], a[28:31], v[216:219], v[32:35]
  ds_read_b128 a[20:23], v3 offset:60416
  v_mul_f32 v76, v68, v76
  v_mfma_f32_16x16x32_bf16 v[32:35], a[24:27], v[208:211], v[32:35]
  v_exp_f32 v25, v25
  v_mul_f32 v77, v69, v77
  s_waitcnt lgkmcnt(2)
  v_mfma_f32_16x16x32_bf16 v[32:35], a[0:3], v[224:227], v[32:35]
  ds_read_b128 a[24:27], v3 offset:57344
  v_exp_f32 v26, v26
  v_mfma_f32_16x16x32_bf16 v[32:35], a[4:7], v[232:235], v[32:35]
  buffer_load_dwordx4 a[144:147], v0, s[44:47], 0 offen offset:2048 sc1
  v_mfma_f32_16x16x32_bf16 v[36:39], a[4:7], v[236:239], v[36:39]
  ds_read_b128 a[28:31], v3 offset:59392
  v_mul_f32 v78, v70, v78
  v_mfma_f32_16x16x32_bf16 v[36:39], a[0:3], v[228:231], v[36:39]
  v_exp_f32 v27, v27
  v_mul_f32 v79, v71, v79
  v_mfma_f32_16x16x32_bf16 v[44:47], a[8:11], v[228:231], v[44:47]
  v_add_u32 v7, 0xa400, v7
  ds_read2_b32 a[0:1], v7 offset0:0 offset1:16
  v_fma_f32 v24, v24, v14, v14
  v_fma_f32 v25, v25, v14, v14
  v_mfma_f32_16x16x32_bf16 v[44:47], a[12:15], v[236:239], v[44:47]
  buffer_load_dwordx4 a[140:143], v0, s[44:47], 0 offen offset:3072 sc1
  v_mfma_f32_16x16x32_bf16 v[40:43], a[12:15], v[232:235], v[40:43]
  ds_read2_b32 a[4:5], v7 offset0:128 offset1:144
  v_fma_f32 v26, v26, v14, v14
  v_fma_f32 v27, v27, v14, v14
  v_mfma_f32_16x16x32_bf16 v[40:43], a[8:11], v[224:227], v[40:43]
  v_rcp_f32 v24, v24
  s_waitcnt lgkmcnt(2)
  v_mfma_f32_16x16x32_bf16 v[40:43], a[16:19], v[240:243], v[40:43]
  ds_read_b128 a[8:11], v3 offset:62464
  s_barrier
  v_rcp_f32 v25, v25
  v_mfma_f32_16x16x32_bf16 v[40:43], a[20:23], v[248:251], v[40:43]
  buffer_load_dwordx4 a[136:139], v0, s[44:47], s100 offen sc1
  v_add_u32 v0, 40960, v0
  v_mfma_f32_16x16x32_bf16 v[44:47], a[20:23], v[252:255], v[44:47]
  ds_read_b128 a[12:15], v3 offset:64512
  v_rcp_f32 v26, v26
  v_mfma_f32_16x16x32_bf16 v[44:47], a[16:19], v[244:247], v[44:47]
  s_add_u32 m0, s6, 16384
  s_add_u32 s27, s79, 491520
  buffer_load_dwordx4 v3, s[44:47], s27 offen offset:0 sc1 lds
  v_mfma_f32_16x16x32_bf16 v[36:39], a[24:27], v[244:247], v[36:39]
  ds_read_b128 a[16:19], v3 offset:63488
  v_rcp_f32 v27, v27
  v_mfma_f32_16x16x32_bf16 v[36:39], a[28:31], v[252:255], v[36:39]
  v_mul_f32 v76, v76, v24
  v_mul_f32 v77, v77, v25
  v_mfma_f32_16x16x32_bf16 v[32:35], a[28:31], v[248:251], v[32:35]
  ds_read_b128 a[20:23], v4 offset:0
  v_mul_f32 v78, v78, v26
  v_mul_f32 v79, v79, v27
  v_mfma_f32_16x16x32_bf16 v[32:35], a[24:27], v[240:243], v[32:35]
  buffer_load_dwordx4 v3, s[44:47], s27 offen offset:1024 sc1 lds
  s_waitcnt lgkmcnt(2)
  v_mfma_f32_16x16x32_bf16 v[32:35], a[0:3], a[32:35], v[32:35]
  ds_read_b128 a[24:27], v4 offset:2048
  v_cvt_pk_bf16_f32 v66, v76, v77
  v_cvt_pk_bf16_f32 v67, v78, v79
  v_mfma_f32_16x16x32_bf16 v[36:39], a[0:3], a[36:39], v[36:39]
  v_permlane16_swap_b32 v64, v66
  v_permlane16_swap_b32 v65, v67
  v_mfma_f32_16x16x32_bf16 v[44:47], a[4:7], a[36:39], v[44:47]
  ds_read_b128 a[28:31], v4 offset:4096
  v_min_u32 v67, -2, v67
  v_mfma_f32_16x16x32_bf16 v[40:43], a[4:7], a[32:35], v[40:43]
  buffer_load_dwordx4 v3, s[44:47], s27 offen offset:2048 sc1 lds
  v_mfma_f32_16x16x32_bf16 v[48:51], a[8:11], v[96:99], 0
  ds_read_b128 a[0:3], v4 offset:1024
  v_mul_f32 v20, v80, v80
  v_mul_f32 v21, v81, v81
  v_mfma_f32_16x16x32_bf16 v[48:51], a[12:15], v[104:107], v[48:51]
  buffer_store_dwordx4 v[64:67], v8, s[36:39], s68 offen offset:1024 sc1
  v_mfma_f32_16x16x32_bf16 v[52:55], a[12:15], v[108:111], 0
  ds_read_b128 a[4:7], v4 offset:3072
  v_mul_f32 v22, v82, v82
  v_mul_f32 v23, v83, v83
  v_mfma_f32_16x16x32_bf16 v[52:55], a[8:11], v[100:103], v[52:55]
  v_fma_f32 v20, v20, v10, v9
  v_fma_f32 v21, v21, v10, v9
  v_fma_f32 v22, v22, v10, v9
  s_waitcnt lgkmcnt(2)
  v_mfma_f32_16x16x32_bf16 v[60:63], a[16:19], v[100:103], 0
  ds_read_b128 a[8:11], v4 offset:5120
  v_fma_f32 v23, v23, v10, v9
  v_mfma_f32_16x16x32_bf16 v[60:63], a[20:23], v[108:111], v[60:63]
  buffer_load_dword v31, v30, s[36:39], s101 offen offset:0 sc1
  v_mul_f32 v20, v80, v20
  v_mfma_f32_16x16x32_bf16 v[56:59], a[20:23], v[104:107], 0
  ds_read_b128 a[12:15], v4 offset:7168
  v_mul_f32 v21, v81, v21
  v_mfma_f32_16x16x32_bf16 v[56:59], a[16:19], v[96:99], v[56:59]
  v_mul_f32 v22, v82, v22
  v_mul_f32 v23, v83, v23
  v_exp_f32 v20, v20
  v_mfma_f32_16x16x32_bf16 v[56:59], a[24:27], v[112:115], v[56:59]
  ds_read_b128 a[16:19], v4 offset:6144
  v_mul_f32 v88, v80, v88
  v_mfma_f32_16x16x32_bf16 v[56:59], a[28:31], v[120:123], v[56:59]
  v_exp_f32 v21, v21
  v_mul_f32 v89, v81, v89
  v_mfma_f32_16x16x32_bf16 v[60:63], a[28:31], v[124:127], v[60:63]
  ds_read_b128 a[20:23], v4 offset:8192
  v_exp_f32 v22, v22
  v_mfma_f32_16x16x32_bf16 v[60:63], a[24:27], v[116:119], v[60:63]
  buffer_load_dwordx4 v3, s[44:47], s27 offen offset:3072 sc1 lds
  s_waitcnt lgkmcnt(2)
  v_mfma_f32_16x16x32_bf16 v[52:55], a[0:3], v[116:119], v[52:55]
  ds_read_b128 a[24:27], v4 offset:10240
  v_mul_f32 v90, v82, v90
  v_mfma_f32_16x16x32_bf16 v[52:55], a[4:7], v[124:127], v[52:55]
  s_add_u32 m0, s6, 32768
  s_add_u32 s27, s79, 532480
  buffer_load_dwordx4 v3, s[44:47], s27 offen offset:0 sc1 lds
  v_mfma_f32_16x16x32_bf16 v[48:51], a[4:7], v[120:123], v[48:51]
  ds_read_b128 a[28:31], v4 offset:12288
  v_exp_f32 v23, v23
  v_mfma_f32_16x16x32_bf16 v[48:51], a[0:3], v[112:115], v[48:51]
  v_mul_f32 v91, v83, v91
  v_fma_f32 v20, v20, v11, v11
  v_fma_f32 v21, v21, v11, v11
  v_fma_f32 v22, v22, v11, v11
  v_mfma_f32_16x16x32_bf16 v[48:51], a[8:11], v[128:131], v[48:51]
  ds_read_b128 a[0:3], v4 offset:9216
  v_fma_f32 v23, v23, v11, v11
  v_mfma_f32_16x16x32_bf16 v[48:51], a[12:15], v[136:139], v[48:51]
  buffer_load_dwordx4 v3, s[44:47], s27 offen offset:1024 sc1 lds
  v_mfma_f32_16x16x32_bf16 v[52:55], a[12:15], v[140:143], v[52:55]
  ds_read_b128 a[4:7], v4 offset:11264
  v_rcp_f32 v20, v20
  v_mfma_f32_16x16x32_bf16 v[52:55], a[8:11], v[132:135], v[52:55]
  v_rcp_f32 v21, v21
  v_rcp_f32 v22, v22
  s_waitcnt lgkmcnt(2)
  v_mfma_f32_16x16x32_bf16 v[60:63], a[16:19], v[132:135], v[60:63]
  ds_read_b128 a[8:11], v4 offset:13312
  v_mfma_f32_16x16x32_bf16 v[60:63], a[20:23], v[140:143], v[60:63]
  buffer_load_dwordx4 v3, s[44:47], s27 offen offset:2048 sc1 lds
  v_rcp_f32 v23, v23
  v_mfma_f32_16x16x32_bf16 v[56:59], a[20:23], v[136:139], v[56:59]
  ds_read_b128 a[12:15], v4 offset:15360
  v_mul_f32 v88, v88, v20
  v_mfma_f32_16x16x32_bf16 v[56:59], a[16:19], v[128:131], v[56:59]
  v_mul_f32 v89, v89, v21
  v_mul_f32 v90, v90, v22
  v_mul_f32 v91, v91, v23
  v_mfma_f32_16x16x32_bf16 v[56:59], a[24:27], v[144:147], v[56:59]
  ds_read_b128 a[16:19], v4 offset:14336
  v_cvt_pk_bf16_f32 v80, v88, v89
  v_mfma_f32_16x16x32_bf16 v[56:59], a[28:31], v[152:155], v[56:59]
  buffer_load_dwordx4 v3, s[44:47], s27 offen offset:3072 sc1 lds
  v_cvt_pk_bf16_f32 v81, v90, v91
  v_mfma_f32_16x16x32_bf16 v[60:63], a[28:31], v[156:159], v[60:63]
  ds_read_b128 a[20:23], v4 offset:16384
  v_mul_f32 v24, v84, v84
  v_mfma_f32_16x16x32_bf16 v[60:63], a[24:27], v[148:151], v[60:63]
  v_mul_f32 v25, v85, v85
  v_mul_f32 v26, v86, v86
  v_mul_f32 v27, v87, v87
  s_waitcnt lgkmcnt(2)
  v_mfma_f32_16x16x32_bf16 v[52:55], a[0:3], v[148:151], v[52:55]
  ds_read_b128 a[24:27], v4 offset:18432
  v_fma_f32 v24, v24, v13, v12
  v_fma_f32 v25, v25, v13, v12
  v_mfma_f32_16x16x32_bf16 v[52:55], a[4:7], v[156:159], v[52:55]
  buffer_load_dwordx4 a[132:135], v0, s[44:47], 0 offen offset:0 sc1
  v_mfma_f32_16x16x32_bf16 v[48:51], a[4:7], v[152:155], v[48:51]
  ds_read_b128 a[28:31], v4 offset:20480
  v_fma_f32 v26, v26, v13, v12
  v_fma_f32 v27, v27, v13, v12
  v_mfma_f32_16x16x32_bf16 v[48:51], a[0:3], v[144:147], v[48:51]
  v_mul_f32 v24, v84, v24
  v_mul_f32 v25, v85, v25
  v_mul_f32 v26, v86, v26
  v_mfma_f32_16x16x32_bf16 v[48:51], a[8:11], v[160:163], v[48:51]
  ds_read_b128 a[0:3], v4 offset:17408
  v_mul_f32 v27, v87, v27
  v_mfma_f32_16x16x32_bf16 v[48:51], a[12:15], v[168:171], v[48:51]
  buffer_load_dwordx4 a[128:131], v0, s[44:47], 0 offen offset:1024 sc1
  v_exp_f32 v24, v24
  v_mfma_f32_16x16x32_bf16 v[52:55], a[12:15], v[172:175], v[52:55]
  ds_read_b128 a[4:7], v4 offset:19456
  v_mul_f32 v92, v84, v92
  v_mfma_f32_16x16x32_bf16 v[52:55], a[8:11], v[164:167], v[52:55]
  v_exp_f32 v25, v25
  v_mul_f32 v93, v85, v93
  s_waitcnt lgkmcnt(2)
  v_mfma_f32_16x16x32_bf16 v[60:63], a[16:19], v[164:167], v[60:63]
  ds_read_b128 a[8:11], v4 offset:21504
  v_exp_f32 v26, v26
  v_mfma_f32_16x16x32_bf16 v[60:63], a[20:23], v[172:175], v[60:63]
  buffer_load_dwordx4 a[124:127], v0, s[44:47], 0 offen offset:2048 sc1
  v_mfma_f32_16x16x32_bf16 v[56:59], a[20:23], v[168:171], v[56:59]
  ds_read_b128 a[12:15], v4 offset:23552
  v_mul_f32 v94, v86, v94
  v_mfma_f32_16x16x32_bf16 v[56:59], a[16:19], v[160:163], v[56:59]
  buffer_load_dwordx4 a[120:123], v0, s[44:47], 0 offen offset:3072 sc1
  v_mfma_f32_16x16x32_bf16 v[56:59], a[24:27], v[176:179], v[56:59]
  ds_read_b128 a[16:19], v4 offset:22528
  v_exp_f32 v27, v27
  v_mfma_f32_16x16x32_bf16 v[56:59], a[28:31], v[184:187], v[56:59]
  v_mul_f32 v95, v87, v95
  v_fma_f32 v24, v24, v14, v14
  v_fma_f32 v25, v25, v14, v14
  v_mfma_f32_16x16x32_bf16 v[60:63], a[28:31], v[188:191], v[60:63]
  ds_read_b128 a[20:23], v4 offset:24576
  v_fma_f32 v26, v26, v14, v14
  v_fma_f32 v27, v27, v14, v14
  v_mfma_f32_16x16x32_bf16 v[60:63], a[24:27], v[180:183], v[60:63]
  buffer_load_dwordx4 a[116:119], v0, s[44:47], s100 offen sc1
  v_add_u32 v0, 40960, v0
  s_waitcnt lgkmcnt(2)
  v_mfma_f32_16x16x32_bf16 v[52:55], a[0:3], v[180:183], v[52:55]
  ds_read_b128 a[24:27], v4 offset:26624
  v_rcp_f32 v24, v24
  v_mfma_f32_16x16x32_bf16 v[52:55], a[4:7], v[188:191], v[52:55]
  v_rcp_f32 v25, v25
  v_mfma_f32_16x16x32_bf16 v[48:51], a[4:7], v[184:187], v[48:51]
  ds_read_b128 a[28:31], v4 offset:28672
  v_rcp_f32 v26, v26
  v_mfma_f32_16x16x32_bf16 v[48:51], a[0:3], v[176:179], v[48:51]
  buffer_load_dwordx4 a[112:115], v0, s[44:47], 0 offen offset:0 sc1
  v_mfma_f32_16x16x32_bf16 v[48:51], a[8:11], v[192:195], v[48:51]
  ds_read_b128 a[0:3], v4 offset:25600
  v_rcp_f32 v27, v27
  v_mfma_f32_16x16x32_bf16 v[48:51], a[12:15], v[200:203], v[48:51]
  v_mul_f32 v92, v92, v24
  v_mul_f32 v93, v93, v25
  v_mul_f32 v94, v94, v26
  v_mul_f32 v95, v95, v27
  v_mfma_f32_16x16x32_bf16 v[52:55], a[12:15], v[204:207], v[52:55]
  ds_read_b128 a[4:7], v4 offset:27648
  s_waitcnt vmcnt(24)
  s_barrier
  v_mfma_f32_16x16x32_bf16 v[52:55], a[8:11], v[196:199], v[52:55]
  buffer_load_dwordx4 a[108:111], v0, s[44:47], 0 offen offset:1024 sc1
  s_waitcnt lgkmcnt(2)
  v_mfma_f32_16x16x32_bf16 v[60:63], a[16:19], v[196:199], v[60:63]
  ds_read_b128 a[8:11], v4 offset:29696
  v_cvt_pk_bf16_f32 v82, v92, v93
  v_cvt_pk_bf16_f32 v83, v94, v95
  v_mfma_f32_16x16x32_bf16 v[60:63], a[20:23], v[204:207], v[60:63]
  v_permlane16_swap_b32 v80, v82
  v_permlane16_swap_b32 v81, v83
  v_mfma_f32_16x16x32_bf16 v[56:59], a[20:23], v[200:203], v[56:59]
  ds_read_b128 a[12:15], v4 offset:31744
  v_min_u32 v83, -2, v83
  v_mfma_f32_16x16x32_bf16 v[56:59], a[16:19], v[192:195], v[56:59]
  s_add_u32 m0, s6, 49152
  s_add_u32 s27, s79, 413696
  buffer_load_dwordx4 v3, s[44:47], s27 offen offset:0 sc1 lds
  v_mfma_f32_16x16x32_bf16 v[56:59], a[24:27], v[208:211], v[56:59]
  ds_read_b128 a[16:19], v4 offset:30720
  v_mul_f32 v20, v32, v32
  v_mul_f32 v21, v33, v33
  v_mfma_f32_16x16x32_bf16 v[56:59], a[28:31], v[216:219], v[56:59]
  v_mul_f32 v22, v34, v34
  v_mul_f32 v23, v35, v35
  v_fma_f32 v20, v20, v10, v9
  v_mfma_f32_16x16x32_bf16 v[60:63], a[28:31], v[220:223], v[60:63]
  ds_read_b128 a[20:23], v4 offset:32768
  v_fma_f32 v21, v21, v10, v9
  v_mfma_f32_16x16x32_bf16 v[60:63], a[24:27], v[212:215], v[60:63]
  buffer_store_dwordx4 v[80:83], v8, s[36:39], s68 offen offset:1536 sc1
  v_fma_f32 v22, v22, v10, v9
  s_waitcnt lgkmcnt(2)
  v_mfma_f32_16x16x32_bf16 v[52:55], a[0:3], v[212:215], v[52:55]
  ds_read_b128 a[24:27], v4 offset:34816
  v_fma_f32 v23, v23, v10, v9
  v_mfma_f32_16x16x32_bf16 v[52:55], a[4:7], v[220:223], v[52:55]
  v_mul_f32 v20, v32, v20
  v_mul_f32 v21, v33, v21
  v_mul_f32 v22, v34, v22
  v_mfma_f32_16x16x32_bf16 v[48:51], a[4:7], v[216:219], v[48:51]
  ds_read_b128 a[28:31], v4 offset:36864
  v_mul_f32 v23, v35, v23
  v_mfma_f32_16x16x32_bf16 v[48:51], a[0:3], v[208:211], v[48:51]
  s_add_u32 s27, s79, 453632
  buffer_load_dwordx4 v3, s[44:47], s27 offen offset:1024 sc1 lds
  v_exp_f32 v20, v20
  s_waitcnt vmcnt(15)
  v_cmp_ne_u32 vcc, s56, v31
  s_mov_b32 s65, 0
  s_cbranch_vccz sequential_preLN__ssm_conv_s4__geglu_ffn__prompt_kernel_fw21_ok
sequential_preLN__ssm_conv_s4__geglu_ffn__prompt_kernel_fw21:
  buffer_load_dword v31, v30, s[36:39], s101 offen offset:0 sc1
  s_add_u32 s65, s65, 1
  s_waitcnt vmcnt(0)
  v_cmp_ne_u32 vcc, s56, v31
  s_cmp_gt_u32 s65, 0x40000
  s_cbranch_scc1 sequential_preLN__ssm_conv_s4__geglu_ffn__prompt_kernel_fw21_ok
  s_cbranch_vccnz sequential_preLN__ssm_conv_s4__geglu_ffn__prompt_kernel_fw21
sequential_preLN__ssm_conv_s4__geglu_ffn__prompt_kernel_fw21_ok:
  v_mfma_f32_16x16x32_bf16 v[48:51], a[8:11], v[224:227], v[48:51]
  ds_read_b128 a[0:3], v4 offset:33792
  v_mul_f32 v40, v32, v40
  v_mfma_f32_16x16x32_bf16 v[48:51], a[12:15], v[232:235], v[48:51]
  buffer_load_dwordx4 v[80:83], v28, s[48:51], s28 offen offset:0 sc1
  v_mfma_f32_16x16x32_bf16 v[52:55], a[12:15], v[236:239], v[52:55]
  ds_read_b128 a[4:7], v4 offset:35840
  v_exp_f32 v21, v21
  v_mfma_f32_16x16x32_bf16 v[52:55], a[8:11], v[228:231], v[52:55]
  v_mul_f32 v41, v33, v41
  v_exp_f32 v22, v22
  s_waitcnt lgkmcnt(2)
  v_mfma_f32_16x16x32_bf16 v[60:63], a[16:19], v[228:231], v[60:63]
  v_add_u32 v7, 0xa400, v7
  ds_read2_b32 a[8:9], v7 offset0:0 offset1:16
  v_mul_f32 v42, v34, v42
  v_mfma_f32_16x16x32_bf16 v[60:63], a[20:23], v[236:239], v[60:63]
  buffer_load_dwordx4 v[84:87], v28, s[48:51], s29 offen offset:0 sc1
  v_mfma_f32_16x16x32_bf16 v[56:59], a[20:23], v[232:235], v[56:59]
  ds_read2_b32 a[12:13], v7 offset0:128 offset1:144
  v_exp_f32 v23, v23
  v_mfma_f32_16x16x32_bf16 v[56:59], a[16:19], v[224:227], v[56:59]
  v_mul_f32 v43, v35, v43
  v_fma_f32 v20, v20, v11, v11
  v_fma_f32 v21, v21, v11, v11
  v_mfma_f32_16x16x32_bf16 v[56:59], a[24:27], v[240:243], v[56:59]
  ds_read_b128 a[16:19], v4 offset:38912
  v_fma_f32 v22, v22, v11, v11
  v_fma_f32 v23, v23, v11, v11
  v_mfma_f32_16x16x32_bf16 v[56:59], a[28:31], v[248:251], v[56:59]
  buffer_load_dwordx4 v[92:95], v28, s[48:51], s31 offen offset:0 sc1
  v_mfma_f32_16x16x32_bf16 v[60:63], a[28:31], v[252:255], v[60:63]
  ds_read_b128 a[20:23], v4 offset:40960
  v_rcp_f32 v20, v20
  v_mfma_f32_16x16x32_bf16 v[60:63], a[24:27], v[244:247], v[60:63]
  v_rcp_f32 v21, v21
  s_waitcnt lgkmcnt(2)
  v_mfma_f32_16x16x32_bf16 v[52:55], a[0:3], v[244:247], v[52:55]
  ds_read_b128 a[24:27], v4 offset:39936
  v_rcp_f32 v22, v22
  v_mfma_f32_16x16x32_bf16 v[52:55], a[4:7], v[252:255], v[52:55]
  buffer_load_dwordx4 v[88:91], v28, s[48:51], s30 offen offset:0 sc1
  v_mfma_f32_16x16x32_bf16 v[48:51], a[4:7], v[248:251], v[48:51]
  ds_read_b128 a[28:31], v4 offset:41984
  v_rcp_f32 v23, v23
  v_mfma_f32_16x16x32_bf16 v[48:51], a[0:3], v[240:243], v[48:51]
  v_mul_f32 v40, v40, v20
  v_mul_f32 v41, v41, v21
  v_mul_f32 v42, v42, v22
  v_mfma_f32_16x16x32_bf16 v[48:51], a[8:11], a[32:35], v[48:51]
  ds_read_b128 a[0:3], v4 offset:44032
  v_mul_f32 v43, v43, v23
  v_cvt_pk_bf16_f32 v32, v40, v41
  v_mfma_f32_16x16x32_bf16 v[52:55], a[8:11], a[36:39], v[52:55]
  s_add_u32 s27, s79, 493568
  buffer_load_dwordx4 v3, s[44:47], s27 offen offset:2048 sc1 lds
  v_mfma_f32_16x16x32_bf16 v[60:63], a[12:15], a[36:39], v[60:63]
  ds_read_b128 a[4:7], v4 offset:46080
  v_cvt_pk_bf16_f32 v33, v42, v43
  v_mul_f32 v24, v36, v36
  v_mfma_f32_16x16x32_bf16 v[56:59], a[12:15], a[32:35], v[56:59]
  v_mul_f32 v25, v37, v37
  v_mul_f32 v26, v38, v38
  v_mul_f32 v27, v39, v39
  s_and_b32 s64, s62, 3
  s_cmp_eq_u32 s64, 3
  s_cbranch_scc0 sequential_preLN__ssm_conv_s4__geglu_ffn__prompt_kernel_u743
  s_waitcnt lgkmcnt(0)
  v_fma_f32 v24, v24, v13, v12
  s_add_u32 s27, s79, 533504
  buffer_load_dwordx4 v3, s[44:47], s27 offen offset:3072 sc1 lds
  v_fma_f32 v25, v25, v13, v12
  v_fma_f32 v26, v26, v13, v12
  v_fma_f32 v27, v27, v13, v12
  v_mul_f32 v24, v36, v24
  v_mul_f32 v25, v37, v25
  v_mul_f32 v26, v38, v26
  v_mul_f32 v27, v39, v27
  buffer_load_dwordx4 a[104:107], v0, s[44:47], 0 offen offset:2048 sc1
  v_exp_f32 v24, v24
  buffer_load_dwordx4 a[100:103], v0, s[44:47], 0 offen offset:3072 sc1
  v_mul_f32 v44, v36, v44
  v_exp_f32 v25, v25
  v_mul_f32 v45, v37, v45
  v_exp_f32 v26, v26
  buffer_load_dwordx4 v[96:99], v28, s[48:51], s32 offen offset:0 sc1
  v_mul_f32 v46, v38, v46
  v_exp_f32 v27, v27
  v_mul_f32 v47, v39, v47
  v_fma_f32 v24, v24, v14, v14
  v_fma_f32 v25, v25, v14, v14
  v_fma_f32 v26, v26, v14, v14
  buffer_load_dwordx4 v[100:103], v28, s[48:51], s33 offen offset:0 sc1
  v_fma_f32 v27, v27, v14, v14
  v_rcp_f32 v24, v24
  v_rcp_f32 v25, v25
  v_rcp_f32 v26, v26
  buffer_load_dwordx4 v[108:111], v28, s[48:51], s35 offen offset:0 sc1
  v_rcp_f32 v27, v27
  v_mul_f32 v44, v44, v24
  v_mul_f32 v45, v45, v25
  v_mul_f32 v46, v46, v26
  v_mul_f32 v47, v47, v27
  buffer_load_dwordx4 v[104:107], v28, s[48:51], s34 offen offset:0 sc1
  v_cvt_pk_bf16_f32 v34, v44, v45
  v_cvt_pk_bf16_f32 v35, v46, v47
  s_nop 0
  v_permlane16_swap_b32 v32, v34
  v_permlane16_swap_b32 v33, v35
  v_min_u32 v35, -2, v35
  buffer_load_dwordx4 v[112:115], v28, s[48:51], s28 offen offset:512 sc1
  v_mul_f32 v20, v48, v48
  v_mul_f32 v21, v49, v49
  v_mul_f32 v22, v50, v50
  v_mul_f32 v23, v51, v51
  v_fma_f32 v20, v20, v10, v9
  v_fma_f32 v21, v21, v10, v9
  buffer_store_dwordx4 v[32:35], v8, s[36:39], s68 offen offset:2048 sc1
  v_fma_f32 v22, v22, v10, v9
  buffer_load_dwordx4 v[116:119], v28, s[48:51], s29 offen offset:512 sc1
  v_fma_f32 v23, v23, v10, v9
  v_mul_f32 v20, v48, v20
  v_mul_f32 v21, v49, v21
  v_mul_f32 v22, v50, v22
  v_mul_f32 v23, v51, v23
  v_exp_f32 v20, v20
  buffer_load_dwordx4 v[124:127], v28, s[48:51], s31 offen offset:512 sc1
  v_mul_f32 v56, v48, v56
  v_exp_f32 v21, v21
  v_mul_f32 v57, v49, v57
  v_exp_f32 v22, v22
  buffer_load_dwordx4 v[120:123], v28, s[48:51], s30 offen offset:512 sc1
  v_mul_f32 v58, v50, v58
  v_exp_f32 v23, v23
  v_mul_f32 v59, v51, v59
  v_fma_f32 v20, v20, v11, v11
  buffer_load_dwordx4 v[128:131], v28, s[48:51], s32 offen offset:512 sc1
  v_fma_f32 v21, v21, v11, v11
  v_fma_f32 v22, v22, v11, v11
  v_fma_f32 v23, v23, v11, v11
  v_rcp_f32 v20, v20
  v_rcp_f32 v21, v21
  buffer_load_dwordx4 v[132:135], v28, s[48:51], s33 offen offset:512 sc1
  v_rcp_f32 v22, v22
  v_rcp_f32 v23, v23
  v_mul_f32 v56, v56, v20
  buffer_load_dwordx4 v[140:143], v28, s[48:51], s35 offen offset:512 sc1
  v_mul_f32 v57, v57, v21
  v_mul_f32 v58, v58, v22
  v_mul_f32 v59, v59, v23
  v_cvt_pk_bf16_f32 v48, v56, v57
  v_cvt_pk_bf16_f32 v49, v58, v59
  v_mul_f32 v24, v52, v52
  buffer_load_dwordx4 v[136:139], v28, s[48:51], s34 offen offset:512 sc1
  v_mul_f32 v25, v53, v53
  v_mul_f32 v26, v54, v54
  buffer_load_dwordx4 v[144:147], v28, s[48:51], s28 offen offset:1024 sc1
  v_mul_f32 v27, v55, v55
  v_fma_f32 v24, v24, v13, v12
  v_fma_f32 v25, v25, v13, v12
  v_fma_f32 v26, v26, v13, v12
  v_fma_f32 v27, v27, v13, v12
  v_mul_f32 v24, v52, v24
  buffer_load_dwordx4 v[148:151], v28, s[48:51], s29 offen offset:1024 sc1
  v_mul_f32 v25, v53, v25
  v_mul_f32 v26, v54, v26
  v_mul_f32 v27, v55, v27
  v_exp_f32 v24, v24
  v_mul_f32 v60, v52, v60
  buffer_load_dwordx4 v[36:39], v28, s[48:51], s31 offen offset:1024 sc1
  v_exp_f32 v25, v25
  v_mul_f32 v61, v53, v61
  v_exp_f32 v26, v26
  buffer_load_dwordx4 v[32:35], v28, s[48:51], s30 offen offset:1024 sc1
  v_mul_f32 v62, v54, v62
  v_exp_f32 v27, v27
  v_mul_f32 v63, v55, v63
  v_fma_f32 v24, v24, v14, v14
  v_fma_f32 v25, v25, v14, v14
  buffer_load_dwordx4 v[40:43], v28, s[48:51], s32 offen offset:1024 sc1
  v_fma_f32 v26, v26, v14, v14
  v_fma_f32 v27, v27, v14, v14
  v_rcp_f32 v24, v24
  v_rcp_f32 v25, v25
  v_rcp_f32 v26, v26
  v_rcp_f32 v27, v27
  buffer_load_dwordx4 v[44:47], v28, s[48:51], s33 offen offset:1024 sc1
  v_mul_f32 v60, v60, v24
  v_mul_f32 v61, v61, v25
  v_mul_f32 v62, v62, v26
  v_mul_f32 v63, v63, v27
  v_cvt_pk_bf16_f32 v50, v60, v61
  buffer_load_dwordx4 a[96:99], v0, s[44:47], s100 offen sc1
  v_add_u32 v0, 40960, v0
  v_cvt_pk_bf16_f32 v51, v62, v63
  v_permlane16_swap_b32 v48, v50
  s_nop 0
  v_permlane16_swap_b32 v49, v51
  v_min_u32 v51, -2, v51
  s_branch sequential_preLN__ssm_conv_s4__geglu_ffn__prompt_kernel_uj44
sequential_preLN__ssm_conv_s4__geglu_ffn__prompt_kernel_u743:
  s_waitcnt lgkmcnt(2)
  v_mfma_f32_16x16x32_bf16 v[64:67], a[16:19], v[96:99], 0
  ds_read_b128 a[8:11], v4 offset:43008
  v_fma_f32 v24, v24, v13, v12
  v_mfma_f32_16x16x32_bf16 v[64:67], a[20:23], v[104:107], v[64:67]
  s_add_u32 s27, s79, 533504
  buffer_load_dwordx4 v3, s[44:47], s27 offen offset:3072 sc1 lds
  v_fma_f32 v25, v25, v13, v12
  v_mfma_f32_16x16x32_bf16 v[68:71], a[20:23], v[108:111], 0
  ds_read_b128 a[12:15], v4 offset:45056
  v_fma_f32 v26, v26, v13, v12
  v_mfma_f32_16x16x32_bf16 v[68:71], a[16:19], v[100:103], v[68:71]
  v_fma_f32 v27, v27, v13, v12
  v_mul_f32 v24, v36, v24
  v_mul_f32 v25, v37, v25
  v_mfma_f32_16x16x32_bf16 v[76:79], a[24:27], v[100:103], 0
  ds_read_b128 a[16:19], v4 offset:47104
  v_mul_f32 v26, v38, v26
  v_mul_f32 v27, v39, v27
  v_mfma_f32_16x16x32_bf16 v[76:79], a[28:31], v[108:111], v[76:79]
  buffer_load_dwordx4 a[104:107], v0, s[44:47], 0 offen offset:2048 sc1
  v_mfma_f32_16x16x32_bf16 v[72:75], a[28:31], v[104:107], 0
  ds_read_b128 a[20:23], v4 offset:49152
  v_exp_f32 v24, v24
  v_mfma_f32_16x16x32_bf16 v[72:75], a[24:27], v[96:99], v[72:75]
  buffer_load_dwordx4 a[100:103], v0, s[44:47], 0 offen offset:3072 sc1
  s_waitcnt lgkmcnt(2)
  v_mfma_f32_16x16x32_bf16 v[72:75], a[0:3], v[112:115], v[72:75]
  ds_read_b128 a[24:27], v4 offset:48128
  v_mul_f32 v44, v36, v44
  v_mfma_f32_16x16x32_bf16 v[72:75], a[4:7], v[120:123], v[72:75]
  v_exp_f32 v25, v25
  v_mul_f32 v45, v37, v45
  v_mfma_f32_16x16x32_bf16 v[76:79], a[4:7], v[124:127], v[76:79]
  ds_read_b128 a[28:31], v4 offset:50176
  v_exp_f32 v26, v26
  v_mfma_f32_16x16x32_bf16 v[76:79], a[0:3], v[116:119], v[76:79]
  buffer_load_dwordx4 v[96:99], v28, s[48:51], s32 offen offset:0 sc1
  v_mul_f32 v46, v38, v46
  v_mfma_f32_16x16x32_bf16 v[68:71], a[8:11], v[116:119], v[68:71]
  ds_read_b128 a[0:3], v4 offset:52224
  v_exp_f32 v27, v27
  v_mfma_f32_16x16x32_bf16 v[68:71], a[12:15], v[124:127], v[68:71]
  v_mul_f32 v47, v39, v47
  v_fma_f32 v24, v24, v14, v14
  v_mfma_f32_16x16x32_bf16 v[64:67], a[12:15], v[120:123], v[64:67]
  ds_read_b128 a[4:7], v4 offset:54272
  v_fma_f32 v25, v25, v14, v14
  v_fma_f32 v26, v26, v14, v14
  v_mfma_f32_16x16x32_bf16 v[64:67], a[8:11], v[112:115], v[64:67]
  buffer_load_dwordx4 v[100:103], v28, s[48:51], s33 offen offset:0 sc1
  s_waitcnt lgkmcnt(2)
  v_mfma_f32_16x16x32_bf16 v[64:67], a[16:19], v[128:131], v[64:67]
  ds_read_b128 a[8:11], v4 offset:51200
  v_fma_f32 v27, v27, v14, v14
  v_mfma_f32_16x16x32_bf16 v[64:67], a[20:23], v[136:139], v[64:67]
  v_rcp_f32 v24, v24
  v_rcp_f32 v25, v25
  v_mfma_f32_16x16x32_bf16 v[68:71], a[20:23], v[140:143], v[68:71]
  ds_read_b128 a[12:15], v4 offset:53248
  v_rcp_f32 v26, v26
  v_mfma_f32_16x16x32_bf16 v[68:71], a[16:19], v[132:135], v[68:71]
  buffer_load_dwordx4 v[108:111], v28, s[48:51], s35 offen offset:0 sc1
  v_mfma_f32_16x16x32_bf16 v[76:79], a[24:27], v[132:135], v[76:79]
  ds_read_b128 a[16:19], v4 offset:55296
  v_rcp_f32 v27, v27
  v_mfma_f32_16x16x32_bf16 v[76:79], a[28:31], v[140:143], v[76:79]
  v_mul_f32 v44, v44, v24
  v_mul_f32 v45, v45, v25
  v_mul_f32 v46, v46, v26
  v_mfma_f32_16x16x32_bf16 v[72:75], a[28:31], v[136:139], v[72:75]
  ds_read_b128 a[20:23], v4 offset:57344
  v_mul_f32 v47, v47, v27
  v_mfma_f32_16x16x32_bf16 v[72:75], a[24:27], v[128:131], v[72:75]
  buffer_load_dwordx4 v[104:107], v28, s[48:51], s34 offen offset:0 sc1
  s_waitcnt lgkmcnt(2)
  v_mfma_f32_16x16x32_bf16 v[72:75], a[0:3], v[144:147], v[72:75]
  ds_read_b128 a[24:27], v4 offset:56320
  v_cvt_pk_bf16_f32 v34, v44, v45
  v_cvt_pk_bf16_f32 v35, v46, v47
  v_mfma_f32_16x16x32_bf16 v[72:75], a[4:7], v[152:155], v[72:75]
  v_permlane16_swap_b32 v32, v34
  v_permlane16_swap_b32 v33, v35
  v_mfma_f32_16x16x32_bf16 v[76:79], a[4:7], v[156:159], v[76:79]
  ds_read_b128 a[28:31], v4 offset:58368
  v_min_u32 v35, -2, v35
  v_mfma_f32_16x16x32_bf16 v[76:79], a[0:3], v[148:151], v[76:79]
  buffer_load_dwordx4 v[112:115], v28, s[48:51], s28 offen offset:512 sc1
  v_mfma_f32_16x16x32_bf16 v[68:71], a[8:11], v[148:151], v[68:71]
  ds_read_b128 a[0:3], v4 offset:60416
  v_mul_f32 v20, v48, v48
  v_mfma_f32_16x16x32_bf16 v[68:71], a[12:15], v[156:159], v[68:71]
  v_mul_f32 v21, v49, v49
  v_mul_f32 v22, v50, v50
  v_mul_f32 v23, v51, v51
  v_mfma_f32_16x16x32_bf16 v[64:67], a[12:15], v[152:155], v[64:67]
  ds_read_b128 a[4:7], v4 offset:62464
  v_fma_f32 v20, v20, v10, v9
  v_fma_f32 v21, v21, v10, v9
  v_mfma_f32_16x16x32_bf16 v[64:67], a[8:11], v[144:147], v[64:67]
  buffer_store_dwordx4 v[32:35], v8, s[36:39], s68 offen offset:2048 sc1
  s_waitcnt lgkmcnt(2)
  v_mfma_f32_16x16x32_bf16 v[64:67], a[16:19], v[160:163], v[64:67]
  ds_read_b128 a[8:11], v4 offset:59392
  v_fma_f32 v22, v22, v10, v9
  v_mfma_f32_16x16x32_bf16 v[64:67], a[20:23], v[168:171], v[64:67]
  buffer_load_dwordx4 v[116:119], v28, s[48:51], s29 offen offset:512 sc1
  v_fma_f32 v23, v23, v10, v9
  v_mfma_f32_16x16x32_bf16 v[68:71], a[20:23], v[172:175], v[68:71]
  ds_read_b128 a[12:15], v4 offset:61440
  v_mul_f32 v20, v48, v20
  v_mfma_f32_16x16x32_bf16 v[68:71], a[16:19], v[164:167], v[68:71]
  v_mul_f32 v21, v49, v21
  v_mul_f32 v22, v50, v22
  v_mul_f32 v23, v51, v23
  v_mfma_f32_16x16x32_bf16 v[76:79], a[24:27], v[164:167], v[76:79]
  ds_read_b128 a[16:19], v4 offset:63488
  v_exp_f32 v20, v20
  v_mfma_f32_16x16x32_bf16 v[76:79], a[28:31], v[172:175], v[76:79]
  buffer_load_dwordx4 v[124:127], v28, s[48:51], s31 offen offset:512 sc1
  v_mfma_f32_16x16x32_bf16 v[72:75], a[28:31], v[168:171], v[72:75]
  ds_read_b128 a[20:23], v5 offset:0
  v_mul_f32 v56, v48, v56
  v_mfma_f32_16x16x32_bf16 v[72:75], a[24:27], v[160:163], v[72:75]
  v_exp_f32 v21, v21
  v_mul_f32 v57, v49, v57
  s_waitcnt lgkmcnt(2)
  v_mfma_f32_16x16x32_bf16 v[72:75], a[0:3], v[176:179], v[72:75]
  ds_read_b128 a[24:27], v4 offset:64512
  v_exp_f32 v22, v22
  v_mfma_f32_16x16x32_bf16 v[72:75], a[4:7], v[184:187], v[72:75]
  buffer_load_dwordx4 v[120:123], v28, s[48:51], s30 offen offset:512 sc1
  v_mfma_f32_16x16x32_bf16 v[76:79], a[4:7], v[188:191], v[76:79]
  ds_read_b128 a[28:31], v5 offset:1024
  v_mul_f32 v58, v50, v58
  v_mfma_f32_16x16x32_bf16 v[76:79], a[0:3], v[180:183], v[76:79]
  v_exp_f32 v23, v23
  v_mul_f32 v59, v51, v59
  v_mfma_f32_16x16x32_bf16 v[68:71], a[8:11], v[180:183], v[68:71]
  ds_read_b128 a[0:3], v5 offset:3072
  v_fma_f32 v20, v20, v11, v11
  v_mfma_f32_16x16x32_bf16 v[68:71], a[12:15], v[188:191], v[68:71]
  buffer_load_dwordx4 v[128:131], v28, s[48:51], s32 offen offset:512 sc1
  v_mfma_f32_16x16x32_bf16 v[64:67], a[12:15], v[184:187], v[64:67]
  ds_read_b128 a[4:7], v5 offset:5120
  v_fma_f32 v21, v21, v11, v11
  v_fma_f32 v22, v22, v11, v11
  v_mfma_f32_16x16x32_bf16 v[64:67], a[8:11], v[176:179], v[64:67]
  v_fma_f32 v23, v23, v11, v11
  v_rcp_f32 v20, v20
  s_waitcnt lgkmcnt(2)
  v_mfma_f32_16x16x32_bf16 v[64:67], a[16:19], v[192:195], v[64:67]
  ds_read_b128 a[8:11], v5 offset:2048
  v_rcp_f32 v21, v21
  v_mfma_f32_16x16x32_bf16 v[64:67], a[20:23], v[200:203], v[64:67]
  buffer_load_dwordx4 v[132:135], v28, s[48:51], s33 offen offset:512 sc1
  v_mfma_f32_16x16x32_bf16 v[68:71], a[20:23], v[204:207], v[68:71]
  ds_read_b128 a[12:15], v5 offset:4096
  v_mfma_f32_16x16x32_bf16 v[68:71], a[16:19], v[196:199], v[68:71]
  v_rcp_f32 v22, v22
  v_rcp_f32 v23, v23
  v_mfma_f32_16x16x32_bf16 v[76:79], a[24:27], v[196:199], v[76:79]
  ds_read_b128 a[16:19], v5 offset:6144
  v_mul_f32 v56, v56, v20
  v_mfma_f32_16x16x32_bf16 v[76:79], a[28:31], v[204:207], v[76:79]
  buffer_load_dwordx4 v[140:143], v28, s[48:51], s35 offen offset:512 sc1
  v_mfma_f32_16x16x32_bf16 v[72:75], a[28:31], v[200:203], v[72:75]
  ds_read_b128 a[20:23], v5 offset:8192
  v_mul_f32 v57, v57, v21
  v_mul_f32 v58, v58, v22
  v_mfma_f32_16x16x32_bf16 v[72:75], a[24:27], v[192:195], v[72:75]
  v_mul_f32 v59, v59, v23
  v_cvt_pk_bf16_f32 v48, v56, v57
  v_cvt_pk_bf16_f32 v49, v58, v59
  s_waitcnt lgkmcnt(2)
  v_mfma_f32_16x16x32_bf16 v[72:75], a[0:3], v[208:211], v[72:75]
  ds_read_b128 a[24:27], v5 offset:7168
  v_mul_f32 v24, v52, v52
  v_mfma_f32_16x16x32_bf16 v[72:75], a[4:7], v[216:219], v[72:75]
  buffer_load_dwordx4 v[136:139], v28, s[48:51], s34 offen offset:512 sc1
  v_mfma_f32_16x16x32_bf16 v[76:79], a[4:7], v[220:223], v[76:79]
  ds_read_b128 a[28:31], v5 offset:9216
  v_mul_f32 v25, v53, v53
  v_mul_f32 v26, v54, v54
  v_mfma_f32_16x16x32_bf16 v[76:79], a[0:3], v[212:215], v[76:79]
  buffer_load_dwordx4 v[144:147], v28, s[48:51], s28 offen offset:1024 sc1
  v_mfma_f32_16x16x32_bf16 v[68:71], a[8:11], v[212:215], v[68:71]
  ds_read_b128 a[0:3], v5 offset:11264
  v_mul_f32 v27, v55, v55
  v_mfma_f32_16x16x32_bf16 v[68:71], a[12:15], v[220:223], v[68:71]
  v_fma_f32 v24, v24, v13, v12
  v_fma_f32 v25, v25, v13, v12
  v_fma_f32 v26, v26, v13, v12
  v_mfma_f32_16x16x32_bf16 v[64:67], a[12:15], v[216:219], v[64:67]
  ds_read_b128 a[4:7], v5 offset:13312
  v_fma_f32 v27, v27, v13, v12
  v_mul_f32 v24, v52, v24
  v_mfma_f32_16x16x32_bf16 v[64:67], a[8:11], v[208:211], v[64:67]
  buffer_load_dwordx4 v[148:151], v28, s[48:51], s29 offen offset:1024 sc1
  s_waitcnt lgkmcnt(2)
  v_mfma_f32_16x16x32_bf16 v[64:67], a[16:19], v[224:227], v[64:67]
  ds_read_b128 a[8:11], v5 offset:10240
  v_mul_f32 v25, v53, v25
  v_mfma_f32_16x16x32_bf16 v[64:67], a[20:23], v[232:235], v[64:67]
  v_mul_f32 v26, v54, v26
  v_mul_f32 v27, v55, v27
  v_exp_f32 v24, v24
  v_mfma_f32_16x16x32_bf16 v[68:71], a[20:23], v[236:239], v[68:71]
  ds_read_b128 a[12:15], v5 offset:12288
  v_mul_f32 v60, v52, v60
  v_mfma_f32_16x16x32_bf16 v[68:71], a[16:19], v[228:231], v[68:71]
  buffer_load_dwordx4 v[36:39], v28, s[48:51], s31 offen offset:1024 sc1
  v_mfma_f32_16x16x32_bf16 v[76:79], a[24:27], v[228:231], v[76:79]
  v_add_u32 v7, 0xa400, v7
  ds_read2_b32 a[16:17], v7 offset0:0 offset1:16
  v_exp_f32 v25, v25
  v_mfma_f32_16x16x32_bf16 v[76:79], a[28:31], v[236:239], v[76:79]
  v_mul_f32 v61, v53, v61
  v_exp_f32 v26, v26
  v_mfma_f32_16x16x32_bf16 v[72:75], a[28:31], v[232:235], v[72:75]
  ds_read2_b32 a[20:21], v7 offset0:128 offset1:144
  v_mfma_f32_16x16x32_bf16 v[72:75], a[24:27], v[224:227], v[72:75]
  buffer_load_dwordx4 v[32:35], v28, s[48:51], s30 offen offset:1024 sc1
  v_mul_f32 v62, v54, v62
  s_waitcnt lgkmcnt(2)
  v_mfma_f32_16x16x32_bf16 v[72:75], a[0:3], v[240:243], v[72:75]
  v_exp_f32 v27, v27
  v_mul_f32 v63, v55, v63
  v_mfma_f32_16x16x32_bf16 v[72:75], a[4:7], v[248:251], v[72:75]
  v_fma_f32 v24, v24, v14, v14
  v_fma_f32 v25, v25, v14, v14
  v_mfma_f32_16x16x32_bf16 v[76:79], a[4:7], v[252:255], v[76:79]
  buffer_load_dwordx4 v[40:43], v28, s[48:51], s32 offen offset:1024 sc1
  v_fma_f32 v26, v26, v14, v14
  v_mfma_f32_16x16x32_bf16 v[76:79], a[0:3], v[244:247], v[76:79]
  v_fma_f32 v27, v27, v14, v14
  v_rcp_f32 v24, v24
  v_mfma_f32_16x16x32_bf16 v[68:71], a[8:11], v[244:247], v[68:71]
  v_rcp_f32 v25, v25
  v_mfma_f32_16x16x32_bf16 v[68:71], a[12:15], v[252:255], v[68:71]
  v_rcp_f32 v26, v26
  v_rcp_f32 v27, v27
  v_mfma_f32_16x16x32_bf16 v[64:67], a[12:15], v[248:251], v[64:67]
  buffer_load_dwordx4 v[44:47], v28, s[48:51], s33 offen offset:1024 sc1
  v_mfma_f32_16x16x32_bf16 v[64:67], a[8:11], v[240:243], v[64:67]
  v_mul_f32 v60, v60, v24
  v_mul_f32 v61, v61, v25
  s_waitcnt lgkmcnt(0)
  v_mfma_f32_16x16x32_bf16 v[64:67], a[16:19], a[32:35], v[64:67]
  v_mul_f32 v62, v62, v26
  v_mul_f32 v63, v63, v27
  v_cvt_pk_bf16_f32 v50, v60, v61
  v_mfma_f32_16x16x32_bf16 v[68:71], a[16:19], a[36:39], v[68:71]
  buffer_load_dwordx4 a[96:99], v0, s[44:47], s100 offen sc1
  v_add_u32 v0, 40960, v0
  v_mfma_f32_16x16x32_bf16 v[76:79], a[20:23], a[36:39], v[76:79]
  v_cvt_pk_bf16_f32 v51, v62, v63
  v_permlane16_swap_b32 v48, v50
  v_mfma_f32_16x16x32_bf16 v[72:75], a[20:23], a[32:35], v[72:75]
  v_permlane16_swap_b32 v49, v51
  v_min_u32 v51, -2, v51
sequential_preLN__ssm_conv_s4__geglu_ffn__prompt_kernel_uj44:
  s_waitcnt vmcnt(27)
  v_mfma_f32_16x16x32_bf16 v[152:155], a[252:255], v[80:83], 0
  s_waitcnt vmcnt(26)
  v_mfma_f32_16x16x32_bf16 v[152:155], a[232:235], v[84:87], v[152:155]
  buffer_store_dwordx4 v[48:51], v8, s[36:39], s68 offen offset:2560 sc1
  v_mfma_f32_16x16x32_bf16 v[156:159], a[228:231], v[84:87], 0
  v_mul_f32 v20, v64, v64
  v_mul_f32 v21, v65, v65
  v_mfma_f32_16x16x32_bf16 v[156:159], a[248:251], v[80:83], v[156:159]
  v_mul_f32 v22, v66, v66
  v_mul_f32 v23, v67, v67
  v_fma_f32 v20, v20, v10, v9
  v_mfma_f32_16x16x32_bf16 v[160:163], a[244:247], v[80:83], 0
  v_fma_f32 v21, v21, v10, v9
  v_fma_f32 v22, v22, v10, v9
  v_mfma_f32_16x16x32_bf16 v[160:163], a[224:227], v[84:87], v[160:163]
  buffer_load_dwordx4 a[92:95], v0, s[44:47], 0 offen offset:0 sc1
  v_mfma_f32_16x16x32_bf16 v[164:167], a[220:223], v[84:87], 0
  v_fma_f32 v23, v23, v10, v9
  v_mul_f32 v20, v64, v20
  v_mul_f32 v21, v65, v21
  v_mfma_f32_16x16x32_bf16 v[164:167], a[240:243], v[80:83], v[164:167]
  v_mul_f32 v22, v66, v22
  v_mul_f32 v23, v67, v23
  v_mfma_f32_16x16x32_bf16 v[168:171], a[236:239], v[80:83], 0
  v_exp_f32 v20, v20
  v_mfma_f32_16x16x32_bf16 v[168:171], a[216:219], v[84:87], v[168:171]
  buffer_load_dwordx4 a[88:91], v0, s[44:47], 0 offen offset:1024 sc1
  v_mul_f32 v72, v64, v72
  s_waitcnt vmcnt(28)
  v_mfma_f32_16x16x32_bf16 v[188:191], a[216:219], v[92:95], 0
  v_exp_f32 v21, v21
  s_waitcnt vmcnt(27)
  v_mfma_f32_16x16x32_bf16 v[188:191], a[236:239], v[88:91], v[188:191]
  v_mul_f32 v73, v65, v73
  v_exp_f32 v22, v22
  v_mfma_f32_16x16x32_bf16 v[184:187], a[240:243], v[88:91], 0
  buffer_load_dwordx4 v[84:87], v28, s[48:51], s35 offen offset:1024 sc1
  v_mfma_f32_16x16x32_bf16 v[184:187], a[220:223], v[92:95], v[184:187]
  v_mul_f32 v74, v66, v74
  v_mfma_f32_16x16x32_bf16 v[180:183], a[224:227], v[92:95], 0
  v_exp_f32 v23, v23
  v_mul_f32 v75, v67, v75
  v_mfma_f32_16x16x32_bf16 v[180:183], a[244:247], v[88:91], v[180:183]
  v_fma_f32 v20, v20, v11, v11
  v_fma_f32 v21, v21, v11, v11
  v_fma_f32 v22, v22, v11, v11
  v_mfma_f32_16x16x32_bf16 v[176:179], a[248:251], v[88:91], 0
  buffer_load_dwordx4 v[80:83], v28, s[48:51], s34 offen offset:1024 sc1
  v_mfma_f32_16x16x32_bf16 v[176:179], a[228:231], v[92:95], v[176:179]
  v_fma_f32 v23, v23, v11, v11
  v_rcp_f32 v20, v20
  v_mfma_f32_16x16x32_bf16 v[172:175], a[232:235], v[92:95], 0
  v_rcp_f32 v21, v21
  v_mfma_f32_16x16x32_bf16 v[172:175], a[252:255], v[88:91], v[172:175]
  v_rcp_f32 v22, v22
  s_waitcnt vmcnt(24)
  v_mfma_f32_16x16x32_bf16 v[192:195], a[252:255], v[96:99], 0
  buffer_load_dwordx4 v[92:95], v28, s[48:51], s29 offen offset:1536 sc1
  s_waitcnt vmcnt(24)
  v_mfma_f32_16x16x32_bf16 v[192:195], a[232:235], v[100:103], v[192:195]
  v_rcp_f32 v23, v23
  v_mfma_f32_16x16x32_bf16 v[196:199], a[228:231], v[100:103], 0
  v_mul_f32 v72, v72, v20
  v_mul_f32 v73, v73, v21
  v_mul_f32 v74, v74, v22
  v_mfma_f32_16x16x32_bf16 v[196:199], a[248:251], v[96:99], v[196:199]
  buffer_load_dwordx4 v[88:91], v28, s[48:51], s28 offen offset:1536 sc1
  v_mfma_f32_16x16x32_bf16 v[200:203], a[244:247], v[96:99], 0
  v_mul_f32 v75, v75, v23
  v_cvt_pk_bf16_f32 v64, v72, v73
  v_mfma_f32_16x16x32_bf16 v[200:203], a[224:227], v[100:103], v[200:203]
  v_cvt_pk_bf16_f32 v65, v74, v75
  v_mul_f32 v24, v68, v68
  v_mul_f32 v25, v69, v69
  v_mfma_f32_16x16x32_bf16 v[204:207], a[220:223], v[100:103], 0
  v_mul_f32 v26, v70, v70
  v_mul_f32 v27, v71, v71
  v_mfma_f32_16x16x32_bf16 v[204:207], a[240:243], v[96:99], v[204:207]
  buffer_load_dwordx4 a[84:87], v0, s[44:47], 0 offen offset:2048 sc1
  v_mfma_f32_16x16x32_bf16 v[208:211], a[236:239], v[96:99], 0
  v_fma_f32 v24, v24, v13, v12
  v_fma_f32 v25, v25, v13, v12
  v_fma_f32 v26, v26, v13, v12
  v_mfma_f32_16x16x32_bf16 v[208:211], a[216:219], v[100:103], v[208:211]
  v_fma_f32 v27, v27, v13, v12
  v_mul_f32 v24, v68, v24
  s_waitcnt vmcnt(25)
  v_mfma_f32_16x16x32_bf16 v[228:231], a[216:219], v[108:111], 0
  v_mul_f32 v25, v69, v25
  v_mul_f32 v26, v70, v26
  s_waitcnt vmcnt(24)
  v_mfma_f32_16x16x32_bf16 v[228:231], a[236:239], v[104:107], v[228:231]
  buffer_load_dwordx4 v[100:103], v28, s[48:51], s31 offen offset:1536 sc1
  v_mul_f32 v27, v71, v27
  v_mfma_f32_16x16x32_bf16 v[224:227], a[240:243], v[104:107], 0
  v_exp_f32 v24, v24
  v_mfma_f32_16x16x32_bf16 v[224:227], a[220:223], v[108:111], v[224:227]
  v_mul_f32 v76, v68, v76
  v_exp_f32 v25, v25
  v_mfma_f32_16x16x32_bf16 v[220:223], a[224:227], v[108:111], 0
  v_mul_f32 v77, v69, v77
  v_mfma_f32_16x16x32_bf16 v[220:223], a[244:247], v[104:107], v[220:223]
  buffer_load_dwordx4 v[96:99], v28, s[48:51], s30 offen offset:1536 sc1
  v_mfma_f32_16x16x32_bf16 v[216:219], a[248:251], v[104:107], 0
  v_exp_f32 v26, v26
  v_mul_f32 v78, v70, v78
  v_mfma_f32_16x16x32_bf16 v[216:219], a[228:231], v[108:111], v[216:219]
  v_exp_f32 v27, v27
  v_mul_f32 v79, v71, v79
  v_mfma_f32_16x16x32_bf16 v[212:215], a[232:235], v[108:111], 0
  buffer_load_dwordx4 a[80:83], v0, s[44:47], 0 offen offset:3072 sc1
  s_waitcnt vmcnt(24)
  v_max_u32 v31, v115, v119
  v_cmp_eq_u32 vcc, -1, v31
  v_mfma_f32_16x16x32_bf16 v[212:215], a[252:255], v[104:107], v[212:215]
  v_fma_f32 v24, v24, v14, v14
  v_fma_f32 v25, v25, v14, v14
  s_cbranch_vccnz sequential_preLN__ssm_conv_s4__geglu_ffn__prompt_kernel_ar23
sequential_preLN__ssm_conv_s4__geglu_ffn__prompt_kernel_ar23_b:
  v_mfma_f32_16x16x32_bf16 v[152:155], a[212:215], v[112:115], v[152:155]
  v_fma_f32 v26, v26, v14, v14
  v_fma_f32 v27, v27, v14, v14
  v_mfma_f32_16x16x32_bf16 v[152:155], a[192:195], v[116:119], v[152:155]
  v_rcp_f32 v24, v24
  v_mfma_f32_16x16x32_bf16 v[156:159], a[188:191], v[116:119], v[156:159]
  buffer_load_dwordx4 v[104:107], v28, s[48:51], s32 offen offset:1536 sc1
  v_rcp_f32 v25, v25
  v_mfma_f32_16x16x32_bf16 v[156:159], a[208:211], v[112:115], v[156:159]
  v_rcp_f32 v26, v26
  v_mfma_f32_16x16x32_bf16 v[160:163], a[204:207], v[112:115], v[160:163]
  v_rcp_f32 v27, v27
  v_mfma_f32_16x16x32_bf16 v[160:163], a[184:187], v[116:119], v[160:163]
  v_mul_f32 v76, v76, v24
  v_mul_f32 v77, v77, v25
  v_mfma_f32_16x16x32_bf16 v[164:167], a[180:183], v[116:119], v[164:167]
  buffer_load_dwordx4 v[108:111], v28, s[48:51], s33 offen offset:1536 sc1
  v_mul_f32 v78, v78, v26
  v_mfma_f32_16x16x32_bf16 v[164:167], a[200:203], v[112:115], v[164:167]
  v_mul_f32 v79, v79, v27
  v_cvt_pk_bf16_f32 v66, v76, v77
  v_mfma_f32_16x16x32_bf16 v[168:171], a[196:199], v[112:115], v[168:171]
  v_cvt_pk_bf16_f32 v67, v78, v79
  v_permlane16_swap_b32 v64, v66
  s_waitcnt vmcnt(24)
  v_max_u32 v31, v123, v127
  v_cmp_eq_u32 vcc, -1, v31
  v_mfma_f32_16x16x32_bf16 v[168:171], a[176:179], v[116:119], v[168:171]
  buffer_load_dwordx4 v[112:115], v28, s[48:51], s34 offen offset:1536 sc1
  s_cbranch_vccnz sequential_preLN__ssm_conv_s4__geglu_ffn__prompt_kernel_ar24
sequential_preLN__ssm_conv_s4__geglu_ffn__prompt_kernel_ar24_b:
  v_mfma_f32_16x16x32_bf16 v[188:191], a[176:179], v[124:127], v[188:191]
  v_add_u32 v6, s6, v3
  v_mfma_f32_16x16x32_bf16 v[188:191], a[196:199], v[120:123], v[188:191]
  v_permlane16_swap_b32 v65, v67
  v_min_u32 v67, -2, v67
  v_mfma_f32_16x16x32_bf16 v[184:187], a[200:203], v[120:123], v[184:187]
  v_mfma_f32_16x16x32_bf16 v[184:187], a[180:183], v[124:127], v[184:187]
  buffer_store_dwordx4 v[64:67], v8, s[36:39], s66 offen offset:3072 sc1
  v_mfma_f32_16x16x32_bf16 v[180:183], a[184:187], v[124:127], v[180:183]
  v_mfma_f32_16x16x32_bf16 v[180:183], a[204:207], v[120:123], v[180:183]
  v_mfma_f32_16x16x32_bf16 v[176:179], a[208:211], v[120:123], v[176:179]
  ds_read_b128 a[4:7], v6 offset:0
  v_mfma_f32_16x16x32_bf16 v[176:179], a[188:191], v[124:127], v[176:179]
  buffer_load_dwordx4 v[116:119], v28, s[48:51], s35 offen offset:1536 sc1
  v_mfma_f32_16x16x32_bf16 v[172:175], a[192:195], v[124:127], v[172:175]
  s_waitcnt vmcnt(25)
  v_max_u32 v31, v131, v135
  v_cmp_eq_u32 vcc, -1, v31
  v_mfma_f32_16x16x32_bf16 v[172:175], a[212:215], v[120:123], v[172:175]
  ds_read_b128 a[8:11], v6 offset:1024
  s_cbranch_vccnz sequential_preLN__ssm_conv_s4__geglu_ffn__prompt_kernel_ar25
sequential_preLN__ssm_conv_s4__geglu_ffn__prompt_kernel_ar25_b:
  v_mfma_f32_16x16x32_bf16 v[192:195], a[212:215], v[128:131], v[192:195]
  v_mfma_f32_16x16x32_bf16 v[192:195], a[192:195], v[132:135], v[192:195]
  buffer_load_dwordx4 v[120:123], v28, s[48:51], s28 offen offset:2048 sc1
  v_mfma_f32_16x16x32_bf16 v[196:199], a[188:191], v[132:135], v[196:199]
  ds_read_b128 a[12:15], v6 offset:2048
  v_mfma_f32_16x16x32_bf16 v[196:199], a[208:211], v[128:131], v[196:199]
  v_mfma_f32_16x16x32_bf16 v[200:203], a[204:207], v[128:131], v[200:203]
  buffer_load_dwordx4 v[124:127], v28, s[48:51], s29 offen offset:2048 sc1
  v_mfma_f32_16x16x32_bf16 v[200:203], a[184:187], v[132:135], v[200:203]
  ds_read_b128 a[16:19], v6 offset:3072
  v_mfma_f32_16x16x32_bf16 v[204:207], a[180:183], v[132:135], v[204:207]
  v_mfma_f32_16x16x32_bf16 v[204:207], a[200:203], v[128:131], v[204:207]
  v_mfma_f32_16x16x32_bf16 v[208:211], a[196:199], v[128:131], v[208:211]
  buffer_load_dwordx4 a[76:79], v0, s[44:47], s100 offen sc1
  v_add_u32 v0, 40960, v0
  ds_read_b128 a[24:27], v6 offset:16384
  s_waitcnt vmcnt(26)
  v_max_u32 v31, v139, v143
  v_cmp_eq_u32 vcc, -1, v31
  v_mfma_f32_16x16x32_bf16 v[208:211], a[176:179], v[132:135], v[208:211]
  s_cbranch_vccnz sequential_preLN__ssm_conv_s4__geglu_ffn__prompt_kernel_ar26
sequential_preLN__ssm_conv_s4__geglu_ffn__prompt_kernel_ar26_b:
  v_mfma_f32_16x16x32_bf16 v[228:231], a[176:179], v[140:143], v[228:231]
  v_mfma_f32_16x16x32_bf16 v[228:231], a[196:199], v[136:139], v[228:231]
  ds_read_b128 a[28:31], v6 offset:17408
  v_mfma_f32_16x16x32_bf16 v[224:227], a[200:203], v[136:139], v[224:227]
  buffer_load_dwordx4 v[132:135], v28, s[48:51], s31 offen offset:2048 sc1
  v_mfma_f32_16x16x32_bf16 v[224:227], a[180:183], v[140:143], v[224:227]
  v_mfma_f32_16x16x32_bf16 v[220:223], a[184:187], v[140:143], v[220:223]
  ds_read_b128 a[32:35], v6 offset:18432
  v_mfma_f32_16x16x32_bf16 v[220:223], a[204:207], v[136:139], v[220:223]
  buffer_load_dwordx4 v[128:131], v28, s[48:51], s30 offen offset:2048 sc1
  v_mfma_f32_16x16x32_bf16 v[216:219], a[208:211], v[136:139], v[216:219]
  v_mfma_f32_16x16x32_bf16 v[216:219], a[188:191], v[140:143], v[216:219]
  ds_read_b128 a[36:39], v6 offset:19456
  v_mfma_f32_16x16x32_bf16 v[212:215], a[192:195], v[140:143], v[212:215]
  s_waitcnt vmcnt(26)
  v_max_u32 v31, v147, v151
  v_cmp_eq_u32 vcc, -1, v31
  v_mfma_f32_16x16x32_bf16 v[212:215], a[212:215], v[136:139], v[212:215]
  buffer_load_dwordx4 a[72:75], v0, s[44:47], 0 offen offset:0 sc1
  s_cbranch_vccnz sequential_preLN__ssm_conv_s4__geglu_ffn__prompt_kernel_ar27
sequential_preLN__ssm_conv_s4__geglu_ffn__prompt_kernel_ar27_b:
  v_mfma_f32_16x16x32_bf16 v[152:155], a[172:175], v[144:147], v[152:155]
  ds_read_b128 a[248:251], v6 offset:32768
  v_mfma_f32_16x16x32_bf16 v[152:155], a[152:155], v[148:151], v[152:155]
  v_mfma_f32_16x16x32_bf16 v[156:159], a[148:151], v[148:151], v[156:159]
  v_mfma_f32_16x16x32_bf16 v[156:159], a[168:171], v[144:147], v[156:159]
  buffer_load_dwordx4 a[68:71], v0, s[44:47], 0 offen offset:1024 sc1
  ds_read_b128 a[244:247], v6 offset:33792
  v_mfma_f32_16x16x32_bf16 v[160:163], a[164:167], v[144:147], v[160:163]
  v_mfma_f32_16x16x32_bf16 v[160:163], a[144:147], v[148:151], v[160:163]
  v_mfma_f32_16x16x32_bf16 v[164:167], a[140:143], v[148:151], v[164:167]
  ds_read_b128 a[240:243], v6 offset:34816
  v_mfma_f32_16x16x32_bf16 v[164:167], a[160:163], v[144:147], v[164:167]
  buffer_load_dwordx4 a[64:67], v0, s[44:47], 0 offen offset:2048 sc1
  v_mfma_f32_16x16x32_bf16 v[168:171], a[156:159], v[144:147], v[168:171]
  s_waitcnt vmcnt(27)
  v_max_u32 v31, v35, v39
  v_cmp_eq_u32 vcc, -1, v31
  v_mfma_f32_16x16x32_bf16 v[168:171], a[136:139], v[148:151], v[168:171]
  ds_read_b128 a[236:239], v6 offset:35840
  s_cbranch_vccnz sequential_preLN__ssm_conv_s4__geglu_ffn__prompt_kernel_ar28
sequential_preLN__ssm_conv_s4__geglu_ffn__prompt_kernel_ar28_b:
  v_mfma_f32_16x16x32_bf16 v[188:191], a[136:139], v[36:39], v[188:191]
  buffer_load_dwordx4 a[60:63], v0, s[44:47], 0 offen offset:3072 sc1
  v_mfma_f32_16x16x32_bf16 v[188:191], a[156:159], v[32:35], v[188:191]
  v_mfma_f32_16x16x32_bf16 v[184:187], a[160:163], v[32:35], v[184:187]
  ds_read_b128 a[0:3], v6 offset:49152
  v_mfma_f32_16x16x32_bf16 v[184:187], a[140:143], v[36:39], v[184:187]
  v_mfma_f32_16x16x32_bf16 v[180:183], a[144:147], v[36:39], v[180:183]
  buffer_load_dwordx4 v[136:139], v28, s[48:51], s32 offen offset:2048 sc1
  v_mfma_f32_16x16x32_bf16 v[180:183], a[164:167], v[32:35], v[180:183]
  ds_read_b128 a[20:23], v6 offset:50176
  v_mfma_f32_16x16x32_bf16 v[176:179], a[168:171], v[32:35], v[176:179]
  v_mfma_f32_16x16x32_bf16 v[176:179], a[148:151], v[36:39], v[176:179]
  v_mfma_f32_16x16x32_bf16 v[172:175], a[152:155], v[36:39], v[172:175]
  buffer_load_dwordx4 v[140:143], v28, s[48:51], s33 offen offset:2048 sc1
  ds_read_b128 a[252:255], v6 offset:51200
  s_waitcnt vmcnt(28)
  v_max_u32 v31, v43, v47
  v_cmp_eq_u32 vcc, -1, v31
  v_mfma_f32_16x16x32_bf16 v[172:175], a[172:175], v[32:35], v[172:175]
  s_cbranch_vccnz sequential_preLN__ssm_conv_s4__geglu_ffn__prompt_kernel_ar29
sequential_preLN__ssm_conv_s4__geglu_ffn__prompt_kernel_ar29_b:
  v_mfma_f32_16x16x32_bf16 v[192:195], a[172:175], v[40:43], v[192:195]
  v_mfma_f32_16x16x32_bf16 v[192:195], a[152:155], v[44:47], v[192:195]
  buffer_load_dwordx4 a[56:59], v0, s[44:47], s100 offen sc1
  v_add_u32 v0, 40960, v0
  ds_read_b128 a[232:235], v6 offset:52224
  v_mfma_f32_16x16x32_bf16 v[196:199], a[148:151], v[44:47], v[196:199]
  v_mfma_f32_16x16x32_bf16 v[196:199], a[168:171], v[40:43], v[196:199]
  v_mfma_f32_16x16x32_bf16 v[200:203], a[164:167], v[40:43], v[200:203]
  v_mfma_f32_16x16x32_bf16 v[200:203], a[144:147], v[44:47], v[200:203]
  buffer_load_dwordx4 v[148:151], v28, s[48:51], s35 offen offset:2048 sc1
  v_mfma_f32_16x16x32_bf16 v[204:207], a[140:143], v[44:47], v[204:207]
  v_mfma_f32_16x16x32_bf16 v[204:207], a[160:163], v[40:43], v[204:207]
  v_mfma_f32_16x16x32_bf16 v[208:211], a[156:159], v[40:43], v[208:211]
  s_waitcnt vmcnt(24)
  v_max_u32 v31, v83, v87
  v_cmp_eq_u32 vcc, -1, v31
  v_mfma_f32_16x16x32_bf16 v[208:211], a[136:139], v[44:47], v[208:211]
  buffer_load_dwordx4 v[144:147], v28, s[48:51], s34 offen offset:2048 sc1
  s_cbranch_vccnz sequential_preLN__ssm_conv_s4__geglu_ffn__prompt_kernel_ar30
sequential_preLN__ssm_conv_s4__geglu_ffn__prompt_kernel_ar30_b:
  v_mfma_f32_16x16x32_bf16 v[228:231], a[136:139], v[84:87], v[228:231]
  v_mfma_f32_16x16x32_bf16 v[228:231], a[156:159], v[80:83], v[228:231]
  v_mfma_f32_16x16x32_bf16 v[224:227], a[160:163], v[80:83], v[224:227]
  v_mfma_f32_16x16x32_bf16 v[224:227], a[140:143], v[84:87], v[224:227]
  buffer_load_dwordx4 v[32:35], v28, s[48:51], s28 offen offset:2560 sc1
  v_mfma_f32_16x16x32_bf16 v[220:223], a[144:147], v[84:87], v[220:223]
  v_mfma_f32_16x16x32_bf16 v[220:223], a[164:167], v[80:83], v[220:223]
  v_mfma_f32_16x16x32_bf16 v[216:219], a[168:171], v[80:83], v[216:219]
  buffer_load_dwordx4 v[36:39], v28, s[48:51], s29 offen offset:2560 sc1
  v_mfma_f32_16x16x32_bf16 v[216:219], a[148:151], v[84:87], v[216:219]
  v_mfma_f32_16x16x32_bf16 v[212:215], a[152:155], v[84:87], v[212:215]
  s_waitcnt vmcnt(25)
  v_max_u32 v31, v91, v95
  v_cmp_eq_u32 vcc, -1, v31
  v_mfma_f32_16x16x32_bf16 v[212:215], a[172:175], v[80:83], v[212:215]
  s_cbranch_vccnz sequential_preLN__ssm_conv_s4__geglu_ffn__prompt_kernel_ar31
sequential_preLN__ssm_conv_s4__geglu_ffn__prompt_kernel_ar31_b:
  v_mfma_f32_16x16x32_bf16 v[152:155], a[132:135], v[88:91], v[152:155]
  buffer_load_dwordx2 v[48:49], v16, s[36:39], s74 offen offset:0 sc1
  v_mfma_f32_16x16x32_bf16 v[152:155], a[112:115], v[92:95], v[152:155]
  v_mfma_f32_16x16x32_bf16 v[156:159], a[108:111], v[92:95], v[156:159]
  v_mfma_f32_16x16x32_bf16 v[156:159], a[128:131], v[88:91], v[156:159]
  v_mfma_f32_16x16x32_bf16 v[160:163], a[124:127], v[88:91], v[160:163]
  buffer_load_dwordx2 v[50:51], v16, s[36:39], s74 offen offset:1024 sc1
  v_mfma_f32_16x16x32_bf16 v[160:163], a[104:107], v[92:95], v[160:163]
  v_mfma_f32_16x16x32_bf16 v[164:167], a[100:103], v[92:95], v[164:167]
  v_mfma_f32_16x16x32_bf16 v[164:167], a[120:123], v[88:91], v[164:167]
  buffer_load_dwordx2 v[52:53], v16, s[36:39], s74 offen offset:2048 sc1
  v_mfma_f32_16x16x32_bf16 v[168:171], a[116:119], v[88:91], v[168:171]
  s_waitcnt vmcnt(25)
  v_max_u32 v31, v99, v103
  v_cmp_eq_u32 vcc, -1, v31
  v_mfma_f32_16x16x32_bf16 v[168:171], a[96:99], v[92:95], v[168:171]
  s_cbranch_vccnz sequential_preLN__ssm_conv_s4__geglu_ffn__prompt_kernel_ar32
sequential_preLN__ssm_conv_s4__geglu_ffn__prompt_kernel_ar32_b:
  v_mfma_f32_16x16x32_bf16 v[188:191], a[96:99], v[100:103], v[188:191]
  v_mfma_f32_16x16x32_bf16 v[188:191], a[116:119], v[96:99], v[188:191]
  buffer_load_dwordx2 v[54:55], v16, s[36:39], s74 offen offset:3072 sc1
  v_mfma_f32_16x16x32_bf16 v[184:187], a[120:123], v[96:99], v[184:187]
  v_mfma_f32_16x16x32_bf16 v[184:187], a[100:103], v[100:103], v[184:187]
  v_mfma_f32_16x16x32_bf16 v[180:183], a[104:107], v[100:103], v[180:183]
  v_mfma_f32_16x16x32_bf16 v[180:183], a[124:127], v[96:99], v[180:183]
  s_add_u32 s64, s74, 4096
  buffer_load_dwordx2 v[56:57], v16, s[36:39], s64 offen sc1
  v_mfma_f32_16x16x32_bf16 v[176:179], a[128:131], v[96:99], v[176:179]
  v_mfma_f32_16x16x32_bf16 v[176:179], a[108:111], v[100:103], v[176:179]
  v_mfma_f32_16x16x32_bf16 v[172:175], a[112:115], v[100:103], v[172:175]
  s_waitcnt vmcnt(24)
  v_max_u32 v31, v107, v111
  v_cmp_eq_u32 vcc, -1, v31
  v_mfma_f32_16x16x32_bf16 v[172:175], a[132:135], v[96:99], v[172:175]
  buffer_load_dwordx4 a[52:55], v0, s[44:47], 0 offen offset:0 sc1
  s_cbranch_vccnz sequential_preLN__ssm_conv_s4__geglu_ffn__prompt_kernel_ar33
sequential_preLN__ssm_conv_s4__geglu_ffn__prompt_kernel_ar33_b:
  v_mfma_f32_16x16x32_bf16 v[192:195], a[132:135], v[104:107], v[192:195]
  v_mfma_f32_16x16x32_bf16 v[192:195], a[112:115], v[108:111], v[192:195]
  v_mfma_f32_16x16x32_bf16 v[196:199], a[108:111], v[108:111], v[196:199]
  buffer_load_dwordx4 v[40:43], v28, s[48:51], s28 offen offset:3072 sc1
  v_mfma_f32_16x16x32_bf16 v[196:199], a[128:131], v[104:107], v[196:199]
  v_mfma_f32_16x16x32_bf16 v[200:203], a[124:127], v[104:107], v[200:203]
  v_mfma_f32_16x16x32_bf16 v[200:203], a[104:107], v[108:111], v[200:203]
  v_mfma_f32_16x16x32_bf16 v[204:207], a[100:103], v[108:111], v[204:207]
  buffer_load_dwordx4 v[44:47], v29, s[48:51], s29 offen offset:3072 sc1
  v_mfma_f32_16x16x32_bf16 v[204:207], a[120:123], v[104:107], v[204:207]
  v_mfma_f32_16x16x32_bf16 v[208:211], a[116:119], v[104:107], v[208:211]
  s_waitcnt vmcnt(24)
  v_max_u32 v31, v115, v119
  v_cmp_eq_u32 vcc, -1, v31
  v_mfma_f32_16x16x32_bf16 v[208:211], a[96:99], v[108:111], v[208:211]
  s_cbranch_vccnz sequential_preLN__ssm_conv_s4__geglu_ffn__prompt_kernel_ar34
sequential_preLN__ssm_conv_s4__geglu_ffn__prompt_kernel_ar34_b:
  v_mfma_f32_16x16x32_bf16 v[228:231], a[96:99], v[116:119], v[228:231]
  buffer_load_dwordx4 a[48:51], v0, s[44:47], 0 offen offset:1024 sc1
  v_mfma_f32_16x16x32_bf16 v[228:231], a[116:119], v[112:115], v[228:231]
  v_mfma_f32_16x16x32_bf16 v[224:227], a[120:123], v[112:115], v[224:227]
  v_mfma_f32_16x16x32_bf16 v[224:227], a[100:103], v[116:119], v[224:227]
  buffer_load_dwordx4 v[80:83], v28, s[48:51], s30 offen offset:2560 sc1
  v_mfma_f32_16x16x32_bf16 v[220:223], a[104:107], v[116:119], v[220:223]
  v_mfma_f32_16x16x32_bf16 v[220:223], a[124:127], v[112:115], v[220:223]
  v_mfma_f32_16x16x32_bf16 v[216:219], a[128:131], v[112:115], v[216:219]
  s_waitcnt lgkmcnt(0)
  s_barrier
  v_mfma_f32_16x16x32_bf16 v[216:219], a[108:111], v[116:119], v[216:219]
  buffer_load_dwordx4 a[44:47], v0, s[44:47], 0 offen offset:2048 sc1
  v_mfma_f32_16x16x32_bf16 v[212:215], a[112:115], v[116:119], v[212:215]
  s_waitcnt vmcnt(25)
  v_max_u32 v31, v123, v127
  v_cmp_eq_u32 vcc, -1, v31
  v_mfma_f32_16x16x32_bf16 v[212:215], a[132:135], v[112:115], v[212:215]
  s_cbranch_vccnz sequential_preLN__ssm_conv_s4__geglu_ffn__prompt_kernel_ar35
sequential_preLN__ssm_conv_s4__geglu_ffn__prompt_kernel_ar35_b:
  v_mfma_f32_16x16x32_bf16 v[152:155], a[92:95], v[120:123], v[152:155]
  s_waitcnt vmcnt(21)
  v_mfma_f32_16x16x32_bf16 v[152:155], a[72:75], v[124:127], v[152:155]
  buffer_load_dwordx4 v[84:87], v28, s[48:51], s31 offen offset:2560 sc1
  s_waitcnt vmcnt(21)
  v_mfma_f32_16x16x32_bf16 v[156:159], a[68:71], v[124:127], v[156:159]
  v_mfma_f32_16x16x32_bf16 v[156:159], a[88:91], v[120:123], v[156:159]
  v_mfma_f32_16x16x32_bf16 v[160:163], a[84:87], v[120:123], v[160:163]
  s_waitcnt vmcnt(20)
  v_mfma_f32_16x16x32_bf16 v[160:163], a[64:67], v[124:127], v[160:163]
  buffer_load_dwordx4 v[88:91], v28, s[48:51], s30 offen offset:3072 sc1
  s_waitcnt vmcnt(20)
  v_mfma_f32_16x16x32_bf16 v[164:167], a[60:63], v[124:127], v[164:167]
  v_mfma_f32_16x16x32_bf16 v[164:167], a[80:83], v[120:123], v[164:167]
  v_mfma_f32_16x16x32_bf16 v[168:171], a[76:79], v[120:123], v[168:171]
  buffer_load_dwordx4 v[92:95], v29, s[48:51], s31 offen offset:3072 sc1
  v_max_u32 v31, v131, v135
  v_cmp_eq_u32 vcc, -1, v31
  s_waitcnt vmcnt(18)
  v_mfma_f32_16x16x32_bf16 v[168:171], a[56:59], v[124:127], v[168:171]
  s_cbranch_vccnz sequential_preLN__ssm_conv_s4__geglu_ffn__prompt_kernel_ar36
sequential_preLN__ssm_conv_s4__geglu_ffn__prompt_kernel_ar36_b:
  v_mfma_f32_16x16x32_bf16 v[188:191], a[56:59], v[132:135], v[188:191]
  v_mfma_f32_16x16x32_bf16 v[188:191], a[76:79], v[128:131], v[188:191]
  v_mfma_f32_16x16x32_bf16 v[184:187], a[80:83], v[128:131], v[184:187]
  buffer_load_dwordx4 a[40:43], v0, s[44:47], 0 offen offset:3072 sc1
  v_mfma_f32_16x16x32_bf16 v[184:187], a[60:63], v[132:135], v[184:187]
  v_mfma_f32_16x16x32_bf16 v[180:183], a[64:67], v[132:135], v[180:183]
  v_mfma_f32_16x16x32_bf16 v[180:183], a[84:87], v[128:131], v[180:183]
  v_mfma_f32_16x16x32_bf16 v[176:179], a[88:91], v[128:131], v[176:179]
  buffer_load_dwordx4 v[96:99], v28, s[48:51], s32 offen offset:2560 sc1
  v_mfma_f32_16x16x32_bf16 v[176:179], a[68:71], v[132:135], v[176:179]
  v_mfma_f32_16x16x32_bf16 v[172:175], a[72:75], v[132:135], v[172:175]
  v_max_u32 v31, v139, v143
  v_cmp_eq_u32 vcc, -1, v31
  v_mfma_f32_16x16x32_bf16 v[172:175], a[92:95], v[128:131], v[172:175]
  s_cbranch_vccnz sequential_preLN__ssm_conv_s4__geglu_ffn__prompt_kernel_ar37
sequential_preLN__ssm_conv_s4__geglu_ffn__prompt_kernel_ar37_b:
  v_mfma_f32_16x16x32_bf16 v[192:195], a[92:95], v[136:139], v[192:195]
  buffer_load_dwordx4 v[100:103], v28, s[48:51], s33 offen offset:2560 sc1
  v_mfma_f32_16x16x32_bf16 v[192:195], a[72:75], v[140:143], v[192:195]
  v_mfma_f32_16x16x32_bf16 v[196:199], a[68:71], v[140:143], v[196:199]
  v_mfma_f32_16x16x32_bf16 v[196:199], a[88:91], v[136:139], v[196:199]
  v_mfma_f32_16x16x32_bf16 v[200:203], a[84:87], v[136:139], v[200:203]
  buffer_load_dwordx4 v[104:107], v28, s[48:51], s32 offen offset:3072 sc1
  v_mfma_f32_16x16x32_bf16 v[200:203], a[64:67], v[140:143], v[200:203]
  v_mfma_f32_16x16x32_bf16 v[204:207], a[60:63], v[140:143], v[204:207]
  v_mfma_f32_16x16x32_bf16 v[204:207], a[80:83], v[136:139], v[204:207]
  v_mfma_f32_16x16x32_bf16 v[208:211], a[76:79], v[136:139], v[208:211]
  buffer_load_dwordx4 v[108:111], v29, s[48:51], s33 offen offset:3072 sc1
  s_waitcnt vmcnt(21)
  v_max_u32 v31, v147, v151
  v_cmp_eq_u32 vcc, -1, v31
  v_mfma_f32_16x16x32_bf16 v[208:211], a[56:59], v[140:143], v[208:211]
  s_cbranch_vccnz sequential_preLN__ssm_conv_s4__geglu_ffn__prompt_kernel_ar38
sequential_preLN__ssm_conv_s4__geglu_ffn__prompt_kernel_ar38_b:
  v_mfma_f32_16x16x32_bf16 v[228:231], a[56:59], v[148:151], v[228:231]
  v_mfma_f32_16x16x32_bf16 v[228:231], a[76:79], v[144:147], v[228:231]
  v_mfma_f32_16x16x32_bf16 v[224:227], a[80:83], v[144:147], v[224:227]
  buffer_load_dwordx4 v[112:115], v28, s[48:51], s34 offen offset:2560 sc1
  v_mfma_f32_16x16x32_bf16 v[224:227], a[60:63], v[148:151], v[224:227]
  s_waitcnt vmcnt(19)
  v_lshlrev_b32 v232, 16, v48
  v_mfma_f32_16x16x32_bf16 v[220:223], a[64:67], v[148:151], v[220:223]
  v_and_b32 v233, 0xffff0000, v48
  v_mfma_f32_16x16x32_bf16 v[220:223], a[84:87], v[144:147], v[220:223]
  v_lshlrev_b32 v234, 16, v49
  v_mfma_f32_16x16x32_bf16 v[216:219], a[88:91], v[144:147], v[216:219]
  v_mfma_f32_16x16x32_bf16 v[216:219], a[68:71], v[148:151], v[216:219]
  buffer_load_dwordx4 v[116:119], v28, s[48:51], s35 offen offset:2560 sc1
  v_and_b32 v235, 0xffff0000, v49
  v_mfma_f32_16x16x32_bf16 v[212:215], a[72:75], v[148:151], v[212:215]
  v_max_u32 v31, v35, v39
  s_waitcnt vmcnt(13)
  v_max3_u32 v31, v31, v43, v47
  v_cmp_eq_u32 vcc, -1, v31
  v_mfma_f32_16x16x32_bf16 v[212:215], a[92:95], v[144:147], v[212:215]
  s_cbranch_vccnz sequential_preLN__ssm_conv_s4__geglu_ffn__prompt_kernel_ar39
sequential_preLN__ssm_conv_s4__geglu_ffn__prompt_kernel_ar39_b:
  v_mfma_f32_16x16x32_bf16 v[152:155], a[52:55], v[32:35], v[152:155]
  v_lshlrev_b32 v236, 16, v50
  v_mfma_f32_16x16x32_bf16 v[152:155], a[4:7], v[36:39], v[152:155]
  v_and_b32 v237, 0xffff0000, v50
  s_add_u32 s64, s57, 1
  s_and_b32 s64, s64, 3
  s_mul_i32 s64, s64, 15360
  v_add_u32 v6, s64, v3
  v_mfma_f32_16x16x32_bf16 v[152:155], a[24:27], v[40:43], v[152:155]
  buffer_load_dwordx4 v[120:123], v28, s[48:51], s34 offen offset:3072 sc1
  v_mfma_f32_16x16x32_bf16 v[152:155], a[248:251], v[44:47], v[152:155]
  v_lshlrev_b32 v238, 16, v51
  v_mfma_f32_16x16x32_bf16 v[156:159], a[244:247], v[44:47], v[156:159]
  v_and_b32 v239, 0xffff0000, v51
  v_mfma_f32_16x16x32_bf16 v[156:159], a[28:31], v[40:43], v[156:159]
  s_nop 3
  ds_write_b128 v6, v[152:155] offset:0
  v_mfma_f32_16x16x32_bf16 v[156:159], a[8:11], v[36:39], v[156:159]
  v_lshlrev_b32 v240, 16, v52
  s_waitcnt vmcnt(13)
  v_mfma_f32_16x16x32_bf16 v[156:159], a[48:51], v[32:35], v[156:159]
  buffer_load_dwordx4 v[124:127], v29, s[48:51], s35 offen offset:3072 sc1
  s_waitcnt vmcnt(12)
  v_mfma_f32_16x16x32_bf16 v[160:163], a[44:47], v[32:35], v[160:163]
  v_and_b32 v241, 0xffff0000, v52
  v_mfma_f32_16x16x32_bf16 v[160:163], a[12:15], v[36:39], v[160:163]
  v_lshlrev_b32 v242, 16, v53
  s_nop 1
  ds_write_b128 v6, v[156:159] offset:1024
  v_mfma_f32_16x16x32_bf16 v[160:163], a[32:35], v[40:43], v[160:163]
  v_and_b32 v243, 0xffff0000, v53
  v_mfma_f32_16x16x32_bf16 v[160:163], a[240:243], v[44:47], v[160:163]
  v_lshlrev_b32 v244, 16, v54
  v_mfma_f32_16x16x32_bf16 v[164:167], a[236:239], v[44:47], v[164:167]
  v_and_b32 v245, 0xffff0000, v54
  v_mfma_f32_16x16x32_bf16 v[164:167], a[36:39], v[40:43], v[164:167]
  s_nop 3
  ds_write_b128 v6, v[160:163] offset:2048
  v_mfma_f32_16x16x32_bf16 v[164:167], a[16:19], v[36:39], v[164:167]
  v_lshlrev_b32 v246, 16, v55
  s_waitcnt vmcnt(8)
  v_mfma_f32_16x16x32_bf16 v[164:167], a[40:43], v[32:35], v[164:167]
  v_and_b32 v247, 0xffff0000, v55
  v_mfma_f32_16x16x32_bf16 v[168:171], a[0:3], v[32:35], v[168:171]
  v_lshlrev_b32 v248, 16, v56
  v_mfma_f32_16x16x32_bf16 v[168:171], a[20:23], v[36:39], v[168:171]
  v_and_b32 v249, 0xffff0000, v56
  s_nop 2
  ds_write_b128 v6, v[164:167] offset:3072
  v_mfma_f32_16x16x32_bf16 v[168:171], a[252:255], v[40:43], v[168:171]
  v_max_u32 v31, v83, v87
  v_max3_u32 v31, v31, v91, v95
  v_cmp_eq_u32 vcc, -1, v31
  v_mfma_f32_16x16x32_bf16 v[168:171], a[232:235], v[44:47], v[168:171]
  s_cbranch_vccnz sequential_preLN__ssm_conv_s4__geglu_ffn__prompt_kernel_ar40
sequential_preLN__ssm_conv_s4__geglu_ffn__prompt_kernel_ar40_b:
  v_mfma_f32_16x16x32_bf16 v[172:175], a[52:55], v[80:83], v[172:175]
  v_lshlrev_b32 v250, 16, v57
  v_mfma_f32_16x16x32_bf16 v[172:175], a[4:7], v[84:87], v[172:175]
  v_and_b32 v251, 0xffff0000, v57
  s_nop 2
  ds_write_b128 v6, v[168:171] offset:4096
  s_add_u32 s64, s57, 2
  s_and_b32 s64, s64, 3
  s_mul_i32 s64, s64, 15360
  v_add_u32 v6, s64, v3
  v_mfma_f32_16x16x32_bf16 v[172:175], a[24:27], v[88:91], v[172:175]
  v_mfma_f32_16x16x32_bf16 v[172:175], a[248:251], v[92:95], v[172:175]
  v_mfma_f32_16x16x32_bf16 v[176:179], a[244:247], v[92:95], v[176:179]
  v_mfma_f32_16x16x32_bf16 v[176:179], a[28:31], v[88:91], v[176:179]
  s_waitcnt lgkmcnt(0)
  s_barrier
  ds_read_b128 v[48:51], v19 offset:0
  s_nop 2
  ds_write_b128 v6, v[172:175] offset:5120
  v_mfma_f32_16x16x32_bf16 v[176:179], a[8:11], v[84:87], v[176:179]
  ds_read_b128 v[52:55], v19 offset:1024
  ds_read_b128 v[56:59], v19 offset:2048
  v_mfma_f32_16x16x32_bf16 v[176:179], a[48:51], v[80:83], v[176:179]
  ds_read_b128 v[60:63], v19 offset:3072
  ds_read_b128 v[64:67], v19 offset:4096
  v_mfma_f32_16x16x32_bf16 v[180:183], a[44:47], v[80:83], v[180:183]
  v_mfma_f32_16x16x32_bf16 v[180:183], a[12:15], v[84:87], v[180:183]
  s_nop 3
  ds_write_b128 v6, v[176:179] offset:6144
  v_mfma_f32_16x16x32_bf16 v[180:183], a[32:35], v[88:91], v[180:183]
  v_mfma_f32_16x16x32_bf16 v[180:183], a[240:243], v[92:95], v[180:183]
  v_mfma_f32_16x16x32_bf16 v[184:187], a[236:239], v[92:95], v[184:187]
  s_waitcnt lgkmcnt(6)
  v_add_f32 v232, v232, v48
  v_add_f32 v233, v233, v49
  v_mfma_f32_16x16x32_bf16 v[184:187], a[36:39], v[88:91], v[184:187]
  v_add_f32 v234, v234, v50
  v_add_f32 v235, v235, v51
  s_waitcnt lgkmcnt(4)
  v_add_f32 v236, v236, v52
  ds_write_b128 v6, v[180:183] offset:7168
  v_mfma_f32_16x16x32_bf16 v[184:187], a[16:19], v[84:87], v[184:187]
  v_add_f32 v237, v237, v53
  v_add_f32 v238, v238, v54
  v_mfma_f32_16x16x32_bf16 v[184:187], a[40:43], v[80:83], v[184:187]
  v_add_f32 v239, v239, v55
  s_waitcnt lgkmcnt(4)
  v_add_f32 v240, v240, v56
  v_mfma_f32_16x16x32_bf16 v[188:191], a[0:3], v[80:83], v[188:191]
  v_add_f32 v241, v241, v57
  v_add_f32 v242, v242, v58
  v_add_f32 v243, v243, v59
  v_mfma_f32_16x16x32_bf16 v[188:191], a[20:23], v[84:87], v[188:191]
  s_waitcnt lgkmcnt(3)
  v_add_f32 v244, v244, v60
  v_add_f32 v245, v245, v61
  ds_write_b128 v6, v[184:187] offset:8192
  v_mfma_f32_16x16x32_bf16 v[188:191], a[252:255], v[88:91], v[188:191]
  s_waitcnt vmcnt(6)
  v_max_u32 v31, v99, v103
  s_waitcnt vmcnt(4)
  v_max3_u32 v31, v31, v107, v111
  v_cmp_eq_u32 vcc, -1, v31
  v_mfma_f32_16x16x32_bf16 v[188:191], a[232:235], v[92:95], v[188:191]
  s_cbranch_vccnz sequential_preLN__ssm_conv_s4__geglu_ffn__prompt_kernel_ar41
sequential_preLN__ssm_conv_s4__geglu_ffn__prompt_kernel_ar41_b:
  v_add_f32 v246, v246, v62
  v_mfma_f32_16x16x32_bf16 v[192:195], a[52:55], v[96:99], v[192:195]
  v_add_f32 v247, v247, v63
  s_waitcnt lgkmcnt(3)
  v_add_f32 v248, v248, v64
  v_add_f32 v249, v249, v65
  v_mfma_f32_16x16x32_bf16 v[192:195], a[4:7], v[100:103], v[192:195]
  v_add_f32 v250, v250, v66
  v_add_f32 v251, v251, v67
  ds_write_b128 v6, v[188:191] offset:9216
  s_add_u32 s64, s57, 3
  s_and_b32 s64, s64, 3
  s_mul_i32 s64, s64, 15360
  v_add_u32 v6, s64, v3
  v_mfma_f32_16x16x32_bf16 v[192:195], a[24:27], v[104:107], v[192:195]
  v_mfma_f32_16x16x32_bf16 v[192:195], a[248:251], v[108:111], v[192:195]
  v_mfma_f32_16x16x32_bf16 v[196:199], a[244:247], v[108:111], v[196:199]
  v_mfma_f32_16x16x32_bf16 v[196:199], a[28:31], v[104:107], v[196:199]
  s_waitcnt lgkmcnt(0)
  s_barrier
  ds_read_b128 v[48:51], v19 offset:5120
  s_nop 2
  ds_write_b128 v6, v[192:195] offset:10240
  v_mfma_f32_16x16x32_bf16 v[196:199], a[8:11], v[100:103], v[196:199]
  ds_read_b128 v[52:55], v19 offset:6144
  ds_read_b128 v[56:59], v19 offset:7168
  v_mfma_f32_16x16x32_bf16 v[196:199], a[48:51], v[96:99], v[196:199]
  ds_read_b128 v[60:63], v19 offset:8192
  ds_read_b128 v[64:67], v19 offset:9216
  v_mfma_f32_16x16x32_bf16 v[200:203], a[44:47], v[96:99], v[200:203]
  v_mfma_f32_16x16x32_bf16 v[200:203], a[12:15], v[100:103], v[200:203]
  s_nop 3
  ds_write_b128 v6, v[196:199] offset:11264
  v_mfma_f32_16x16x32_bf16 v[200:203], a[32:35], v[104:107], v[200:203]
  v_mfma_f32_16x16x32_bf16 v[200:203], a[240:243], v[108:111], v[200:203]
  v_mfma_f32_16x16x32_bf16 v[204:207], a[236:239], v[108:111], v[204:207]
  s_waitcnt lgkmcnt(6)
  v_add_f32 v232, v232, v48
  v_add_f32 v233, v233, v49
  v_mfma_f32_16x16x32_bf16 v[204:207], a[36:39], v[104:107], v[204:207]
  v_add_f32 v234, v234, v50
  v_add_f32 v235, v235, v51
  s_waitcnt lgkmcnt(4)
  v_add_f32 v236, v236, v52
  ds_write_b128 v6, v[200:203] offset:12288
  v_mfma_f32_16x16x32_bf16 v[204:207], a[16:19], v[100:103], v[204:207]
  v_add_f32 v237, v237, v53
  v_add_f32 v238, v238, v54
  v_mfma_f32_16x16x32_bf16 v[204:207], a[40:43], v[96:99], v[204:207]
  v_add_f32 v239, v239, v55
  s_waitcnt lgkmcnt(4)
  v_add_f32 v240, v240, v56
  v_mfma_f32_16x16x32_bf16 v[208:211], a[0:3], v[96:99], v[208:211]
  v_add_f32 v241, v241, v57
  v_add_f32 v242, v242, v58
  v_add_f32 v243, v243, v59
  v_mfma_f32_16x16x32_bf16 v[208:211], a[20:23], v[100:103], v[208:211]
  s_waitcnt lgkmcnt(3)
  v_add_f32 v244, v244, v60
  v_add_f32 v245, v245, v61
  ds_write_b128 v6, v[204:207] offset:13312
  v_mfma_f32_16x16x32_bf16 v[208:211], a[252:255], v[104:107], v[208:211]
  s_waitcnt vmcnt(2)
  v_max_u32 v31, v115, v119
  s_waitcnt vmcnt(0)
  v_max3_u32 v31, v31, v123, v127
  v_cmp_eq_u32 vcc, -1, v31
  v_mfma_f32_16x16x32_bf16 v[208:211], a[232:235], v[108:111], v[208:211]
  s_cbranch_vccnz sequential_preLN__ssm_conv_s4__geglu_ffn__prompt_kernel_ar42
sequential_preLN__ssm_conv_s4__geglu_ffn__prompt_kernel_ar42_b:
  v_add_f32 v246, v246, v62
  v_mfma_f32_16x16x32_bf16 v[212:215], a[52:55], v[112:115], v[212:215]
  v_add_f32 v247, v247, v63
  s_waitcnt lgkmcnt(3)
  v_add_f32 v248, v248, v64
  v_add_f32 v249, v249, v65
  v_mfma_f32_16x16x32_bf16 v[212:215], a[4:7], v[116:119], v[212:215]
  v_add_f32 v250, v250, v66
  v_add_f32 v251, v251, v67
  ds_write_b128 v6, v[208:211] offset:14336
  v_mfma_f32_16x16x32_bf16 v[212:215], a[24:27], v[120:123], v[212:215]
  v_mfma_f32_16x16x32_bf16 v[212:215], a[248:251], v[124:127], v[212:215]
  v_mfma_f32_16x16x32_bf16 v[216:219], a[244:247], v[124:127], v[216:219]
  v_mfma_f32_16x16x32_bf16 v[216:219], a[28:31], v[120:123], v[216:219]
  s_waitcnt lgkmcnt(0)
  s_barrier
  ds_read_b128 v[48:51], v19 offset:10240
  v_mfma_f32_16x16x32_bf16 v[216:219], a[8:11], v[116:119], v[216:219]
  ds_read_b128 v[52:55], v19 offset:11264
  ds_read_b128 v[56:59], v19 offset:12288
  v_mfma_f32_16x16x32_bf16 v[216:219], a[48:51], v[112:115], v[216:219]
  ds_read_b128 v[60:63], v19 offset:13312
  ds_read_b128 v[64:67], v19 offset:14336
  v_mfma_f32_16x16x32_bf16 v[220:223], a[44:47], v[112:115], v[220:223]
  v_mfma_f32_16x16x32_bf16 v[220:223], a[12:15], v[116:119], v[220:223]
  v_mfma_f32_16x16x32_bf16 v[220:223], a[32:35], v[120:123], v[220:223]
  v_mfma_f32_16x16x32_bf16 v[220:223], a[240:243], v[124:127], v[220:223]
  v_mfma_f32_16x16x32_bf16 v[224:227], a[236:239], v[124:127], v[224:227]
  s_waitcnt lgkmcnt(4)
  v_add_f32 v232, v232, v48
  v_add_f32 v233, v233, v49
  v_mfma_f32_16x16x32_bf16 v[224:227], a[36:39], v[120:123], v[224:227]
  v_add_f32 v234, v234, v50
  v_add_f32 v235, v235, v51
  v_mfma_f32_16x16x32_bf16 v[224:227], a[16:19], v[116:119], v[224:227]
  s_waitcnt lgkmcnt(3)
  v_add_f32 v236, v236, v52
  v_add_f32 v237, v237, v53
  v_mfma_f32_16x16x32_bf16 v[224:227], a[40:43], v[112:115], v[224:227]
  v_add_f32 v238, v238, v54
  v_add_f32 v239, v239, v55
  v_mfma_f32_16x16x32_bf16 v[228:231], a[0:3], v[112:115], v[228:231]
  s_waitcnt lgkmcnt(2)
  v_add_f32 v240, v240, v56
  v_add_f32 v241, v241, v57
  v_mfma_f32_16x16x32_bf16 v[228:231], a[20:23], v[116:119], v[228:231]
  v_add_f32 v242, v242, v58
  v_add_f32 v243, v243, v59
  v_mfma_f32_16x16x32_bf16 v[228:231], a[252:255], v[120:123], v[228:231]
  s_waitcnt lgkmcnt(1)
  v_add_f32 v244, v244, v60
  v_add_f32 v245, v245, v61
  v_mfma_f32_16x16x32_bf16 v[228:231], a[232:235], v[124:127], v[228:231]
  v_add_f32 v246, v246, v62
  v_add_f32 v247, v247, v63
  s_waitcnt lgkmcnt(0)
  v_add_f32 v248, v248, v64
  v_add_f32 v249, v249, v65
  v_add_f32 v250, v250, v66
  v_add_f32 v251, v251, v67
  v_add_f32 v232, v232, v212
  v_add_f32 v233, v233, v213
  v_add_f32 v234, v234, v214
  v_add_f32 v235, v235, v215
  v_cvt_pk_bf16_f32 v48, v232, v233
  v_cvt_pk_bf16_f32 v49, v234, v235
  v_add_f32 v236, v236, v216
  v_add_f32 v237, v237, v217
  v_add_f32 v238, v238, v218
  v_add_f32 v239, v239, v219
  v_cvt_pk_bf16_f32 v50, v236, v237
  v_cvt_pk_bf16_f32 v51, v238, v239
  s_nop 0
  v_permlane16_swap_b32 v48, v50
  v_permlane16_swap_b32 v49, v51
  buffer_store_dwordx4 v[48:51], v17, s[52:55], s67 offen offset:0
  v_add_f32 v240, v240, v220
  v_add_f32 v241, v241, v221
  v_add_f32 v242, v242, v222
  v_add_f32 v243, v243, v223
  v_cvt_pk_bf16_f32 v52, v240, v241
  v_cvt_pk_bf16_f32 v53, v242, v243
  v_add_f32 v244, v244, v224
  v_add_f32 v245, v245, v225
  v_add_f32 v246, v246, v226
  v_add_f32 v247, v247, v227
  v_cvt_pk_bf16_f32 v54, v244, v245
  v_cvt_pk_bf16_f32 v55, v246, v247
  s_nop 0
  v_permlane16_swap_b32 v52, v54
  v_permlane16_swap_b32 v53, v55
  buffer_store_dwordx4 v[52:55], v17, s[52:55], s67 offen offset:64
  v_add_f32 v248, v248, v228
  v_add_f32 v249, v249, v229
  v_add_f32 v250, v250, v230
  v_add_f32 v251, v251, v231
  v_cvt_pk_bf16_f32 v56, v248, v249
  v_cvt_pk_bf16_f32 v57, v250, v251
  buffer_store_dwordx2 v[56:57], v18, s[52:55], s67 offen offset:128
sequential_preLN__ssm_conv_s4__geglu_ffn__prompt_kernel_end:
  s_endpgm
sequential_preLN__ssm_conv_s4__geglu_ffn__prompt_kernel_st1:
  s_mov_b32 s65, 0
sequential_preLN__ssm_conv_s4__geglu_ffn__prompt_kernel_st1_l:
  buffer_load_dwordx4 v[224:227], v199, s[36:39], s77 offen offset:0 sc1
  buffer_load_dwordx4 v[228:231], v199, s[36:39], s77 offen offset:16 sc1
  buffer_load_dwordx4 v[232:235], v199, s[36:39], s69 offen offset:0 sc1
  buffer_load_dwordx4 v[236:239], v199, s[36:39], s69 offen offset:16 sc1
  s_add_u32 s65, s65, 1
  s_waitcnt vmcnt(0)
  v_cmp_ne_u32 vcc, s56, v225
  v_cmp_ne_u32 s[22:23], s56, v227
  v_cmp_ne_u32 s[26:27], s56, v229
  s_or_b64 vcc, vcc, s[22:23]
  v_cmp_ne_u32 s[22:23], s56, v231
  s_or_b64 vcc, vcc, s[26:27]
  v_cmp_ne_u32 s[26:27], s56, v233
  s_or_b64 vcc, vcc, s[22:23]
  v_cmp_ne_u32 s[22:23], s56, v235
  s_or_b64 vcc, vcc, s[26:27]
  v_cmp_ne_u32 s[26:27], s56, v237
  s_or_b64 vcc, vcc, s[22:23]
  v_cmp_ne_u32 s[22:23], s56, v239
  s_or_b64 vcc, vcc, s[26:27]
  s_or_b64 vcc, vcc, s[22:23]
  s_cmp_gt_u32 s65, 0x40000
  s_cbranch_scc1 sequential_preLN__ssm_conv_s4__geglu_ffn__prompt_kernel_st1_b
  s_cbranch_vccnz sequential_preLN__ssm_conv_s4__geglu_ffn__prompt_kernel_st1_l
  s_branch sequential_preLN__ssm_conv_s4__geglu_ffn__prompt_kernel_st1_b
sequential_preLN__ssm_conv_s4__geglu_ffn__prompt_kernel_hw2:
  s_mov_b32 s65, 0
sequential_preLN__ssm_conv_s4__geglu_ffn__prompt_kernel_hw2_l:
  buffer_load_dwordx4 v[24:27], v19, s[36:39], s24 offen sc1
  s_add_u32 s65, s65, 1
  s_waitcnt vmcnt(0)
  v_cmp_ne_u32 vcc, s56, v24
  v_cmp_ne_u32 s[22:23], s56, v25
  v_cmp_ne_u32 s[98:99], s56, v26
  s_or_b64 vcc, vcc, s[22:23]
  v_cmp_ne_u32 s[22:23], s56, v27
  s_or_b64 vcc, vcc, s[98:99]
  s_or_b64 vcc, vcc, s[22:23]
  s_cmp_gt_u32 s65, 0x40000
  s_cbranch_scc1 sequential_preLN__ssm_conv_s4__geglu_ffn__prompt_kernel_hw2_b
  s_cbranch_vccnz sequential_preLN__ssm_conv_s4__geglu_ffn__prompt_kernel_hw2_l
  s_branch sequential_preLN__ssm_conv_s4__geglu_ffn__prompt_kernel_hw2_b
sequential_preLN__ssm_conv_s4__geglu_ffn__prompt_kernel_hw8:
  s_mov_b32 s65, 0
sequential_preLN__ssm_conv_s4__geglu_ffn__prompt_kernel_hw8_l:
  buffer_load_dwordx4 v[24:27], v19, s[36:39], s24 offen sc1
  s_add_u32 s65, s65, 1
  s_waitcnt vmcnt(0)
  v_cmp_ne_u32 vcc, s56, v24
  v_cmp_ne_u32 s[22:23], s56, v25
  v_cmp_ne_u32 s[98:99], s56, v26
  s_or_b64 vcc, vcc, s[22:23]
  v_cmp_ne_u32 s[22:23], s56, v27
  s_or_b64 vcc, vcc, s[98:99]
  s_or_b64 vcc, vcc, s[22:23]
  s_cmp_gt_u32 s65, 0x40000
  s_cbranch_scc1 sequential_preLN__ssm_conv_s4__geglu_ffn__prompt_kernel_hw8_b
  s_cbranch_vccnz sequential_preLN__ssm_conv_s4__geglu_ffn__prompt_kernel_hw8_l
  s_branch sequential_preLN__ssm_conv_s4__geglu_ffn__prompt_kernel_hw8_b
sequential_preLN__ssm_conv_s4__geglu_ffn__prompt_kernel_hr10:
  s_mov_b32 s65, 0
sequential_preLN__ssm_conv_s4__geglu_ffn__prompt_kernel_hr10_l:
  buffer_load_dwordx4 v[96:99], v3, s[36:39], s8 offen offset:0 sc1
  buffer_load_dwordx4 v[100:103], v3, s[36:39], s8 offen offset:1024 sc1
  buffer_load_dwordx4 v[104:107], v3, s[36:39], s8 offen offset:2048 sc1
  buffer_load_dwordx4 v[108:111], v3, s[36:39], s8 offen offset:3072 sc1
  buffer_load_dwordx4 v[112:115], v3, s[36:39], s9 offen offset:0 sc1
  buffer_load_dwordx4 v[116:119], v3, s[36:39], s9 offen offset:1024 sc1
  buffer_load_dwordx4 v[120:123], v3, s[36:39], s9 offen offset:2048 sc1
  buffer_load_dwordx4 v[124:127], v3, s[36:39], s9 offen offset:3072 sc1
  s_add_u32 s65, s65, 1
  s_waitcnt vmcnt(4)
  v_max_u32 v31, v99, v103
  v_max3_u32 v31, v31, v107, v111
  v_cmp_eq_u32 vcc, -1, v31
  s_cmp_gt_u32 s65, 0x40000
  s_cbranch_scc1 sequential_preLN__ssm_conv_s4__geglu_ffn__prompt_kernel_hr10_b
  s_cbranch_vccnz sequential_preLN__ssm_conv_s4__geglu_ffn__prompt_kernel_hr10_l
  s_branch sequential_preLN__ssm_conv_s4__geglu_ffn__prompt_kernel_hr10_b
sequential_preLN__ssm_conv_s4__geglu_ffn__prompt_kernel_hr11:
  s_mov_b32 s65, 0
sequential_preLN__ssm_conv_s4__geglu_ffn__prompt_kernel_hr11_l:
  buffer_load_dwordx4 v[112:115], v3, s[36:39], s9 offen offset:0 sc1
  buffer_load_dwordx4 v[116:119], v3, s[36:39], s9 offen offset:1024 sc1
  buffer_load_dwordx4 v[120:123], v3, s[36:39], s9 offen offset:2048 sc1
  buffer_load_dwordx4 v[124:127], v3, s[36:39], s9 offen offset:3072 sc1
  buffer_load_dwordx4 v[128:131], v3, s[36:39], s10 offen offset:0 sc1
  buffer_load_dwordx4 v[132:135], v3, s[36:39], s10 offen offset:1024 sc1
  buffer_load_dwordx4 v[136:139], v3, s[36:39], s10 offen offset:2048 sc1
  buffer_load_dwordx4 v[140:143], v3, s[36:39], s10 offen offset:3072 sc1
  buffer_load_dwordx4 v[144:147], v3, s[36:39], s11 offen offset:0 sc1
  s_add_u32 s65, s65, 1
  s_waitcnt vmcnt(5)
  v_max_u32 v31, v115, v119
  v_max3_u32 v31, v31, v123, v127
  v_cmp_eq_u32 vcc, -1, v31
  s_cmp_gt_u32 s65, 0x40000
  s_cbranch_scc1 sequential_preLN__ssm_conv_s4__geglu_ffn__prompt_kernel_hr11_b
  s_cbranch_vccnz sequential_preLN__ssm_conv_s4__geglu_ffn__prompt_kernel_hr11_l
  s_branch sequential_preLN__ssm_conv_s4__geglu_ffn__prompt_kernel_hr11_b
sequential_preLN__ssm_conv_s4__geglu_ffn__prompt_kernel_hr12:
  s_mov_b32 s65, 0
sequential_preLN__ssm_conv_s4__geglu_ffn__prompt_kernel_hr12_l:
  buffer_load_dwordx4 v[128:131], v3, s[36:39], s10 offen offset:0 sc1
  buffer_load_dwordx4 v[132:135], v3, s[36:39], s10 offen offset:1024 sc1
  buffer_load_dwordx4 v[136:139], v3, s[36:39], s10 offen offset:2048 sc1
  buffer_load_dwordx4 v[140:143], v3, s[36:39], s10 offen offset:3072 sc1
  buffer_load_dwordx4 v[144:147], v3, s[36:39], s11 offen offset:0 sc1
  buffer_load_dwordx4 v[148:151], v3, s[36:39], s11 offen offset:1024 sc1
  buffer_load_dwordx4 v[80:83], v9, s[36:39], s75 offen sc1
  buffer_load_dwordx4 v[84:87], v9, s[36:39], s76 offen sc1
  buffer_load_dwordx4 v[88:91], v10, s[36:39], s77 offen sc1
  buffer_load_dwordx4 v[152:155], v3, s[36:39], s11 offen offset:2048 sc1
  buffer_load_dwordx4 v[156:159], v3, s[36:39], s11 offen offset:3072 sc1
  buffer_load_dwordx4 v[160:163], v3, s[36:39], s12 offen offset:0 sc1
  buffer_load_dwordx4 v[164:167], v3, s[36:39], s12 offen offset:1024 sc1
  s_add_u32 s65, s65, 1
  s_waitcnt vmcnt(9)
  v_max_u32 v31, v131, v135
  v_max3_u32 v31, v31, v139, v143
  v_cmp_eq_u32 vcc, -1, v31
  s_cmp_gt_u32 s65, 0x40000
  s_cbranch_scc1 sequential_preLN__ssm_conv_s4__geglu_ffn__prompt_kernel_hr12_b
  s_cbranch_vccnz sequential_preLN__ssm_conv_s4__geglu_ffn__prompt_kernel_hr12_l
  s_branch sequential_preLN__ssm_conv_s4__geglu_ffn__prompt_kernel_hr12_b
sequential_preLN__ssm_conv_s4__geglu_ffn__prompt_kernel_hr13:
  s_mov_b32 s65, 0
sequential_preLN__ssm_conv_s4__geglu_ffn__prompt_kernel_hr13_l:
  buffer_load_dwordx4 v[144:147], v3, s[36:39], s11 offen offset:0 sc1
  buffer_load_dwordx4 v[148:151], v3, s[36:39], s11 offen offset:1024 sc1
  buffer_load_dwordx4 v[152:155], v3, s[36:39], s11 offen offset:2048 sc1
  buffer_load_dwordx4 v[156:159], v3, s[36:39], s11 offen offset:3072 sc1
  buffer_load_dwordx4 v[160:163], v3, s[36:39], s12 offen offset:0 sc1
  buffer_load_dwordx4 v[164:167], v3, s[36:39], s12 offen offset:1024 sc1
  buffer_load_dwordx4 v[168:171], v3, s[36:39], s12 offen offset:2048 sc1
  buffer_load_dwordx4 v[172:175], v3, s[36:39], s12 offen offset:3072 sc1
  buffer_load_dwordx4 v[176:179], v3, s[36:39], s13 offen offset:0 sc1
  buffer_load_dwordx4 v[180:183], v3, s[36:39], s13 offen offset:1024 sc1
  buffer_load_dwordx4 v[184:187], v3, s[36:39], s13 offen offset:2048 sc1
  buffer_load_dwordx4 v[188:191], v3, s[36:39], s13 offen offset:3072 sc1
  s_add_u32 s65, s65, 1
  s_waitcnt vmcnt(8)
  v_max_u32 v31, v147, v151
  v_max3_u32 v31, v31, v155, v159
  v_cmp_eq_u32 vcc, -1, v31
  s_cmp_gt_u32 s65, 0x40000
  s_cbranch_scc1 sequential_preLN__ssm_conv_s4__geglu_ffn__prompt_kernel_hr13_b
  s_cbranch_vccnz sequential_preLN__ssm_conv_s4__geglu_ffn__prompt_kernel_hr13_l
  s_branch sequential_preLN__ssm_conv_s4__geglu_ffn__prompt_kernel_hr13_b
sequential_preLN__ssm_conv_s4__geglu_ffn__prompt_kernel_hr14:
  s_mov_b32 s65, 0
sequential_preLN__ssm_conv_s4__geglu_ffn__prompt_kernel_hr14_l:
  buffer_load_dwordx4 v[160:163], v3, s[36:39], s12 offen offset:0 sc1
  buffer_load_dwordx4 v[164:167], v3, s[36:39], s12 offen offset:1024 sc1
  buffer_load_dwordx4 v[168:171], v3, s[36:39], s12 offen offset:2048 sc1
  buffer_load_dwordx4 v[172:175], v3, s[36:39], s12 offen offset:3072 sc1
  buffer_load_dwordx4 v[176:179], v3, s[36:39], s13 offen offset:0 sc1
  buffer_load_dwordx4 v[180:183], v3, s[36:39], s13 offen offset:1024 sc1
  buffer_load_dwordx4 v[184:187], v3, s[36:39], s13 offen offset:2048 sc1
  buffer_load_dwordx4 v[188:191], v3, s[36:39], s13 offen offset:3072 sc1
  buffer_load_dwordx4 v[192:195], v3, s[36:39], s14 offen offset:0 sc1
  buffer_load_dwordx4 v[196:199], v3, s[36:39], s14 offen offset:1024 sc1
  buffer_load_dwordx4 v[200:203], v3, s[36:39], s14 offen offset:2048 sc1
  buffer_load_dwordx4 v[204:207], v3, s[36:39], s14 offen offset:3072 sc1
  s_add_u32 s65, s65, 1
  s_waitcnt vmcnt(0)
  v_max_u32 v31, v163, v167
  v_max3_u32 v31, v31, v171, v175
  v_cmp_eq_u32 vcc, -1, v31
  s_cmp_gt_u32 s65, 0x40000
  s_cbranch_scc1 sequential_preLN__ssm_conv_s4__geglu_ffn__prompt_kernel_hr14_b
  s_cbranch_vccnz sequential_preLN__ssm_conv_s4__geglu_ffn__prompt_kernel_hr14_l
  s_branch sequential_preLN__ssm_conv_s4__geglu_ffn__prompt_kernel_hr14_b
sequential_preLN__ssm_conv_s4__geglu_ffn__prompt_kernel_hr15:
  s_mov_b32 s65, 0
sequential_preLN__ssm_conv_s4__geglu_ffn__prompt_kernel_hr15_l:
  buffer_load_dwordx4 v[176:179], v3, s[36:39], s13 offen offset:0 sc1
  buffer_load_dwordx4 v[180:183], v3, s[36:39], s13 offen offset:1024 sc1
  buffer_load_dwordx4 v[184:187], v3, s[36:39], s13 offen offset:2048 sc1
  buffer_load_dwordx4 v[188:191], v3, s[36:39], s13 offen offset:3072 sc1
  buffer_load_dwordx4 v[192:195], v3, s[36:39], s14 offen offset:0 sc1
  buffer_load_dwordx4 v[196:199], v3, s[36:39], s14 offen offset:1024 sc1
  buffer_load_dwordx4 v[200:203], v3, s[36:39], s14 offen offset:2048 sc1
  buffer_load_dwordx4 v[204:207], v3, s[36:39], s14 offen offset:3072 sc1
  buffer_load_dwordx4 v[208:211], v3, s[36:39], s15 offen offset:0 sc1
  buffer_load_dwordx4 v[212:215], v3, s[36:39], s15 offen offset:1024 sc1
  buffer_load_dwordx4 v[216:219], v3, s[36:39], s15 offen offset:2048 sc1
  buffer_load_dwordx4 v[220:223], v3, s[36:39], s15 offen offset:3072 sc1
  buffer_load_dwordx4 v[224:227], v3, s[36:39], s16 offen offset:0 sc1
  s_add_u32 s65, s65, 1
  s_waitcnt vmcnt(0)
  v_max_u32 v31, v179, v183
  v_max3_u32 v31, v31, v187, v191
  v_cmp_eq_u32 vcc, -1, v31
  s_cmp_gt_u32 s65, 0x40000
  s_cbranch_scc1 sequential_preLN__ssm_conv_s4__geglu_ffn__prompt_kernel_hr15_b
  s_cbranch_vccnz sequential_preLN__ssm_conv_s4__geglu_ffn__prompt_kernel_hr15_l
  s_branch sequential_preLN__ssm_conv_s4__geglu_ffn__prompt_kernel_hr15_b
sequential_preLN__ssm_conv_s4__geglu_ffn__prompt_kernel_hr16:
  s_mov_b32 s65, 0
sequential_preLN__ssm_conv_s4__geglu_ffn__prompt_kernel_hr16_l:
  buffer_load_dwordx4 v[192:195], v3, s[36:39], s14 offen offset:0 sc1
  buffer_load_dwordx4 v[196:199], v3, s[36:39], s14 offen offset:1024 sc1
  buffer_load_dwordx4 v[200:203], v3, s[36:39], s14 offen offset:2048 sc1
  buffer_load_dwordx4 v[204:207], v3, s[36:39], s14 offen offset:3072 sc1
  s_add_u32 s65, s65, 1
  s_waitcnt vmcnt(0)
  v_max_u32 v31, v195, v199
  v_max3_u32 v31, v31, v203, v207
  v_cmp_eq_u32 vcc, -1, v31
  s_cmp_gt_u32 s65, 0x40000
  s_cbranch_scc1 sequential_preLN__ssm_conv_s4__geglu_ffn__prompt_kernel_hr16_b
  s_cbranch_vccnz sequential_preLN__ssm_conv_s4__geglu_ffn__prompt_kernel_hr16_l
  s_branch sequential_preLN__ssm_conv_s4__geglu_ffn__prompt_kernel_hr16_b
sequential_preLN__ssm_conv_s4__geglu_ffn__prompt_kernel_hr17:
  s_mov_b32 s65, 0
sequential_preLN__ssm_conv_s4__geglu_ffn__prompt_kernel_hr17_l:
  buffer_load_dwordx4 v[208:211], v3, s[36:39], s15 offen offset:0 sc1
  buffer_load_dwordx4 v[212:215], v3, s[36:39], s15 offen offset:1024 sc1
  buffer_load_dwordx4 v[216:219], v3, s[36:39], s15 offen offset:2048 sc1
  buffer_load_dwordx4 v[220:223], v3, s[36:39], s15 offen offset:3072 sc1
  s_add_u32 s65, s65, 1
  s_waitcnt vmcnt(0)
  v_max_u32 v31, v211, v215
  v_max3_u32 v31, v31, v219, v223
  v_cmp_eq_u32 vcc, -1, v31
  s_cmp_gt_u32 s65, 0x40000
  s_cbranch_scc1 sequential_preLN__ssm_conv_s4__geglu_ffn__prompt_kernel_hr17_b
  s_cbranch_vccnz sequential_preLN__ssm_conv_s4__geglu_ffn__prompt_kernel_hr17_l
  s_branch sequential_preLN__ssm_conv_s4__geglu_ffn__prompt_kernel_hr17_b
sequential_preLN__ssm_conv_s4__geglu_ffn__prompt_kernel_hr18:
  s_mov_b32 s65, 0
sequential_preLN__ssm_conv_s4__geglu_ffn__prompt_kernel_hr18_l:
  buffer_load_dwordx4 v[224:227], v3, s[36:39], s16 offen offset:0 sc1
  buffer_load_dwordx4 v[228:231], v3, s[36:39], s16 offen offset:1024 sc1
  buffer_load_dwordx4 v[232:235], v3, s[36:39], s16 offen offset:2048 sc1
  buffer_load_dwordx4 v[236:239], v3, s[36:39], s16 offen offset:3072 sc1
  s_add_u32 s65, s65, 1
  s_waitcnt vmcnt(0)
  v_max_u32 v31, v227, v231
  v_max3_u32 v31, v31, v235, v239
  v_cmp_eq_u32 vcc, -1, v31
  s_cmp_gt_u32 s65, 0x40000
  s_cbranch_scc1 sequential_preLN__ssm_conv_s4__geglu_ffn__prompt_kernel_hr18_b
  s_cbranch_vccnz sequential_preLN__ssm_conv_s4__geglu_ffn__prompt_kernel_hr18_l
  s_branch sequential_preLN__ssm_conv_s4__geglu_ffn__prompt_kernel_hr18_b
sequential_preLN__ssm_conv_s4__geglu_ffn__prompt_kernel_hr19:
  s_mov_b32 s65, 0
sequential_preLN__ssm_conv_s4__geglu_ffn__prompt_kernel_hr19_l:
  buffer_load_dwordx4 v[240:243], v3, s[36:39], s17 offen offset:0 sc1
  buffer_load_dwordx4 v[244:247], v3, s[36:39], s17 offen offset:1024 sc1
  buffer_load_dwordx4 v[248:251], v3, s[36:39], s17 offen offset:2048 sc1
  buffer_load_dwordx4 v[252:255], v3, s[36:39], s17 offen offset:3072 sc1
  s_add_u32 s65, s65, 1
  s_waitcnt vmcnt(0)
  v_max_u32 v31, v243, v247
  v_max3_u32 v31, v31, v251, v255
  v_cmp_eq_u32 vcc, -1, v31
  s_cmp_gt_u32 s65, 0x40000
  s_cbranch_scc1 sequential_preLN__ssm_conv_s4__geglu_ffn__prompt_kernel_hr19_b
  s_cbranch_vccnz sequential_preLN__ssm_conv_s4__geglu_ffn__prompt_kernel_hr19_l
  s_branch sequential_preLN__ssm_conv_s4__geglu_ffn__prompt_kernel_hr19_b
sequential_preLN__ssm_conv_s4__geglu_ffn__prompt_kernel_sr20:
  s_mov_b32 s65, 0
sequential_preLN__ssm_conv_s4__geglu_ffn__prompt_kernel_sr20_l:
  buffer_load_dwordx4 v[80:83], v9, s[36:39], s75 offen sc1
  buffer_load_dwordx4 v[84:87], v9, s[36:39], s76 offen sc1
  buffer_load_dwordx4 v[88:91], v10, s[36:39], s77 offen sc1
  buffer_load_dwordx4 v[152:155], v3, s[36:39], s11 offen offset:2048 sc1
  buffer_load_dwordx4 v[156:159], v3, s[36:39], s11 offen offset:3072 sc1
  buffer_load_dwordx4 v[160:163], v3, s[36:39], s12 offen offset:0 sc1
  buffer_load_dwordx4 v[164:167], v3, s[36:39], s12 offen offset:1024 sc1
  buffer_load_dwordx4 v[168:171], v3, s[36:39], s12 offen offset:2048 sc1
  buffer_load_dwordx4 v[172:175], v3, s[36:39], s12 offen offset:3072 sc1
  buffer_load_dwordx4 v[176:179], v3, s[36:39], s13 offen offset:0 sc1
  buffer_load_dwordx4 v[180:183], v3, s[36:39], s13 offen offset:1024 sc1
  buffer_load_dwordx4 v[184:187], v3, s[36:39], s13 offen offset:2048 sc1
  s_add_u32 s65, s65, 1
  s_waitcnt vmcnt(9)
  v_max3_u32 v31, v83, v87, v91
  v_cmp_eq_u32 vcc, -1, v31
  s_cmp_gt_u32 s65, 0x40000
  s_cbranch_scc1 sequential_preLN__ssm_conv_s4__geglu_ffn__prompt_kernel_sr20_b
  s_cbranch_vccnz sequential_preLN__ssm_conv_s4__geglu_ffn__prompt_kernel_sr20_l
  s_branch sequential_preLN__ssm_conv_s4__geglu_ffn__prompt_kernel_sr20_b
sequential_preLN__ssm_conv_s4__geglu_ffn__prompt_kernel_ar23:
  s_mov_b32 s65, 0
sequential_preLN__ssm_conv_s4__geglu_ffn__prompt_kernel_ar23_l:
  buffer_load_dwordx4 v[112:115], v28, s[48:51], s28 offen offset:512 sc1
  buffer_load_dwordx4 v[116:119], v28, s[48:51], s29 offen offset:512 sc1
  s_add_u32 s65, s65, 1
  s_waitcnt vmcnt(0)
  v_max_u32 v31, v115, v119
  v_cmp_eq_u32 vcc, -1, v31
  s_cmp_gt_u32 s65, 0x40000
  s_cbranch_scc1 sequential_preLN__ssm_conv_s4__geglu_ffn__prompt_kernel_ar23_b
  s_cbranch_vccnz sequential_preLN__ssm_conv_s4__geglu_ffn__prompt_kernel_ar23_l
  s_branch sequential_preLN__ssm_conv_s4__geglu_ffn__prompt_kernel_ar23_b
sequential_preLN__ssm_conv_s4__geglu_ffn__prompt_kernel_ar24:
  s_mov_b32 s65, 0
sequential_preLN__ssm_conv_s4__geglu_ffn__prompt_kernel_ar24_l:
  buffer_load_dwordx4 v[120:123], v28, s[48:51], s30 offen offset:512 sc1
  buffer_load_dwordx4 v[124:127], v28, s[48:51], s31 offen offset:512 sc1
  s_add_u32 s65, s65, 1
  s_waitcnt vmcnt(0)
  v_max_u32 v31, v123, v127
  v_cmp_eq_u32 vcc, -1, v31
  s_cmp_gt_u32 s65, 0x40000
  s_cbranch_scc1 sequential_preLN__ssm_conv_s4__geglu_ffn__prompt_kernel_ar24_b
  s_cbranch_vccnz sequential_preLN__ssm_conv_s4__geglu_ffn__prompt_kernel_ar24_l
  s_branch sequential_preLN__ssm_conv_s4__geglu_ffn__prompt_kernel_ar24_b
sequential_preLN__ssm_conv_s4__geglu_ffn__prompt_kernel_ar25:
  s_mov_b32 s65, 0
sequential_preLN__ssm_conv_s4__geglu_ffn__prompt_kernel_ar25_l:
  buffer_load_dwordx4 v[128:131], v28, s[48:51], s32 offen offset:512 sc1
  buffer_load_dwordx4 v[132:135], v28, s[48:51], s33 offen offset:512 sc1
  s_add_u32 s65, s65, 1
  s_waitcnt vmcnt(0)
  v_max_u32 v31, v131, v135
  v_cmp_eq_u32 vcc, -1, v31
  s_cmp_gt_u32 s65, 0x40000
  s_cbranch_scc1 sequential_preLN__ssm_conv_s4__geglu_ffn__prompt_kernel_ar25_b
  s_cbranch_vccnz sequential_preLN__ssm_conv_s4__geglu_ffn__prompt_kernel_ar25_l
  s_branch sequential_preLN__ssm_conv_s4__geglu_ffn__prompt_kernel_ar25_b
sequential_preLN__ssm_conv_s4__geglu_ffn__prompt_kernel_ar26:
  s_mov_b32 s65, 0
sequential_preLN__ssm_conv_s4__geglu_ffn__prompt_kernel_ar26_l:
  buffer_load_dwordx4 v[136:139], v28, s[48:51], s34 offen offset:512 sc1
  buffer_load_dwordx4 v[140:143], v28, s[48:51], s35 offen offset:512 sc1
  s_add_u32 s65, s65, 1
  s_waitcnt vmcnt(0)
  v_max_u32 v31, v139, v143
  v_cmp_eq_u32 vcc, -1, v31
  s_cmp_gt_u32 s65, 0x40000
  s_cbranch_scc1 sequential_preLN__ssm_conv_s4__geglu_ffn__prompt_kernel_ar26_b
  s_cbranch_vccnz sequential_preLN__ssm_conv_s4__geglu_ffn__prompt_kernel_ar26_l
  s_branch sequential_preLN__ssm_conv_s4__geglu_ffn__prompt_kernel_ar26_b
sequential_preLN__ssm_conv_s4__geglu_ffn__prompt_kernel_ar27:
  s_mov_b32 s65, 0
sequential_preLN__ssm_conv_s4__geglu_ffn__prompt_kernel_ar27_l:
  buffer_load_dwordx4 v[144:147], v28, s[48:51], s28 offen offset:1024 sc1
  buffer_load_dwordx4 v[148:151], v28, s[48:51], s29 offen offset:1024 sc1
  s_add_u32 s65, s65, 1
  s_waitcnt vmcnt(0)
  v_max_u32 v31, v147, v151
  v_cmp_eq_u32 vcc, -1, v31
  s_cmp_gt_u32 s65, 0x40000
  s_cbranch_scc1 sequential_preLN__ssm_conv_s4__geglu_ffn__prompt_kernel_ar27_b
  s_cbranch_vccnz sequential_preLN__ssm_conv_s4__geglu_ffn__prompt_kernel_ar27_l
  s_branch sequential_preLN__ssm_conv_s4__geglu_ffn__prompt_kernel_ar27_b
sequential_preLN__ssm_conv_s4__geglu_ffn__prompt_kernel_ar28:
  s_mov_b32 s65, 0
sequential_preLN__ssm_conv_s4__geglu_ffn__prompt_kernel_ar28_l:
  buffer_load_dwordx4 v[32:35], v28, s[48:51], s30 offen offset:1024 sc1
  buffer_load_dwordx4 v[36:39], v28, s[48:51], s31 offen offset:1024 sc1
  s_add_u32 s65, s65, 1
  s_waitcnt vmcnt(0)
  v_max_u32 v31, v35, v39
  v_cmp_eq_u32 vcc, -1, v31
  s_cmp_gt_u32 s65, 0x40000
  s_cbranch_scc1 sequential_preLN__ssm_conv_s4__geglu_ffn__prompt_kernel_ar28_b
  s_cbranch_vccnz sequential_preLN__ssm_conv_s4__geglu_ffn__prompt_kernel_ar28_l
  s_branch sequential_preLN__ssm_conv_s4__geglu_ffn__prompt_kernel_ar28_b
sequential_preLN__ssm_conv_s4__geglu_ffn__prompt_kernel_ar29:
  s_mov_b32 s65, 0
sequential_preLN__ssm_conv_s4__geglu_ffn__prompt_kernel_ar29_l:
  buffer_load_dwordx4 v[40:43], v28, s[48:51], s32 offen offset:1024 sc1
  buffer_load_dwordx4 v[44:47], v28, s[48:51], s33 offen offset:1024 sc1
  s_add_u32 s65, s65, 1
  s_waitcnt vmcnt(0)
  v_max_u32 v31, v43, v47
  v_cmp_eq_u32 vcc, -1, v31
  s_cmp_gt_u32 s65, 0x40000
  s_cbranch_scc1 sequential_preLN__ssm_conv_s4__geglu_ffn__prompt_kernel_ar29_b
  s_cbranch_vccnz sequential_preLN__ssm_conv_s4__geglu_ffn__prompt_kernel_ar29_l
  s_branch sequential_preLN__ssm_conv_s4__geglu_ffn__prompt_kernel_ar29_b
sequential_preLN__ssm_conv_s4__geglu_ffn__prompt_kernel_ar30:
  s_mov_b32 s65, 0
sequential_preLN__ssm_conv_s4__geglu_ffn__prompt_kernel_ar30_l:
  buffer_load_dwordx4 v[80:83], v28, s[48:51], s34 offen offset:1024 sc1
  buffer_load_dwordx4 v[84:87], v28, s[48:51], s35 offen offset:1024 sc1
  s_add_u32 s65, s65, 1
  s_waitcnt vmcnt(0)
  v_max_u32 v31, v83, v87
  v_cmp_eq_u32 vcc, -1, v31
  s_cmp_gt_u32 s65, 0x40000
  s_cbranch_scc1 sequential_preLN__ssm_conv_s4__geglu_ffn__prompt_kernel_ar30_b
  s_cbranch_vccnz sequential_preLN__ssm_conv_s4__geglu_ffn__prompt_kernel_ar30_l
  s_branch sequential_preLN__ssm_conv_s4__geglu_ffn__prompt_kernel_ar30_b
sequential_preLN__ssm_conv_s4__geglu_ffn__prompt_kernel_ar31:
  s_mov_b32 s65, 0
sequential_preLN__ssm_conv_s4__geglu_ffn__prompt_kernel_ar31_l:
  buffer_load_dwordx4 v[88:91], v28, s[48:51], s28 offen offset:1536 sc1
  buffer_load_dwordx4 v[92:95], v28, s[48:51], s29 offen offset:1536 sc1
  s_add_u32 s65, s65, 1
  s_waitcnt vmcnt(0)
  v_max_u32 v31, v91, v95
  v_cmp_eq_u32 vcc, -1, v31
  s_cmp_gt_u32 s65, 0x40000
  s_cbranch_scc1 sequential_preLN__ssm_conv_s4__geglu_ffn__prompt_kernel_ar31_b
  s_cbranch_vccnz sequential_preLN__ssm_conv_s4__geglu_ffn__prompt_kernel_ar31_l
  s_branch sequential_preLN__ssm_conv_s4__geglu_ffn__prompt_kernel_ar31_b
sequential_preLN__ssm_conv_s4__geglu_ffn__prompt_kernel_ar32:
  s_mov_b32 s65, 0
sequential_preLN__ssm_conv_s4__geglu_ffn__prompt_kernel_ar32_l:
  buffer_load_dwordx4 v[96:99], v28, s[48:51], s30 offen offset:1536 sc1
  buffer_load_dwordx4 v[100:103], v28, s[48:51], s31 offen offset:1536 sc1
  s_add_u32 s65, s65, 1
  s_waitcnt vmcnt(0)
  v_max_u32 v31, v99, v103
  v_cmp_eq_u32 vcc, -1, v31
  s_cmp_gt_u32 s65, 0x40000
  s_cbranch_scc1 sequential_preLN__ssm_conv_s4__geglu_ffn__prompt_kernel_ar32_b
  s_cbranch_vccnz sequential_preLN__ssm_conv_s4__geglu_ffn__prompt_kernel_ar32_l
  s_branch sequential_preLN__ssm_conv_s4__geglu_ffn__prompt_kernel_ar32_b
sequential_preLN__ssm_conv_s4__geglu_ffn__prompt_kernel_ar33:
  s_mov_b32 s65, 0
sequential_preLN__ssm_conv_s4__geglu_ffn__prompt_kernel_ar33_l:
  buffer_load_dwordx4 v[104:107], v28, s[48:51], s32 offen offset:1536 sc1
  buffer_load_dwordx4 v[108:111], v28, s[48:51], s33 offen offset:1536 sc1
  s_add_u32 s65, s65, 1
  s_waitcnt vmcnt(0)
  v_max_u32 v31, v107, v111
  v_cmp_eq_u32 vcc, -1, v31
  s_cmp_gt_u32 s65, 0x40000
  s_cbranch_scc1 sequential_preLN__ssm_conv_s4__geglu_ffn__prompt_kernel_ar33_b
  s_cbranch_vccnz sequential_preLN__ssm_conv_s4__geglu_ffn__prompt_kernel_ar33_l
  s_branch sequential_preLN__ssm_conv_s4__geglu_ffn__prompt_kernel_ar33_b
sequential_preLN__ssm_conv_s4__geglu_ffn__prompt_kernel_ar34:
  s_mov_b32 s65, 0
sequential_preLN__ssm_conv_s4__geglu_ffn__prompt_kernel_ar34_l:
  buffer_load_dwordx4 v[112:115], v28, s[48:51], s34 offen offset:1536 sc1
  buffer_load_dwordx4 v[116:119], v28, s[48:51], s35 offen offset:1536 sc1
  s_add_u32 s65, s65, 1
  s_waitcnt vmcnt(0)
  v_max_u32 v31, v115, v119
  v_cmp_eq_u32 vcc, -1, v31
  s_cmp_gt_u32 s65, 0x40000
  s_cbranch_scc1 sequential_preLN__ssm_conv_s4__geglu_ffn__prompt_kernel_ar34_b
  s_cbranch_vccnz sequential_preLN__ssm_conv_s4__geglu_ffn__prompt_kernel_ar34_l
  s_branch sequential_preLN__ssm_conv_s4__geglu_ffn__prompt_kernel_ar34_b
sequential_preLN__ssm_conv_s4__geglu_ffn__prompt_kernel_ar35:
  s_mov_b32 s65, 0
sequential_preLN__ssm_conv_s4__geglu_ffn__prompt_kernel_ar35_l:
  buffer_load_dwordx4 v[120:123], v28, s[48:51], s28 offen offset:2048 sc1
  buffer_load_dwordx4 v[124:127], v28, s[48:51], s29 offen offset:2048 sc1
  s_add_u32 s65, s65, 1
  s_waitcnt vmcnt(0)
  v_max_u32 v31, v123, v127
  v_cmp_eq_u32 vcc, -1, v31
  s_cmp_gt_u32 s65, 0x40000
  s_cbranch_scc1 sequential_preLN__ssm_conv_s4__geglu_ffn__prompt_kernel_ar35_b
  s_cbranch_vccnz sequential_preLN__ssm_conv_s4__geglu_ffn__prompt_kernel_ar35_l
  s_branch sequential_preLN__ssm_conv_s4__geglu_ffn__prompt_kernel_ar35_b
sequential_preLN__ssm_conv_s4__geglu_ffn__prompt_kernel_ar36:
  s_mov_b32 s65, 0
sequential_preLN__ssm_conv_s4__geglu_ffn__prompt_kernel_ar36_l:
  buffer_load_dwordx4 v[128:131], v28, s[48:51], s30 offen offset:2048 sc1
  buffer_load_dwordx4 v[132:135], v28, s[48:51], s31 offen offset:2048 sc1
  s_add_u32 s65, s65, 1
  s_waitcnt vmcnt(0)
  v_max_u32 v31, v131, v135
  v_cmp_eq_u32 vcc, -1, v31
  s_cmp_gt_u32 s65, 0x40000
  s_cbranch_scc1 sequential_preLN__ssm_conv_s4__geglu_ffn__prompt_kernel_ar36_b
  s_cbranch_vccnz sequential_preLN__ssm_conv_s4__geglu_ffn__prompt_kernel_ar36_l
  s_branch sequential_preLN__ssm_conv_s4__geglu_ffn__prompt_kernel_ar36_b
sequential_preLN__ssm_conv_s4__geglu_ffn__prompt_kernel_ar37:
  s_mov_b32 s65, 0
sequential_preLN__ssm_conv_s4__geglu_ffn__prompt_kernel_ar37_l:
  buffer_load_dwordx4 v[136:139], v28, s[48:51], s32 offen offset:2048 sc1
  buffer_load_dwordx4 v[140:143], v28, s[48:51], s33 offen offset:2048 sc1
  s_add_u32 s65, s65, 1
  s_waitcnt vmcnt(0)
  v_max_u32 v31, v139, v143
  v_cmp_eq_u32 vcc, -1, v31
  s_cmp_gt_u32 s65, 0x40000
  s_cbranch_scc1 sequential_preLN__ssm_conv_s4__geglu_ffn__prompt_kernel_ar37_b
  s_cbranch_vccnz sequential_preLN__ssm_conv_s4__geglu_ffn__prompt_kernel_ar37_l
  s_branch sequential_preLN__ssm_conv_s4__geglu_ffn__prompt_kernel_ar37_b
sequential_preLN__ssm_conv_s4__geglu_ffn__prompt_kernel_ar38:
  s_mov_b32 s65, 0
sequential_preLN__ssm_conv_s4__geglu_ffn__prompt_kernel_ar38_l:
  buffer_load_dwordx4 v[144:147], v28, s[48:51], s34 offen offset:2048 sc1
  buffer_load_dwordx4 v[148:151], v28, s[48:51], s35 offen offset:2048 sc1
  s_add_u32 s65, s65, 1
  s_waitcnt vmcnt(0)
  v_max_u32 v31, v147, v151
  v_cmp_eq_u32 vcc, -1, v31
  s_cmp_gt_u32 s65, 0x40000
  s_cbranch_scc1 sequential_preLN__ssm_conv_s4__geglu_ffn__prompt_kernel_ar38_b
  s_cbranch_vccnz sequential_preLN__ssm_conv_s4__geglu_ffn__prompt_kernel_ar38_l
  s_branch sequential_preLN__ssm_conv_s4__geglu_ffn__prompt_kernel_ar38_b
sequential_preLN__ssm_conv_s4__geglu_ffn__prompt_kernel_ar39:
  s_mov_b32 s65, 0
sequential_preLN__ssm_conv_s4__geglu_ffn__prompt_kernel_ar39_l:
  buffer_load_dwordx4 v[32:35], v28, s[48:51], s28 offen offset:2560 sc1
  buffer_load_dwordx4 v[36:39], v28, s[48:51], s29 offen offset:2560 sc1
  buffer_load_dwordx4 v[40:43], v28, s[48:51], s28 offen offset:3072 sc1
  buffer_load_dwordx4 v[44:47], v29, s[48:51], s29 offen offset:3072 sc1
  s_add_u32 s65, s65, 1
  s_waitcnt vmcnt(0)
  v_max_u32 v31, v35, v39
  v_max3_u32 v31, v31, v43, v47
  v_cmp_eq_u32 vcc, -1, v31
  s_cmp_gt_u32 s65, 0x40000
  s_cbranch_scc1 sequential_preLN__ssm_conv_s4__geglu_ffn__prompt_kernel_ar39_b
  s_cbranch_vccnz sequential_preLN__ssm_conv_s4__geglu_ffn__prompt_kernel_ar39_l
  s_branch sequential_preLN__ssm_conv_s4__geglu_ffn__prompt_kernel_ar39_b
sequential_preLN__ssm_conv_s4__geglu_ffn__prompt_kernel_ar40:
  s_mov_b32 s65, 0
sequential_preLN__ssm_conv_s4__geglu_ffn__prompt_kernel_ar40_l:
  buffer_load_dwordx4 v[80:83], v28, s[48:51], s30 offen offset:2560 sc1
  buffer_load_dwordx4 v[84:87], v28, s[48:51], s31 offen offset:2560 sc1
  buffer_load_dwordx4 v[88:91], v28, s[48:51], s30 offen offset:3072 sc1
  buffer_load_dwordx4 v[92:95], v29, s[48:51], s31 offen offset:3072 sc1
  s_add_u32 s65, s65, 1
  s_waitcnt vmcnt(0)
  v_max_u32 v31, v83, v87
  v_max3_u32 v31, v31, v91, v95
  v_cmp_eq_u32 vcc, -1, v31
  s_cmp_gt_u32 s65, 0x40000
  s_cbranch_scc1 sequential_preLN__ssm_conv_s4__geglu_ffn__prompt_kernel_ar40_b
  s_cbranch_vccnz sequential_preLN__ssm_conv_s4__geglu_ffn__prompt_kernel_ar40_l
  s_branch sequential_preLN__ssm_conv_s4__geglu_ffn__prompt_kernel_ar40_b
sequential_preLN__ssm_conv_s4__geglu_ffn__prompt_kernel_ar41:
  s_mov_b32 s65, 0
sequential_preLN__ssm_conv_s4__geglu_ffn__prompt_kernel_ar41_l:
  buffer_load_dwordx4 v[96:99], v28, s[48:51], s32 offen offset:2560 sc1
  buffer_load_dwordx4 v[100:103], v28, s[48:51], s33 offen offset:2560 sc1
  buffer_load_dwordx4 v[104:107], v28, s[48:51], s32 offen offset:3072 sc1
  buffer_load_dwordx4 v[108:111], v29, s[48:51], s33 offen offset:3072 sc1
  s_add_u32 s65, s65, 1
  s_waitcnt vmcnt(0)
  v_max_u32 v31, v99, v103
  v_max3_u32 v31, v31, v107, v111
  v_cmp_eq_u32 vcc, -1, v31
  s_cmp_gt_u32 s65, 0x40000
  s_cbranch_scc1 sequential_preLN__ssm_conv_s4__geglu_ffn__prompt_kernel_ar41_b
  s_cbranch_vccnz sequential_preLN__ssm_conv_s4__geglu_ffn__prompt_kernel_ar41_l
  s_branch sequential_preLN__ssm_conv_s4__geglu_ffn__prompt_kernel_ar41_b
sequential_preLN__ssm_conv_s4__geglu_ffn__prompt_kernel_ar42:
  s_mov_b32 s65, 0
sequential_preLN__ssm_conv_s4__geglu_ffn__prompt_kernel_ar42_l:
  buffer_load_dwordx4 v[112:115], v28, s[48:51], s34 offen offset:2560 sc1
  buffer_load_dwordx4 v[116:119], v28, s[48:51], s35 offen offset:2560 sc1
  buffer_load_dwordx4 v[120:123], v28, s[48:51], s34 offen offset:3072 sc1
  buffer_load_dwordx4 v[124:127], v29, s[48:51], s35 offen offset:3072 sc1
  s_add_u32 s65, s65, 1
  s_waitcnt vmcnt(0)
  v_max_u32 v31, v115, v119
  v_max3_u32 v31, v31, v123, v127
  v_cmp_eq_u32 vcc, -1, v31
  s_cmp_gt_u32 s65, 0x40000
  s_cbranch_scc1 sequential_preLN__ssm_conv_s4__geglu_ffn__prompt_kernel_ar42_b
  s_cbranch_vccnz sequential_preLN__ssm_conv_s4__geglu_ffn__prompt_kernel_ar42_l
  s_branch sequential_preLN__ssm_conv_s4__geglu_ffn__prompt_kernel_ar42_b
sequential_preLN__ssm_conv_s4__geglu_ffn__prompt_kernel_last:
.section .rodata,"a"
.p2align 6
.amdhsa_kernel sequential_preLN__ssm_conv_s4__geglu_ffn__prompt_kernel
  .amdhsa_next_free_vgpr 512
  .amdhsa_next_free_sgpr 102
  .amdhsa_accum_offset 256
  .amdhsa_group_segment_fixed_size 0
  .amdhsa_kernarg_size 128
  .amdhsa_user_sgpr_count 2
  .amdhsa_user_sgpr_kernarg_segment_ptr 1
  .amdhsa_system_sgpr_workgroup_id_x 1
.end_amdhsa_kernel
```
